```python
import torch

def _softmax(x, axis=-1):
    return torch.softmax(x, dim=axis)

def _gelu(x):
    return torch.nn.functional.gelu(x, approximate='tanh')

def _silu(x):
    return torch.nn.functional.silu(x)

def _sigmoid(x):
    return torch.sigmoid(x)

def _layernorm(x, axis=-1, eps=1e-05):
    m = x.mean(dim=axis, keepdim=True)
    v = x.var(dim=axis, keepdim=True, unbiased=False)
    return (x - m) / torch.sqrt(v + eps)

def _scatter_add(tgt, idx, src, axis=0):
    return tgt.clone().index_add_(axis, idx, src)

def _segment_sum(src, seg, n):
    out = torch.zeros((n,) + src.shape[1:], dtype=src.dtype)
    return out.index_add_(0, seg, src)

def _pad(x, pw):
    flat = tuple((v for pair in reversed(pw) for v in pair))
    return torch.nn.functional.pad(x, flat)
kernel_name = 'adaLN_cond__linear_kernel_hedgehog__glu_gated_bilinear__prompt'

def setup_inputs():

    _w = lambda a: (lambda t: t.to(torch.bfloat16) if t.is_floating_point() else t)(torch.as_tensor(a))

    def _A_setup():
        B, S, D, H = (1, 2048, 448, 16)
        Dh = D // H
        return {'x': _w((lambda *s: torch.randn(*s, dtype=torch.bfloat16) * 0.05)(B, S, D)), 'wqkv': _w((lambda *s: torch.randn(*s, dtype=torch.bfloat16) * 0.4)(D, 3 * D)), 'w_phi': _w((lambda *s: torch.randn(*s, dtype=torch.bfloat16) * 0.4)(H, Dh, Dh) * Dh ** (-0.5)), 'wo': _w((lambda *s: torch.randn(*s, dtype=torch.bfloat16) * 0.05)(D, D))}
    _A_in = _A_setup()

    def _B_setup():
        B, S, D, F = (1, 2048, 448, 1792)
        return {'x': _w((lambda *s: torch.randn(*s, dtype=torch.bfloat16) * 0.05)(B, S, D)), 'w_gate': _w((lambda *s: torch.randn(*s, dtype=torch.bfloat16) * 1.6)(D, F) * D ** (-0.5)), 'w_up': _w((lambda *s: torch.randn(*s, dtype=torch.bfloat16) * 1.6)(D, F) * D ** (-0.5)), 'w_down': _w((lambda *s: torch.randn(*s, dtype=torch.bfloat16) * 1.6)(F, D) * F ** (-0.5))}
    _B_in = _B_setup()
    return {'A_x': _A_in['x'], 'A_wqkv': _A_in['wqkv'], 'A_w_phi': _A_in['w_phi'], 'A_wo': _A_in['wo'], 'B_x': _B_in['x'], 'B_w_gate': _B_in['w_gate'], 'B_w_up': _B_in['w_up'], 'B_w_down': _B_in['w_down'], 'c': _w((lambda *s: torch.randn(*s, dtype=torch.bfloat16) * 0.1)(1, 448) * 8.0), 'w_mod': _w((lambda *s: torch.randn(*s, dtype=torch.bfloat16) * 0.1)(448, 6 * 448) * 448 ** (-0.5) * 8.0)}

def reference(A_x, A_wqkv, A_w_phi, A_wo, B_x, B_w_gate, B_w_up, B_w_down, c, w_mod):

    def _A_ref(x, wqkv, w_phi, wo):
        B, S, D = x.shape
        H = 16
        Dh = D // H
        qkv = (lambda x, *d: x.permute(*d))((x @ wqkv).reshape(B, S, 3, H, Dh), 2, 0, 3, 1, 4)
        q, k, v = (qkv[0], qkv[1], qkv[2])
        pq = torch.einsum('bhsd,hdf->bhsf', q, w_phi)
        pk = torch.einsum('bhsd,hdf->bhsf', k, w_phi)
        phi_q = torch.concatenate([_softmax(pq, axis=-1), _softmax(-pq, axis=-1)], axis=-1)
        phi_k = torch.concatenate([_softmax(pk, axis=-1), _softmax(-pk, axis=-1)], axis=-1)
        kv = torch.einsum('bhsf,bhsd->bhfd', phi_k, v)
        z = torch.einsum('bhsf->bhf', phi_k)
        num = torch.einsum('bhqf,bhfd->bhqd', phi_q, kv)
        den = torch.einsum('bhqf,bhf->bhq', phi_q, z)[..., None] + 1e-06
        o = num / den
        return (lambda x, *d: x.permute(*d))(o, 0, 2, 1, 3).reshape(B, S, D) @ wo

    def _B_ref(x, w_gate, w_up, w_down):
        g = torch.einsum('bsd,df->bsf', x, w_gate)
        u = torch.einsum('bsd,df->bsf', x, w_up)
        h = g * u
        return torch.einsum('bsf,fd->bsd', h, w_down)
    x = A_x
    mod = (_silu(c) @ w_mod).reshape(c.shape[0], 6, 1, -1)
    sa, ca, ga, sb, cb, gb = (mod[:, 0].clone(), mod[:, 1].clone(), mod[:, 2].clone(), mod[:, 3].clone(), mod[:, 4].clone(), mod[:, 5].clone())
    h = _layernorm(x, axis=-1) * (1 + ca) + sa
    x = x + ga * _A_ref(h, A_wqkv, A_w_phi, A_wo)
    h = _layernorm(x, axis=-1) * (1 + cb) + sb
    x = x + gb * _B_ref(h, B_w_gate, B_w_up, B_w_down)
    return x
```

```asm
; @launch grid=(256,1,1) block=(256,1,1) lds=163840
.amdgcn_target "amdgcn-amd-amdhsa--gfx950"
.text
.globl adaLN_cond__linear_kernel_hedgehog__glu_gated_bilinear__prompt_kernel
.p2align 8
.type adaLN_cond__linear_kernel_hedgehog__glu_gated_bilinear__prompt_kernel,@function
adaLN_cond__linear_kernel_hedgehog__glu_gated_bilinear__prompt_kernel:
    s_cmp_ge_u32 s2, 256
    s_cbranch_scc1 L_exit
    s_load_dwordx16 s[16:31], s[0:1], 0
    s_load_dwordx8 s[32:39], s[0:1], 64
    s_load_dwordx2 s[84:85], s[0:1], 96
    s_getpc_b64 s[8:9]
L_pc:
    s_lshr_b32 s10, s2, 3
    s_mul_i32 s10, s10, 1664
    v_lshl_add_u32 v3, v0, 7, s10
    v_min_u32 v3, L_exit-L_pc, v3
    v_cmp_gt_u32 vcc, 13, v0
    s_nop 0
    s_and_b64 exec, exec, vcc
    s_cbranch_execz L_ct
    global_load_dword v2, v3, s[8:9]
L_ct:
    s_mov_b64 exec, -1
    v_and_b32 v255, 63, v0
    v_lshrrev_b32_e64 v1, 6, v0
    s_nop 0
    v_readfirstlane_b32 s3, v1
    s_and_b32 s4, s2, 7
    s_lshr_b32 s5, s2, 3
    s_lshr_b32 s8, s5, 4
    s_lshl_b32 s6, s4, 1
    s_add_u32 s6, s6, s8
    s_and_b32 s7, s5, 15
    s_mov_b32 s95, 0
    s_mov_b32 s96, 0x3fb8aa3b
    s_mov_b32 s97, 0x3fb8aa3b
    s_mov_b32 s98, 0
    s_mov_b32 s99, -1
    s_mov_b32 s100, 0xffff0000
    s_mov_b32 s101, 0x3f803f80
    s_mov_b32 s46, 1835008
    s_mov_b32 s47, 0x00020000
    s_mov_b32 s50, 1204224
    s_mov_b32 s51, 0x00020000
    s_mov_b32 s54, 25088
    s_mov_b32 s55, 0x00020000
    s_mov_b32 s58, 401408
    s_mov_b32 s59, 0x00020000
    s_mov_b32 s62, 1605632
    s_mov_b32 s63, 0x00020000
    s_mov_b32 s66, 1605632
    s_mov_b32 s67, 0x00020000
    s_mov_b32 s70, 1605632
    s_mov_b32 s71, 0x00020000
    s_mov_b32 s74, 896
    s_mov_b32 s75, 0x00020000
    s_mov_b32 s78, 2408448
    s_mov_b32 s79, 0x00020000
    s_mov_b32 s82, 1835008
    s_mov_b32 s83, 0x00020000
    s_mov_b32 s86, 33554432
    s_mov_b32 s87, 0x00020000
    s_lshr_b32 s8, s5, 3
    s_lshl_b32 s8, s8, 3
    s_add_u32 s8, s8, s4
    s_lshl_b32 s8, s8, 3
    s_and_b32 s9, s5, 7
    s_add_u32 s43, s8, s9
    s_sub_u32 s8, s43, 112
    s_lshl_b32 s8, s8, 2
    s_add_u32 s8, s8, s3
    s_mul_i32 s12, s8, 2341
    s_lshr_b32 s12, s12, 16
    s_mul_i32 s9, s12, 28
    s_sub_u32 s42, s8, s9
    s_add_u32 s42, s42, 14
    s_lshr_b32 s8, s4, 1
    s_lshl_b32 s8, s8, 2
    s_lshr_b32 s9, s5, 3
    s_add_u32 s8, s8, s9
    s_and_b32 s9, s4, 1
    s_lshl_b32 s9, s9, 3
    s_and_b32 s10, s5, 7
    s_add_u32 s4, s9, s10
    s_mov_b32 s5, s8
    s_mul_i32 s14, s3, 28672
    v_mov_b32 v254, 0
    v_lshlrev_b32 v1, 7, v255
    v_and_b32 v6, 15, v255
    v_lshlrev_b32 v6, 21, v6
    s_and_b32 s8, s4, 7
    s_mul_i32 s9, s8, 37
    s_lshr_b32 s9, s9, 8
    s_mul_i32 s9, s9, 7
    s_sub_u32 s41, s8, s9
    s_mov_b32 s41, 0
    v_lshrrev_b32 v3, 3, v255
    v_lshrrev_b32 v4, 4, v255
    v_and_b32 v5, 7, v255
    v_xor_b32 v5, v5, v4
    v_lshlrev_b32 v5, 4, v5
    v_mul_u32_u24 v3, 896, v3
    v_add_u32 v250, v3, v5
    v_xor_b32 v251, 64, v250
    s_lshl_b32 s8, s5, 2
    s_add_u32 s8, s8, s3
    s_mul_i32 s11, s8, 28672
    s_and_b32 s8, s4, 7
    s_mul_i32 s8, s8, 2
    s_add_u32 s8, s8, s3
    s_lshl_b32 s9, s5, 4
    s_add_u32 s8, s8, s9
    s_mul_i32 s10, s8, 7168
    s_cmp_ge_u32 s3, 2
    s_cselect_b32 s10, 0x4000000, s10
    v_min_u32 v7, 7040, v1
    v_mul_u32_u24 v170, 5376, v255
    v_lshlrev_b32 v168, 1, v255
    s_lshl_b32 s8, s43, 4
    s_mul_i32 s9, s3, 688128
    s_add_u32 s8, s8, s9
    s_lshl_b32 s9, s3, 8
    s_cmp_ge_u32 s43, 112
    s_cselect_b32 s8, 0x4000000, s8
    s_waitcnt lgkmcnt(0)
    s_mov_b64 s[44:45], s[16:17]
    s_mov_b64 s[76:77], s[34:35]
    s_mov_b64 s[72:73], s[32:33]
    s_mov_b32 s0, s14
    s_nop 0
    buffer_load_dword v253, v254, s[84:87], 0 offen sc1
    buffer_load_ushort v184, v168, s[72:75], s9 offen offset:0
    buffer_load_ushort v185, v168, s[72:75], s9 offen offset:128
    buffer_load_dwordx4 v[172:175], v170, s[76:79], s8 offen
    s_add_u32 s8, s8, 344064
    buffer_load_dwordx4 v[176:179], v170, s[76:79], s8 offen
    buffer_load_dword v2, v7, s[44:47], s10 offen
    s_mov_b64 s[48:49], s[18:19]
    s_mov_b64 s[52:53], s[20:21]
    s_mov_b64 s[56:57], s[22:23]
    s_mov_b64 s[60:61], s[26:27]
    s_mov_b64 s[64:65], s[28:29]
    s_mov_b64 s[68:69], s[30:31]
    s_mov_b64 s[80:81], s[36:37]
    v_lshrrev_b32 v3, 2, v255
    v_mul_u32_u24 v3, 2688, v3
    v_and_b32_e64 v4, 3, v255
    v_lshl_add_u32 v252, v4, 4, v3
    s_mul_i32 s10, s3, 43008
    s_mul_i32 s9, s4, 56
    s_add_u32 s1, s10, s9
    v_and_b32 v5, 31, v255
    v_lshrrev_b32 v6, 5, v255
    v_bfe_u32 v7, v255, 1, 3
    v_xor_b32 v6, v6, v7
    v_lshlrev_b32 v5, 7, v5
    v_add_u32 v5, s0, v5
    v_xor_b32 v7, 0, v6
    v_lshl_add_u32 v240, v7, 4, v5
    v_xor_b32_e64 v7, 2, v6
    v_lshl_add_u32 v241, v7, 4, v5
    v_xor_b32_e64 v7, 4, v6
    v_lshl_add_u32 v242, v7, 4, v5
    v_xor_b32_e64 v7, 6, v6
    v_lshl_add_u32 v243, v7, 4, v5
    v_mov_b32 v224, 0
    v_mov_b32 v225, 0
    v_mov_b32 v226, 0
    v_mov_b32 v227, 0
    s_mul_i32 s8, s3, 448
    s_add_u32 s2, s8, 4096
    v_min_u32 v232, 55, v255
    v_lshlrev_b32 v232, 3, v232
    s_lshl_b32 s9, s41, 8
    s_sub_u32 s8, s8, s9
    v_add_u32_e64 v233, s8, v232
    v_add_u32 v234, 1792, v233
    v_min_u32_e64 v233, v233, v234
    v_add_u32 v233, 151552, v233
    v_lshrrev_b32 v3, 5, v255
    v_lshlrev_b32 v222, 5, v3
    v_add_u32 v222, 151552, v222
    v_bfe_u32 v4, v255, 3, 1
    v_lshl_add_u32 v246, v4, 6, v222
    v_and_b32_e64 v4, 7, v255
    v_lshl_add_u32 v246, v4, 2, v246
    v_lshlrev_b32_e64 v3, 3, v3
    v_bfe_u32 v4, v255, 2, 2
    v_add_u32 v3, v3, v4
    v_lshlrev_b32 v3, 6, v3
    v_bfe_u32 v4, v255, 4, 1
    v_lshl_add_u32 v3, v4, 5, v3
    v_and_b32_e64 v4, 3, v255
    v_lshl_add_u32 v223, v4, 3, v3
    v_mul_u32_u24 v244, 4682, v255
    v_lshrrev_b32 v244, 16, v244
    v_mul_u32_u24 v3, 14, v244
    v_sub_u32 v3, v255, v3
    v_lshrrev_b32 v4, 2, v244
    v_mul_u32_u24 v244, 3584, v244
    v_lshl_add_u32 v244, v3, 4, v244
    v_lshl_add_u32 v244, v4, 26, v244
    s_lshl_b32 s14, s5, 1
    s_add_u32 s14, s14, s3
    s_sub_u32 s14, s14, 2
    s_mul_i32 s14, s14, 57344
    s_mul_i32 s9, s4, 224
    s_add_u32 s37, s14, s9
    s_cmp_ge_u32 s5, 14
    s_cselect_b32 s37, 0x4000000, s37
    v_lshrrev_b32 v245, 3, v255
    v_bfe_u32 v3, v255, 4, 1
    v_lshlrev_b32 v3, 2, v3
    v_and_b32 v4, 7, v255
    v_xor_b32_e64 v3, v3, v4
    v_mul_u32_u24 v245, 896, v245
    v_lshl_add_u32 v245, v3, 4, v245
    s_lshl_b32 s14, s6, 1
    s_and_b32 s9, s7, 1
    s_add_u32 s14, s14, s9
    s_lshl_b32 s14, s14, 1
    s_add_u32 s14, s14, s3
    s_sub_u32 s14, s14, 2
    s_mul_i32 s14, s14, 28672
    s_lshr_b32 s9, s7, 1
    s_lshl_b32 s9, s9, 7
    s_add_u32 s40, s14, s9
    s_cmp_ge_u32 s7, 14
    s_cselect_b32 s40, 0x4000000, s40
    s_cmp_ge_u32 s6, 14
    s_cselect_b32 s40, 0x4000000, s40
    s_cmp_lt_u32 s43, 112
    s_cselect_b32 s12, 1000, s12
    v_lshrrev_b32 v228, 3, v255
    v_and_b32_e64 v229, 7, v255
    v_mul_u32_u24 v230, 5376, v228
    v_lshl_add_u32 v230, v229, 4, v230
    v_lshlrev_b32_e64 v228, 1, v228
    s_lshl_b32 s14, s6, 4
    s_add_u32 s14, s14, s7
    s_mov_b32 s10, 0
    s_add_u32 s10, s10, s11
    s_add_u32 m0, s0, 0
    s_add_u32 s15, s10, 0
    buffer_load_dwordx4 v250, s[44:47], s15 offen  lds
    s_add_u32 m0, s0, 1024
    s_add_u32 s15, s10, 7168
    buffer_load_dwordx4 v251, s[44:47], s15 offen  lds
    s_add_u32 m0, s0, 2048
    s_add_u32 s15, s10, 14336
    buffer_load_dwordx4 v250, s[44:47], s15 offen  lds
    s_add_u32 m0, s0, 3072
    s_add_u32 s15, s10, 21504
    buffer_load_dwordx4 v251, s[44:47], s15 offen  lds
    s_mov_b32 s10, 128
    s_add_u32 s10, s10, s11
    s_add_u32 m0, s0, 4096
    s_add_u32 s15, s10, 0
    buffer_load_dwordx4 v250, s[44:47], s15 offen  lds
    s_add_u32 m0, s0, 5120
    s_add_u32 s15, s10, 7168
    buffer_load_dwordx4 v251, s[44:47], s15 offen  lds
    s_add_u32 m0, s0, 6144
    s_add_u32 s15, s10, 14336
    buffer_load_dwordx4 v250, s[44:47], s15 offen  lds
    s_add_u32 m0, s0, 7168
    s_add_u32 s15, s10, 21504
    buffer_load_dwordx4 v251, s[44:47], s15 offen  lds
    s_mov_b32 s10, 256
    s_add_u32 s10, s10, s11
    s_add_u32 m0, s0, 8192
    s_add_u32 s15, s10, 0
    buffer_load_dwordx4 v250, s[44:47], s15 offen  lds
    s_add_u32 m0, s0, 9216
    s_add_u32 s15, s10, 7168
    buffer_load_dwordx4 v251, s[44:47], s15 offen  lds
    s_add_u32 m0, s0, 10240
    s_add_u32 s15, s10, 14336
    buffer_load_dwordx4 v250, s[44:47], s15 offen  lds
    s_add_u32 m0, s0, 11264
    s_add_u32 s15, s10, 21504
    buffer_load_dwordx4 v251, s[44:47], s15 offen  lds
    s_mul_i32 s8, s14, 4736
    s_cmp_lg_u32 s3, 1
    s_cselect_b32 s8, 0x4000000, s8
    v_min_u32 v7, 4608, v1
    buffer_load_dword a200, v7, s[48:51], s8 offen
    v_lshlrev_b32 v7, 4, v255
    s_mul_i32 s8, s4, 1568
    s_lshl_b32 s9, s3, 10
    s_add_u32 s8, s8, s9
    s_add_u32 m0, s9, 159744
    s_cmp_ge_u32 s3, 2
    s_cselect_b32 s8, 0x4000000, s8
    buffer_load_dwordx4 v7, s[52:55], s8 offen lds
    s_waitcnt vmcnt(19)
    v_readfirstlane_b32 s13, v253
    s_nop 0
    s_lshl_b32 s8, s13, 4
    s_add_u32 s9, s8, 1
    s_mul_i32 s88, s9, 0x9E3779B1
    s_add_u32 s9, s8, 2
    s_mul_i32 s89, s9, 0x9E3779B1
    s_add_u32 s9, s8, 3
    s_mul_i32 s90, s9, 0x9E3779B1
    s_add_u32 s9, s8, 4
    s_mul_i32 s91, s9, 0x9E3779B1
    s_add_u32 s9, s8, 5
    s_mul_i32 s92, s9, 0x9E3779B1
    s_add_u32 s9, s8, 6
    s_mul_i32 s93, s9, 0x9E3779B1
    s_add_u32 s9, s8, 7
    s_mul_i32 s94, s9, 0x9E3779B1
    s_mov_b32 s10, 384
    s_add_u32 s10, s10, s11
    s_add_u32 m0, s0, 12288
    s_add_u32 s15, s10, 0
    buffer_load_dwordx4 v250, s[44:47], s15 offen  lds
    s_add_u32 m0, s0, 13312
    s_add_u32 s15, s10, 7168
    buffer_load_dwordx4 v251, s[44:47], s15 offen  lds
    s_add_u32 m0, s0, 14336
    s_add_u32 s15, s10, 14336
    buffer_load_dwordx4 v250, s[44:47], s15 offen  lds
    s_add_u32 m0, s0, 15360
    s_add_u32 s15, s10, 21504
    buffer_load_dwordx4 v251, s[44:47], s15 offen  lds
    s_waitcnt vmcnt(14)
    s_cmp_ge_u32 s43, 112
    s_cbranch_scc1 L_gv2
    v_mov_b32 v192, 0
    v_mov_b32 v193, 0
    v_mov_b32 v194, 0
    v_mov_b32 v195, 0
    v_mov_b32 v196, 0
    v_mov_b32 v197, 0
    v_mov_b32 v198, 0
    v_mov_b32 v199, 0
    v_lshlrev_b32_e64 v184, 16, v184
    v_mul_f32_e64 v188, -v184, s96
    v_exp_f32 v188, v188
    v_lshlrev_b32 v185, 16, v185
    v_mul_f32_e64 v189, -v185, s96
    v_exp_f32 v189, v189
    v_add_f32 v188, 1.0, v188
    v_rcp_f32 v188, v188
    v_add_f32 v189, 1.0, v189
    v_rcp_f32 v189, v189
    v_lshrrev_b32_e64 v168, 1, v255
    s_lshl_b32 s8, s3, 5
    s_add_u32 s8, s8, 151552
    v_add_u32_e64 v169, s8, v168
    v_add_u32 v170, 151552, v168
    v_mul_f32_e64 v184, v184, v188
    v_cvt_pk_bf16_f32 v184, v184, v184
    v_and_b32 v188, s100, v184
    v_lshrrev_b32 v184, 16, v184
    v_mul_f32_e64 v185, v185, v189
    v_cvt_pk_bf16_f32 v185, v185, v185
    v_and_b32 v189, s100, v185
    v_lshrrev_b32 v185, 16, v185
    v_dot2c_f32_bf16 v192, v172, v184
    v_dot2c_f32_bf16 v193, v172, v188
    v_dot2c_f32_bf16 v194, v173, v184
    v_dot2c_f32_bf16 v195, v173, v188
    v_dot2c_f32_bf16 v196, v174, v184
    v_dot2c_f32_bf16 v197, v174, v188
    v_dot2c_f32_bf16 v198, v175, v184
    v_dot2c_f32_bf16 v199, v175, v188
    v_dot2c_f32_bf16 v192, v176, v185
    v_dot2c_f32_bf16 v193, v176, v189
    v_dot2c_f32_bf16 v194, v177, v185
    v_dot2c_f32_bf16 v195, v177, v189
    v_dot2c_f32_bf16 v196, v178, v185
    v_dot2c_f32_bf16 v197, v178, v189
    v_dot2c_f32_bf16 v198, v179, v185
    v_dot2c_f32_bf16 v199, v179, v189
    v_permlane32_swap_b32 v192, v196
    v_permlane32_swap_b32 v193, v197
    v_permlane32_swap_b32 v194, v198
    v_permlane32_swap_b32 v195, v199
    v_add_f32 v192, v192, v196
    v_add_f32 v193, v193, v197
    v_add_f32 v194, v194, v198
    v_add_f32 v195, v195, v199
    s_nop 0
    v_permlane16_swap_b32 v192, v194
    v_permlane16_swap_b32 v193, v195
    v_add_f32 v192, v192, v194
    v_add_f32 v193, v193, v195
    s_nop 0
    v_add_f32_dpp v192, v192, v192 row_ror:8 row_mask:0xf bank_mask:0xf
    v_add_f32_dpp v193, v193, v193 row_ror:8 row_mask:0xf bank_mask:0xf
    s_nop 0
    v_add_f32_dpp v192, v192, v192 row_ror:4 row_mask:0xf bank_mask:0xf
    v_add_f32_dpp v193, v193, v193 row_ror:4 row_mask:0xf bank_mask:0xf
    s_nop 0
    v_add_f32_dpp v192, v192, v192 row_ror:2 row_mask:0xf bank_mask:0xf
    v_add_f32_dpp v193, v193, v193 row_ror:2 row_mask:0xf bank_mask:0xf
    s_nop 0
    s_nop 0
    v_add_f32_dpp v192, v192, v192 row_ror:1 row_mask:0xf bank_mask:0xf
    v_add_f32_dpp v193, v193, v193 row_ror:1 row_mask:0xf bank_mask:0xf
    s_mov_b32 exec_lo, 0x00010001
    s_mov_b32 exec_hi, 0x00010001
    ds_write_b64 v169, v[192:193]
    s_waitcnt lgkmcnt(0)
    s_barrier
    s_cmp_lg_u32 s3, 3
    s_cbranch_scc1 L_gvp
    ds_read_b64 v[172:173], v170 offset:0
    ds_read_b64 v[174:175], v170 offset:32
    ds_read_b64 v[176:177], v170 offset:64
    ds_read_b64 v[178:179], v170 offset:96
    s_mov_b32 s8, 0
    s_cmp_ge_u32 s43, 56
    s_cselect_b32 s8, 1.0, s8
    v_mov_b32_e64 v181, s88
    s_lshl_b32 s9, s43, 5
    s_add_u32 s9, s9, 4096
    s_waitcnt lgkmcnt(0)
    v_add_f32 v172, v172, v174
    v_add_f32 v173, v173, v175
    v_add_f32 v176, v176, v178
    v_add_f32 v177, v177, v179
    v_add_f32 v172, v172, v176
    v_add_f32_e64 v173, v173, v177
    v_cvt_pk_bf16_f32 v174, v172, v173
    v_lshlrev_b32 v172, 16, v174
    v_and_b32 v173, s100, v174
    v_add_f32 v172, s8, v172
    v_add_f32 v173, s8, v173
    v_cvt_pk_bf16_f32 v180, v172, v173
    buffer_store_dwordx2 v[180:181], v168, s[84:87], s9 offen sc1
L_gvp:
    s_mov_b64 exec, -1
L_gv2:
    s_nop 0
    ds_read_b128 v[4:7], v240 offset:0
    ds_read_b128 v[12:15], v241 offset:0
    ds_read_b128 v[20:23], v242 offset:0
    ds_read_b128 v[28:31], v243 offset:0
    s_mov_b32 s10, 512
    s_add_u32 s10, s10, s11
    s_add_u32 m0, s0, 16384
    s_add_u32 s15, s10, 0
    buffer_load_dwordx4 v250, s[44:47], s15 offen  lds
    s_add_u32 m0, s0, 17408
    s_add_u32 s15, s10, 7168
    buffer_load_dwordx4 v251, s[44:47], s15 offen  lds
    s_add_u32 m0, s0, 18432
    s_add_u32 s15, s10, 14336
    buffer_load_dwordx4 v250, s[44:47], s15 offen  lds
    s_add_u32 m0, s0, 19456
    s_add_u32 s15, s10, 21504
    buffer_load_dwordx4 v251, s[44:47], s15 offen  lds
    s_waitcnt vmcnt(14)
    ds_read_b128 v[36:39], v240 offset:4096
    ds_read_b128 v[44:47], v241 offset:4096
    ds_read_b128 v[52:55], v242 offset:4096
    ds_read_b128 v[60:63], v243 offset:4096
    s_waitcnt lgkmcnt(4)
    v_dot2c_f32_bf16 v224, s101, v4
    v_dot2c_f32_bf16 v226, v4, v4
    v_dot2c_f32_bf16 v225, s101, v5
    v_dot2c_f32_bf16 v227, v5, v5
    v_dot2c_f32_bf16 v224, s101, v6
    v_dot2c_f32_bf16 v226, v6, v6
    v_dot2c_f32_bf16 v225, s101, v7
    v_dot2c_f32_bf16 v227, v7, v7
    v_dot2c_f32_bf16 v224, s101, v12
    v_dot2c_f32_bf16 v226, v12, v12
    v_dot2c_f32_bf16 v225, s101, v13
    v_dot2c_f32_bf16 v227, v13, v13
    v_dot2c_f32_bf16 v224, s101, v14
    v_dot2c_f32_bf16 v226, v14, v14
    v_dot2c_f32_bf16 v225, s101, v15
    v_dot2c_f32_bf16 v227, v15, v15
    v_dot2c_f32_bf16 v224, s101, v20
    v_dot2c_f32_bf16 v226, v20, v20
    v_dot2c_f32_bf16 v225, s101, v21
    v_dot2c_f32_bf16 v227, v21, v21
    v_dot2c_f32_bf16 v224, s101, v22
    v_dot2c_f32_bf16 v226, v22, v22
    v_dot2c_f32_bf16 v225, s101, v23
    v_dot2c_f32_bf16 v227, v23, v23
    v_dot2c_f32_bf16 v224, s101, v28
    v_dot2c_f32_bf16 v226, v28, v28
    v_dot2c_f32_bf16 v225, s101, v29
    v_dot2c_f32_bf16 v227, v29, v29
    v_dot2c_f32_bf16 v224, s101, v30
    v_dot2c_f32_bf16 v226, v30, v30
    v_dot2c_f32_bf16 v225, s101, v31
    v_dot2c_f32_bf16 v227, v31, v31
    v_lshlrev_b32 v0, 16, v4
    v_and_b32 v1, s100, v4
    v_lshlrev_b32 v2, 16, v5
    v_and_b32 v3, s100, v5
    v_lshlrev_b32 v4, 16, v6
    v_and_b32 v5, s100, v6
    v_lshlrev_b32 v6, 16, v7
    v_and_b32 v7, s100, v7
    v_lshlrev_b32 v8, 16, v12
    v_and_b32 v9, s100, v12
    v_lshlrev_b32 v10, 16, v13
    v_and_b32 v11, s100, v13
    v_lshlrev_b32 v12, 16, v14
    v_and_b32 v13, s100, v14
    v_lshlrev_b32 v14, 16, v15
    v_and_b32 v15, s100, v15
    v_lshlrev_b32 v16, 16, v20
    v_and_b32 v17, s100, v20
    v_lshlrev_b32 v18, 16, v21
    v_and_b32 v19, s100, v21
    v_lshlrev_b32 v20, 16, v22
    v_and_b32 v21, s100, v22
    v_lshlrev_b32 v22, 16, v23
    v_and_b32 v23, s100, v23
    v_lshlrev_b32 v24, 16, v28
    v_and_b32 v25, s100, v28
    v_lshlrev_b32 v26, 16, v29
    v_and_b32 v27, s100, v29
    v_lshlrev_b32 v28, 16, v30
    v_and_b32 v29, s100, v30
    v_lshlrev_b32 v30, 16, v31
    v_and_b32 v31, s100, v31
    s_mov_b32 s10, 640
    s_add_u32 s10, s10, s11
    s_add_u32 m0, s0, 20480
    s_add_u32 s15, s10, 0
    buffer_load_dwordx4 v250, s[44:47], s15 offen  lds
    s_add_u32 m0, s0, 21504
    s_add_u32 s15, s10, 7168
    buffer_load_dwordx4 v251, s[44:47], s15 offen  lds
    s_add_u32 m0, s0, 22528
    s_add_u32 s15, s10, 14336
    buffer_load_dwordx4 v250, s[44:47], s15 offen  lds
    s_add_u32 m0, s0, 23552
    s_add_u32 s15, s10, 21504
    buffer_load_dwordx4 v251, s[44:47], s15 offen  lds
    s_waitcnt vmcnt(14)
    ds_read_b128 v[68:71], v240 offset:8192
    ds_read_b128 v[76:79], v241 offset:8192
    ds_read_b128 v[84:87], v242 offset:8192
    ds_read_b128 v[92:95], v243 offset:8192
    s_waitcnt lgkmcnt(4)
    v_dot2c_f32_bf16 v224, s101, v36
    v_dot2c_f32_bf16 v226, v36, v36
    v_dot2c_f32_bf16 v225, s101, v37
    v_dot2c_f32_bf16 v227, v37, v37
    v_dot2c_f32_bf16 v224, s101, v38
    v_dot2c_f32_bf16 v226, v38, v38
    v_dot2c_f32_bf16 v225, s101, v39
    v_dot2c_f32_bf16 v227, v39, v39
    v_dot2c_f32_bf16 v224, s101, v44
    v_dot2c_f32_bf16 v226, v44, v44
    v_dot2c_f32_bf16 v225, s101, v45
    v_dot2c_f32_bf16 v227, v45, v45
    v_dot2c_f32_bf16 v224, s101, v46
    v_dot2c_f32_bf16 v226, v46, v46
    v_dot2c_f32_bf16 v225, s101, v47
    v_dot2c_f32_bf16 v227, v47, v47
    v_dot2c_f32_bf16 v224, s101, v52
    v_dot2c_f32_bf16 v226, v52, v52
    v_dot2c_f32_bf16 v225, s101, v53
    v_dot2c_f32_bf16 v227, v53, v53
    v_dot2c_f32_bf16 v224, s101, v54
    v_dot2c_f32_bf16 v226, v54, v54
    v_dot2c_f32_bf16 v225, s101, v55
    v_dot2c_f32_bf16 v227, v55, v55
    v_dot2c_f32_bf16 v224, s101, v60
    v_dot2c_f32_bf16 v226, v60, v60
    v_dot2c_f32_bf16 v225, s101, v61
    v_dot2c_f32_bf16 v227, v61, v61
    v_dot2c_f32_bf16 v224, s101, v62
    v_dot2c_f32_bf16 v226, v62, v62
    v_dot2c_f32_bf16 v225, s101, v63
    v_dot2c_f32_bf16 v227, v63, v63
    v_lshlrev_b32 v32, 16, v36
    v_and_b32 v33, s100, v36
    v_lshlrev_b32 v34, 16, v37
    v_and_b32 v35, s100, v37
    v_lshlrev_b32 v36, 16, v38
    v_and_b32 v37, s100, v38
    v_lshlrev_b32 v38, 16, v39
    v_and_b32 v39, s100, v39
    v_lshlrev_b32 v40, 16, v44
    v_and_b32 v41, s100, v44
    v_lshlrev_b32 v42, 16, v45
    v_and_b32 v43, s100, v45
    v_lshlrev_b32 v44, 16, v46
    v_and_b32 v45, s100, v46
    v_lshlrev_b32 v46, 16, v47
    v_and_b32 v47, s100, v47
    v_lshlrev_b32 v48, 16, v52
    v_and_b32 v49, s100, v52
    v_lshlrev_b32 v50, 16, v53
    v_and_b32 v51, s100, v53
    v_lshlrev_b32 v52, 16, v54
    v_and_b32 v53, s100, v54
    v_lshlrev_b32 v54, 16, v55
    v_and_b32 v55, s100, v55
    v_lshlrev_b32 v56, 16, v60
    v_and_b32 v57, s100, v60
    v_lshlrev_b32 v58, 16, v61
    v_and_b32 v59, s100, v61
    v_lshlrev_b32 v60, 16, v62
    v_and_b32 v61, s100, v62
    v_lshlrev_b32 v62, 16, v63
    v_and_b32 v63, s100, v63
    s_mov_b32 s10, 768
    s_add_u32 s10, s10, s11
    s_add_u32 m0, s0, 24576
    s_add_u32 s15, s10, 0
    buffer_load_dwordx4 v250, s[44:47], s15 offen  lds
    s_add_u32 m0, s0, 25600
    s_add_u32 s15, s10, 7168
    buffer_load_dwordx4 v251, s[44:47], s15 offen  lds
    s_add_u32 m0, s0, 26624
    s_add_u32 s15, s10, 14336
    buffer_load_dwordx4 v250, s[44:47], s15 offen  lds
    s_add_u32 m0, s0, 27648
    s_add_u32 s15, s10, 21504
    buffer_load_dwordx4 v251, s[44:47], s15 offen  lds
    s_waitcnt vmcnt(12)
    ds_read_b128 v[100:103], v240 offset:12288
    ds_read_b128 v[108:111], v241 offset:12288
    ds_read_b128 v[116:119], v242 offset:12288
    ds_read_b128 v[124:127], v243 offset:12288
    s_waitcnt lgkmcnt(4)
    v_dot2c_f32_bf16 v224, s101, v68
    v_dot2c_f32_bf16 v226, v68, v68
    v_dot2c_f32_bf16 v225, s101, v69
    v_dot2c_f32_bf16 v227, v69, v69
    v_dot2c_f32_bf16 v224, s101, v70
    v_dot2c_f32_bf16 v226, v70, v70
    v_dot2c_f32_bf16 v225, s101, v71
    v_dot2c_f32_bf16 v227, v71, v71
    v_dot2c_f32_bf16 v224, s101, v76
    v_dot2c_f32_bf16 v226, v76, v76
    v_dot2c_f32_bf16 v225, s101, v77
    v_dot2c_f32_bf16 v227, v77, v77
    v_dot2c_f32_bf16 v224, s101, v78
    v_dot2c_f32_bf16 v226, v78, v78
    v_dot2c_f32_bf16 v225, s101, v79
    v_dot2c_f32_bf16 v227, v79, v79
    v_dot2c_f32_bf16 v224, s101, v84
    v_dot2c_f32_bf16 v226, v84, v84
    v_dot2c_f32_bf16 v225, s101, v85
    v_dot2c_f32_bf16 v227, v85, v85
    v_dot2c_f32_bf16 v224, s101, v86
    v_dot2c_f32_bf16 v226, v86, v86
    v_dot2c_f32_bf16 v225, s101, v87
    v_dot2c_f32_bf16 v227, v87, v87
    v_dot2c_f32_bf16 v224, s101, v92
    v_dot2c_f32_bf16 v226, v92, v92
    v_dot2c_f32_bf16 v225, s101, v93
    v_dot2c_f32_bf16 v227, v93, v93
    v_dot2c_f32_bf16 v224, s101, v94
    v_dot2c_f32_bf16 v226, v94, v94
    v_dot2c_f32_bf16 v225, s101, v95
    v_dot2c_f32_bf16 v227, v95, v95
    v_lshlrev_b32 v64, 16, v68
    v_and_b32 v65, s100, v68
    v_lshlrev_b32 v66, 16, v69
    v_and_b32 v67, s100, v69
    v_lshlrev_b32 v68, 16, v70
    v_and_b32 v69, s100, v70
    v_lshlrev_b32 v70, 16, v71
    v_and_b32 v71, s100, v71
    v_lshlrev_b32 v72, 16, v76
    v_and_b32 v73, s100, v76
    v_lshlrev_b32 v74, 16, v77
    v_and_b32 v75, s100, v77
    v_lshlrev_b32 v76, 16, v78
    v_and_b32 v77, s100, v78
    v_lshlrev_b32 v78, 16, v79
    v_and_b32 v79, s100, v79
    v_lshlrev_b32 v80, 16, v84
    v_and_b32 v81, s100, v84
    v_lshlrev_b32 v82, 16, v85
    v_and_b32 v83, s100, v85
    v_lshlrev_b32 v84, 16, v86
    v_and_b32 v85, s100, v86
    v_lshlrev_b32 v86, 16, v87
    v_and_b32 v87, s100, v87
    v_lshlrev_b32 v88, 16, v92
    v_and_b32 v89, s100, v92
    v_lshlrev_b32 v90, 16, v93
    v_and_b32 v91, s100, v93
    v_lshlrev_b32 v92, 16, v94
    v_and_b32 v93, s100, v94
    v_lshlrev_b32 v94, 16, v95
    v_and_b32_e64 v95, s100, v95
    s_waitcnt vmcnt(8)
    s_mul_i32 s8, s12, 129024
    s_lshl_b32 s9, s42, 7
    s_add_u32 s8, s8, s9
    s_mul_i32 s9, s12, 48
    s_nop 0
    buffer_load_ushort a132, v228, s[72:75], s9 offen offset:0
    buffer_load_ushort a133, v228, s[72:75], s9 offen offset:16
    buffer_load_ushort a134, v228, s[72:75], s9 offen offset:32
    buffer_load_dwordx4 a[120:123], v230, s[76:79], s8 offen
    s_add_u32 s8, s8, 43008
    buffer_load_dwordx4 a[124:127], v230, s[76:79], s8 offen
    s_add_u32 s8, s8, 43008
    buffer_load_dwordx4 a[128:131], v230, s[76:79], s8 offen
    ds_read_b128 v[132:135], v240 offset:16384
    ds_read_b128 v[140:143], v241 offset:16384
    ds_read_b128 v[148:151], v242 offset:16384
    ds_read_b128 v[156:159], v243 offset:16384
    s_waitcnt lgkmcnt(4)
    v_dot2c_f32_bf16 v224, s101, v100
    v_dot2c_f32_bf16 v226, v100, v100
    v_dot2c_f32_bf16 v225, s101, v101
    v_dot2c_f32_bf16 v227, v101, v101
    v_dot2c_f32_bf16 v224, s101, v102
    v_dot2c_f32_bf16 v226, v102, v102
    v_dot2c_f32_bf16 v225, s101, v103
    v_dot2c_f32_bf16 v227, v103, v103
    v_dot2c_f32_bf16 v224, s101, v108
    v_dot2c_f32_bf16 v226, v108, v108
    v_dot2c_f32_bf16 v225, s101, v109
    v_dot2c_f32_bf16 v227, v109, v109
    v_dot2c_f32_bf16 v224, s101, v110
    v_dot2c_f32_bf16 v226, v110, v110
    v_dot2c_f32_bf16 v225, s101, v111
    v_dot2c_f32_bf16 v227, v111, v111
    v_dot2c_f32_bf16 v224, s101, v116
    v_dot2c_f32_bf16 v226, v116, v116
    v_dot2c_f32_bf16 v225, s101, v117
    v_dot2c_f32_bf16 v227, v117, v117
    v_dot2c_f32_bf16 v224, s101, v118
    v_dot2c_f32_bf16 v226, v118, v118
    v_dot2c_f32_bf16 v225, s101, v119
    v_dot2c_f32_bf16 v227, v119, v119
    v_dot2c_f32_bf16 v224, s101, v124
    v_dot2c_f32_bf16 v226, v124, v124
    v_dot2c_f32_bf16 v225, s101, v125
    v_dot2c_f32_bf16 v227, v125, v125
    v_dot2c_f32_bf16 v224, s101, v126
    v_dot2c_f32_bf16 v226, v126, v126
    v_dot2c_f32_bf16 v225, s101, v127
    v_dot2c_f32_bf16 v227, v127, v127
    v_lshlrev_b32 v96, 16, v100
    v_and_b32 v97, s100, v100
    v_lshlrev_b32 v98, 16, v101
    v_and_b32 v99, s100, v101
    v_lshlrev_b32 v100, 16, v102
    v_and_b32 v101, s100, v102
    v_lshlrev_b32 v102, 16, v103
    v_and_b32 v103, s100, v103
    v_lshlrev_b32 v104, 16, v108
    v_and_b32 v105, s100, v108
    v_lshlrev_b32 v106, 16, v109
    v_and_b32 v107, s100, v109
    v_lshlrev_b32 v108, 16, v110
    v_and_b32 v109, s100, v110
    v_lshlrev_b32 v110, 16, v111
    v_and_b32 v111, s100, v111
    v_lshlrev_b32 v112, 16, v116
    v_and_b32 v113, s100, v116
    v_lshlrev_b32 v114, 16, v117
    v_and_b32 v115, s100, v117
    v_lshlrev_b32 v116, 16, v118
    v_and_b32 v117, s100, v118
    v_lshlrev_b32 v118, 16, v119
    v_and_b32 v119, s100, v119
    v_lshlrev_b32 v120, 16, v124
    v_and_b32 v121, s100, v124
    v_lshlrev_b32 v122, 16, v125
    v_and_b32 v123, s100, v125
    v_lshlrev_b32 v124, 16, v126
    v_and_b32 v125, s100, v126
    v_lshlrev_b32 v126, 16, v127
    v_and_b32 v127, s100, v127
    s_waitcnt vmcnt(10)
    ds_read_b128 v[164:167], v240 offset:20480
    ds_read_b128 v[172:175], v241 offset:20480
    ds_read_b128 v[180:183], v242 offset:20480
    ds_read_b128 v[188:191], v243 offset:20480
    s_lshl_b32 s9, s3, 11
    s_mov_b32 s10, 0
    s_add_u32 s10, s10, s1
    s_nop 0
    s_add_u32 m0, s9, 114688
    s_add_u32 s15, s10, 896
    buffer_load_dwordx4 v252, s[48:51], s15 offen  lds
    s_add_u32 m0, s9, 115712
    s_add_u32 s15, s10, 1792
    buffer_load_dwordx4 v252, s[48:51], s15 offen  lds
    s_mov_b32 s10, 172032
    s_add_u32 s10, s10, s1
    s_nop 0
    s_add_u32 m0, s0, 12288
    s_add_u32 s15, s10, 896
    buffer_load_dwordx4 v252, s[48:51], s15 offen  lds
    s_add_u32 m0, s0, 13312
    s_add_u32 s15, s10, 1792
    buffer_load_dwordx4 v252, s[48:51], s15 offen  lds
    s_waitcnt lgkmcnt(4)
    v_dot2c_f32_bf16 v224, s101, v132
    v_dot2c_f32_bf16 v226, v132, v132
    v_dot2c_f32_bf16 v225, s101, v133
    v_dot2c_f32_bf16 v227, v133, v133
    v_dot2c_f32_bf16 v224, s101, v134
    v_dot2c_f32_bf16 v226, v134, v134
    v_dot2c_f32_bf16 v225, s101, v135
    v_dot2c_f32_bf16 v227, v135, v135
    v_dot2c_f32_bf16 v224, s101, v140
    v_dot2c_f32_bf16 v226, v140, v140
    v_dot2c_f32_bf16 v225, s101, v141
    v_dot2c_f32_bf16 v227, v141, v141
    v_dot2c_f32_bf16 v224, s101, v142
    v_dot2c_f32_bf16 v226, v142, v142
    v_dot2c_f32_bf16 v225, s101, v143
    v_dot2c_f32_bf16 v227, v143, v143
    v_dot2c_f32_bf16 v224, s101, v148
    v_dot2c_f32_bf16 v226, v148, v148
    v_dot2c_f32_bf16 v225, s101, v149
    v_dot2c_f32_bf16 v227, v149, v149
    v_dot2c_f32_bf16 v224, s101, v150
    v_dot2c_f32_bf16 v226, v150, v150
    v_dot2c_f32_bf16 v225, s101, v151
    v_dot2c_f32_bf16 v227, v151, v151
    v_dot2c_f32_bf16 v224, s101, v156
    v_dot2c_f32_bf16 v226, v156, v156
    v_dot2c_f32_bf16 v225, s101, v157
    v_dot2c_f32_bf16 v227, v157, v157
    v_dot2c_f32_bf16 v224, s101, v158
    v_dot2c_f32_bf16 v226, v158, v158
    v_dot2c_f32_bf16 v225, s101, v159
    v_dot2c_f32_bf16 v227, v159, v159
    v_lshlrev_b32 v128, 16, v132
    v_and_b32 v129, s100, v132
    v_lshlrev_b32 v130, 16, v133
    v_and_b32 v131, s100, v133
    v_lshlrev_b32 v132, 16, v134
    v_and_b32 v133, s100, v134
    v_lshlrev_b32 v134, 16, v135
    v_and_b32 v135, s100, v135
    v_lshlrev_b32 v136, 16, v140
    v_and_b32 v137, s100, v140
    v_lshlrev_b32 v138, 16, v141
    v_and_b32 v139, s100, v141
    v_lshlrev_b32 v140, 16, v142
    v_and_b32 v141, s100, v142
    v_lshlrev_b32 v142, 16, v143
    v_and_b32 v143, s100, v143
    v_lshlrev_b32 v144, 16, v148
    v_and_b32 v145, s100, v148
    v_lshlrev_b32 v146, 16, v149
    v_and_b32 v147, s100, v149
    v_lshlrev_b32 v148, 16, v150
    v_and_b32 v149, s100, v150
    v_lshlrev_b32 v150, 16, v151
    v_and_b32 v151, s100, v151
    v_lshlrev_b32 v152, 16, v156
    v_and_b32 v153, s100, v156
    v_lshlrev_b32 v154, 16, v157
    v_and_b32 v155, s100, v157
    v_lshlrev_b32 v156, 16, v158
    v_and_b32 v157, s100, v158
    v_lshlrev_b32 v158, 16, v159
    v_and_b32 v159, s100, v159
    s_waitcnt vmcnt(10)
    ds_read_b128 v[196:199], v240 offset:24576
    ds_read_b128 v[204:207], v241 offset:24576
    ds_read_b128 v[212:215], v242 offset:24576
    ds_read_b128 v[216:219], v243 offset:24576
    s_waitcnt lgkmcnt(4)
    v_dot2c_f32_bf16 v224, s101, v164
    v_dot2c_f32_bf16 v226, v164, v164
    v_dot2c_f32_bf16 v225, s101, v165
    v_dot2c_f32_bf16 v227, v165, v165
    v_dot2c_f32_bf16 v224, s101, v166
    v_dot2c_f32_bf16 v226, v166, v166
    v_dot2c_f32_bf16 v225, s101, v167
    v_dot2c_f32_bf16 v227, v167, v167
    v_dot2c_f32_bf16 v224, s101, v172
    v_dot2c_f32_bf16 v226, v172, v172
    v_dot2c_f32_bf16 v225, s101, v173
    v_dot2c_f32_bf16 v227, v173, v173
    v_dot2c_f32_bf16 v224, s101, v174
    v_dot2c_f32_bf16 v226, v174, v174
    v_dot2c_f32_bf16 v225, s101, v175
    v_dot2c_f32_bf16 v227, v175, v175
    v_dot2c_f32_bf16 v224, s101, v180
    v_dot2c_f32_bf16 v226, v180, v180
    v_dot2c_f32_bf16 v225, s101, v181
    v_dot2c_f32_bf16 v227, v181, v181
    v_dot2c_f32_bf16 v224, s101, v182
    v_dot2c_f32_bf16 v226, v182, v182
    v_dot2c_f32_bf16 v225, s101, v183
    v_dot2c_f32_bf16 v227, v183, v183
    v_dot2c_f32_bf16 v224, s101, v188
    v_dot2c_f32_bf16 v226, v188, v188
    v_dot2c_f32_bf16 v225, s101, v189
    v_dot2c_f32_bf16 v227, v189, v189
    v_dot2c_f32_bf16 v224, s101, v190
    v_dot2c_f32_bf16 v226, v190, v190
    v_dot2c_f32_bf16 v225, s101, v191
    v_dot2c_f32_bf16 v227, v191, v191
    v_lshlrev_b32 v160, 16, v164
    v_and_b32 v161, s100, v164
    v_lshlrev_b32 v162, 16, v165
    v_and_b32 v163, s100, v165
    v_lshlrev_b32 v164, 16, v166
    v_and_b32 v165, s100, v166
    v_lshlrev_b32 v166, 16, v167
    v_and_b32 v167, s100, v167
    v_lshlrev_b32 v168, 16, v172
    v_and_b32 v169, s100, v172
    v_lshlrev_b32 v170, 16, v173
    v_and_b32 v171, s100, v173
    v_lshlrev_b32 v172, 16, v174
    v_and_b32 v173, s100, v174
    v_lshlrev_b32 v174, 16, v175
    v_and_b32 v175, s100, v175
    v_lshlrev_b32 v176, 16, v180
    v_and_b32 v177, s100, v180
    v_lshlrev_b32 v178, 16, v181
    v_and_b32 v179, s100, v181
    v_lshlrev_b32 v180, 16, v182
    v_and_b32 v181, s100, v182
    v_lshlrev_b32 v182, 16, v183
    v_and_b32 v183, s100, v183
    v_lshlrev_b32 v184, 16, v188
    v_and_b32 v185, s100, v188
    v_lshlrev_b32 v186, 16, v189
    v_and_b32 v187, s100, v189
    v_lshlrev_b32 v188, 16, v190
    v_and_b32 v189, s100, v190
    v_lshlrev_b32 v190, 16, v191
    v_and_b32 v191, s100, v191
    s_waitcnt lgkmcnt(0)
    v_dot2c_f32_bf16 v224, s101, v196
    v_dot2c_f32_bf16 v226, v196, v196
    v_dot2c_f32_bf16 v225, s101, v197
    v_dot2c_f32_bf16 v227, v197, v197
    v_dot2c_f32_bf16 v224, s101, v198
    v_dot2c_f32_bf16 v226, v198, v198
    v_dot2c_f32_bf16 v225, s101, v199
    v_dot2c_f32_bf16 v227, v199, v199
    v_dot2c_f32_bf16 v224, s101, v204
    v_dot2c_f32_bf16 v226, v204, v204
    v_dot2c_f32_bf16 v225, s101, v205
    v_dot2c_f32_bf16 v227, v205, v205
    v_dot2c_f32_bf16 v224, s101, v206
    v_dot2c_f32_bf16 v226, v206, v206
    v_dot2c_f32_bf16 v225, s101, v207
    v_dot2c_f32_bf16 v227, v207, v207
    v_dot2c_f32_bf16 v224, s101, v212
    v_dot2c_f32_bf16 v226, v212, v212
    v_dot2c_f32_bf16 v225, s101, v213
    v_dot2c_f32_bf16 v227, v213, v213
    v_dot2c_f32_bf16 v224, s101, v214
    v_dot2c_f32_bf16 v226, v214, v214
    v_dot2c_f32_bf16 v225, s101, v215
    v_dot2c_f32_bf16 v227, v215, v215
    v_dot2c_f32_bf16 v224, s101, v216
    v_dot2c_f32_bf16 v226, v216, v216
    v_dot2c_f32_bf16 v225, s101, v217
    v_dot2c_f32_bf16 v227, v217, v217
    v_dot2c_f32_bf16 v224, s101, v218
    v_dot2c_f32_bf16 v226, v218, v218
    v_dot2c_f32_bf16 v225, s101, v219
    v_dot2c_f32_bf16 v227, v219, v219
    v_lshlrev_b32 v192, 16, v196
    v_and_b32 v193, s100, v196
    v_lshlrev_b32 v194, 16, v197
    v_and_b32 v195, s100, v197
    v_lshlrev_b32 v196, 16, v198
    v_and_b32 v197, s100, v198
    v_lshlrev_b32 v198, 16, v199
    v_and_b32 v199, s100, v199
    v_lshlrev_b32 v200, 16, v204
    v_and_b32 v201, s100, v204
    v_lshlrev_b32 v202, 16, v205
    v_and_b32 v203, s100, v205
    v_lshlrev_b32 v204, 16, v206
    v_and_b32 v205, s100, v206
    v_lshlrev_b32 v206, 16, v207
    v_and_b32 v207, s100, v207
    v_lshlrev_b32 v208, 16, v212
    v_and_b32 v209, s100, v212
    v_lshlrev_b32 v210, 16, v213
    v_and_b32 v211, s100, v213
    v_lshlrev_b32 v212, 16, v214
    v_and_b32 v213, s100, v214
    v_lshlrev_b32 v214, 16, v215
    v_and_b32 v215, s100, v215
    v_add_f32 v224, v224, v225
    v_add_f32 v226, v226, v227
    s_nop 1
    v_permlane32_swap_b32 v224, v226
    v_add_f32 v224, v224, v226
    v_mov_b32 v226, v224
    s_nop 1
    v_permlane32_swap_b32 v224, v226
    v_mul_f32 v224, 0x3b124925, v224
    v_mul_f32 v226, 0x3b124925, v226
    v_fma_f32 v226, -v224, v224, v226
    v_max_f32_e64 v226, 0, v226
    v_cvt_pk_bf16_f32 v225, v224, v226
    v_lshlrev_b32 v224, 16, v225
    v_and_b32 v226, s100, v225
    v_add_f32 v226, 0x3727c5ac, v226
    v_cvt_pk_bf16_f32 v225, v226, v226
    v_and_b32 v226, s100, v225
    v_sqrt_f32_e64 v226, v226
    s_nop 0
    v_cvt_pk_bf16_f32 v225, v226, v226
    v_and_b32 v225, s100, v225
    v_rcp_f32_e64 v226, v225
    s_nop 0
    v_mul_f32_e64 v220, -v224, v226
    v_mov_b32_e64 v221, v226
    v_pk_fma_f32 v[0:1], v[0:1], v[220:221], v[220:221] op_sel:[0,1,0] op_sel_hi:[1,1,0]
    v_pk_fma_f32 v[2:3], v[2:3], v[220:221], v[220:221] op_sel:[0,1,0] op_sel_hi:[1,1,0]
    v_pk_fma_f32 v[4:5], v[4:5], v[220:221], v[220:221] op_sel:[0,1,0] op_sel_hi:[1,1,0]
    v_pk_fma_f32 v[6:7], v[6:7], v[220:221], v[220:221] op_sel:[0,1,0] op_sel_hi:[1,1,0]
    v_pk_fma_f32 v[8:9], v[8:9], v[220:221], v[220:221] op_sel:[0,1,0] op_sel_hi:[1,1,0]
    v_pk_fma_f32 v[10:11], v[10:11], v[220:221], v[220:221] op_sel:[0,1,0] op_sel_hi:[1,1,0]
    v_pk_fma_f32 v[12:13], v[12:13], v[220:221], v[220:221] op_sel:[0,1,0] op_sel_hi:[1,1,0]
    v_pk_fma_f32 v[14:15], v[14:15], v[220:221], v[220:221] op_sel:[0,1,0] op_sel_hi:[1,1,0]
    v_pk_fma_f32 v[16:17], v[16:17], v[220:221], v[220:221] op_sel:[0,1,0] op_sel_hi:[1,1,0]
    v_pk_fma_f32 v[18:19], v[18:19], v[220:221], v[220:221] op_sel:[0,1,0] op_sel_hi:[1,1,0]
    v_pk_fma_f32 v[20:21], v[20:21], v[220:221], v[220:221] op_sel:[0,1,0] op_sel_hi:[1,1,0]
    v_pk_fma_f32 v[22:23], v[22:23], v[220:221], v[220:221] op_sel:[0,1,0] op_sel_hi:[1,1,0]
    v_pk_fma_f32 v[24:25], v[24:25], v[220:221], v[220:221] op_sel:[0,1,0] op_sel_hi:[1,1,0]
    v_pk_fma_f32 v[26:27], v[26:27], v[220:221], v[220:221] op_sel:[0,1,0] op_sel_hi:[1,1,0]
    v_pk_fma_f32 v[28:29], v[28:29], v[220:221], v[220:221] op_sel:[0,1,0] op_sel_hi:[1,1,0]
    v_pk_fma_f32 v[30:31], v[30:31], v[220:221], v[220:221] op_sel:[0,1,0] op_sel_hi:[1,1,0]
    v_pk_fma_f32 v[32:33], v[32:33], v[220:221], v[220:221] op_sel:[0,1,0] op_sel_hi:[1,1,0]
    v_pk_fma_f32 v[34:35], v[34:35], v[220:221], v[220:221] op_sel:[0,1,0] op_sel_hi:[1,1,0]
    v_pk_fma_f32 v[36:37], v[36:37], v[220:221], v[220:221] op_sel:[0,1,0] op_sel_hi:[1,1,0]
    v_pk_fma_f32 v[38:39], v[38:39], v[220:221], v[220:221] op_sel:[0,1,0] op_sel_hi:[1,1,0]
    v_pk_fma_f32 v[40:41], v[40:41], v[220:221], v[220:221] op_sel:[0,1,0] op_sel_hi:[1,1,0]
    v_pk_fma_f32 v[42:43], v[42:43], v[220:221], v[220:221] op_sel:[0,1,0] op_sel_hi:[1,1,0]
    v_pk_fma_f32 v[44:45], v[44:45], v[220:221], v[220:221] op_sel:[0,1,0] op_sel_hi:[1,1,0]
    v_pk_fma_f32 v[46:47], v[46:47], v[220:221], v[220:221] op_sel:[0,1,0] op_sel_hi:[1,1,0]
    v_pk_fma_f32 v[48:49], v[48:49], v[220:221], v[220:221] op_sel:[0,1,0] op_sel_hi:[1,1,0]
    v_pk_fma_f32 v[50:51], v[50:51], v[220:221], v[220:221] op_sel:[0,1,0] op_sel_hi:[1,1,0]
    v_pk_fma_f32 v[52:53], v[52:53], v[220:221], v[220:221] op_sel:[0,1,0] op_sel_hi:[1,1,0]
    v_pk_fma_f32 v[54:55], v[54:55], v[220:221], v[220:221] op_sel:[0,1,0] op_sel_hi:[1,1,0]
    v_pk_fma_f32 v[56:57], v[56:57], v[220:221], v[220:221] op_sel:[0,1,0] op_sel_hi:[1,1,0]
    v_pk_fma_f32 v[58:59], v[58:59], v[220:221], v[220:221] op_sel:[0,1,0] op_sel_hi:[1,1,0]
    v_pk_fma_f32 v[60:61], v[60:61], v[220:221], v[220:221] op_sel:[0,1,0] op_sel_hi:[1,1,0]
    v_pk_fma_f32 v[62:63], v[62:63], v[220:221], v[220:221] op_sel:[0,1,0] op_sel_hi:[1,1,0]
    v_pk_fma_f32 v[64:65], v[64:65], v[220:221], v[220:221] op_sel:[0,1,0] op_sel_hi:[1,1,0]
    v_pk_fma_f32 v[66:67], v[66:67], v[220:221], v[220:221] op_sel:[0,1,0] op_sel_hi:[1,1,0]
    v_pk_fma_f32 v[68:69], v[68:69], v[220:221], v[220:221] op_sel:[0,1,0] op_sel_hi:[1,1,0]
    v_pk_fma_f32 v[70:71], v[70:71], v[220:221], v[220:221] op_sel:[0,1,0] op_sel_hi:[1,1,0]
    v_pk_fma_f32 v[72:73], v[72:73], v[220:221], v[220:221] op_sel:[0,1,0] op_sel_hi:[1,1,0]
    v_pk_fma_f32 v[74:75], v[74:75], v[220:221], v[220:221] op_sel:[0,1,0] op_sel_hi:[1,1,0]
    v_pk_fma_f32 v[76:77], v[76:77], v[220:221], v[220:221] op_sel:[0,1,0] op_sel_hi:[1,1,0]
    v_pk_fma_f32 v[78:79], v[78:79], v[220:221], v[220:221] op_sel:[0,1,0] op_sel_hi:[1,1,0]
    buffer_load_dwordx2 v[224:225], v232, s[84:87], s2 offen sc1
    buffer_load_dwordx2 v[226:227], v232, s[84:87], s2 offen offset:1792 sc1
    s_mov_b32 s10, 344064
    s_add_u32 s10, s10, s1
    s_nop 0
    s_add_u32 m0, s0, 14336
    s_add_u32 s15, s10, 896
    buffer_load_dwordx4 v252, s[48:51], s15 offen  lds
    s_add_u32 m0, s0, 15360
    s_add_u32 s15, s10, 1792
    buffer_load_dwordx4 v252, s[48:51], s15 offen  lds
    s_mov_b32 s10, 516096
    s_add_u32 s10, s10, s1
    s_nop 0
    s_add_u32 m0, s0, 16384
    s_add_u32 s15, s10, 896
    buffer_load_dwordx4 v252, s[48:51], s15 offen  lds
    s_add_u32 m0, s0, 17408
    s_add_u32 s15, s10, 1792
    buffer_load_dwordx4 v252, s[48:51], s15 offen  lds
    v_pk_fma_f32 v[80:81], v[80:81], v[220:221], v[220:221] op_sel:[0,1,0] op_sel_hi:[1,1,0]
    v_pk_fma_f32 v[82:83], v[82:83], v[220:221], v[220:221] op_sel:[0,1,0] op_sel_hi:[1,1,0]
    v_pk_fma_f32 v[84:85], v[84:85], v[220:221], v[220:221] op_sel:[0,1,0] op_sel_hi:[1,1,0]
    v_pk_fma_f32 v[86:87], v[86:87], v[220:221], v[220:221] op_sel:[0,1,0] op_sel_hi:[1,1,0]
    v_pk_fma_f32 v[88:89], v[88:89], v[220:221], v[220:221] op_sel:[0,1,0] op_sel_hi:[1,1,0]
    v_pk_fma_f32 v[90:91], v[90:91], v[220:221], v[220:221] op_sel:[0,1,0] op_sel_hi:[1,1,0]
    v_pk_fma_f32 v[92:93], v[92:93], v[220:221], v[220:221] op_sel:[0,1,0] op_sel_hi:[1,1,0]
    v_pk_fma_f32 v[94:95], v[94:95], v[220:221], v[220:221] op_sel:[0,1,0] op_sel_hi:[1,1,0]
    v_pk_fma_f32 v[96:97], v[96:97], v[220:221], v[220:221] op_sel:[0,1,0] op_sel_hi:[1,1,0]
    v_pk_fma_f32 v[98:99], v[98:99], v[220:221], v[220:221] op_sel:[0,1,0] op_sel_hi:[1,1,0]
    v_pk_fma_f32 v[100:101], v[100:101], v[220:221], v[220:221] op_sel:[0,1,0] op_sel_hi:[1,1,0]
    v_pk_fma_f32 v[102:103], v[102:103], v[220:221], v[220:221] op_sel:[0,1,0] op_sel_hi:[1,1,0]
    v_pk_fma_f32 v[104:105], v[104:105], v[220:221], v[220:221] op_sel:[0,1,0] op_sel_hi:[1,1,0]
    v_pk_fma_f32 v[106:107], v[106:107], v[220:221], v[220:221] op_sel:[0,1,0] op_sel_hi:[1,1,0]
    v_pk_fma_f32 v[108:109], v[108:109], v[220:221], v[220:221] op_sel:[0,1,0] op_sel_hi:[1,1,0]
    v_pk_fma_f32 v[110:111], v[110:111], v[220:221], v[220:221] op_sel:[0,1,0] op_sel_hi:[1,1,0]
    v_pk_fma_f32 v[112:113], v[112:113], v[220:221], v[220:221] op_sel:[0,1,0] op_sel_hi:[1,1,0]
    v_pk_fma_f32 v[114:115], v[114:115], v[220:221], v[220:221] op_sel:[0,1,0] op_sel_hi:[1,1,0]
    v_pk_fma_f32 v[116:117], v[116:117], v[220:221], v[220:221] op_sel:[0,1,0] op_sel_hi:[1,1,0]
    v_pk_fma_f32 v[118:119], v[118:119], v[220:221], v[220:221] op_sel:[0,1,0] op_sel_hi:[1,1,0]
    v_pk_fma_f32 v[120:121], v[120:121], v[220:221], v[220:221] op_sel:[0,1,0] op_sel_hi:[1,1,0]
    v_pk_fma_f32 v[122:123], v[122:123], v[220:221], v[220:221] op_sel:[0,1,0] op_sel_hi:[1,1,0]
    v_pk_fma_f32 v[124:125], v[124:125], v[220:221], v[220:221] op_sel:[0,1,0] op_sel_hi:[1,1,0]
    v_pk_fma_f32 v[126:127], v[126:127], v[220:221], v[220:221] op_sel:[0,1,0] op_sel_hi:[1,1,0]
    v_pk_fma_f32 v[128:129], v[128:129], v[220:221], v[220:221] op_sel:[0,1,0] op_sel_hi:[1,1,0]
    v_pk_fma_f32 v[130:131], v[130:131], v[220:221], v[220:221] op_sel:[0,1,0] op_sel_hi:[1,1,0]
    v_pk_fma_f32 v[132:133], v[132:133], v[220:221], v[220:221] op_sel:[0,1,0] op_sel_hi:[1,1,0]
    v_pk_fma_f32 v[134:135], v[134:135], v[220:221], v[220:221] op_sel:[0,1,0] op_sel_hi:[1,1,0]
    v_pk_fma_f32 v[136:137], v[136:137], v[220:221], v[220:221] op_sel:[0,1,0] op_sel_hi:[1,1,0]
    v_pk_fma_f32 v[138:139], v[138:139], v[220:221], v[220:221] op_sel:[0,1,0] op_sel_hi:[1,1,0]
    v_pk_fma_f32 v[140:141], v[140:141], v[220:221], v[220:221] op_sel:[0,1,0] op_sel_hi:[1,1,0]
    v_pk_fma_f32 v[142:143], v[142:143], v[220:221], v[220:221] op_sel:[0,1,0] op_sel_hi:[1,1,0]
    v_pk_fma_f32 v[144:145], v[144:145], v[220:221], v[220:221] op_sel:[0,1,0] op_sel_hi:[1,1,0]
    v_pk_fma_f32 v[146:147], v[146:147], v[220:221], v[220:221] op_sel:[0,1,0] op_sel_hi:[1,1,0]
    v_pk_fma_f32 v[148:149], v[148:149], v[220:221], v[220:221] op_sel:[0,1,0] op_sel_hi:[1,1,0]
    v_pk_fma_f32 v[150:151], v[150:151], v[220:221], v[220:221] op_sel:[0,1,0] op_sel_hi:[1,1,0]
    v_pk_fma_f32 v[152:153], v[152:153], v[220:221], v[220:221] op_sel:[0,1,0] op_sel_hi:[1,1,0]
    v_pk_fma_f32 v[154:155], v[154:155], v[220:221], v[220:221] op_sel:[0,1,0] op_sel_hi:[1,1,0]
    v_pk_fma_f32 v[156:157], v[156:157], v[220:221], v[220:221] op_sel:[0,1,0] op_sel_hi:[1,1,0]
    v_pk_fma_f32 v[158:159], v[158:159], v[220:221], v[220:221] op_sel:[0,1,0] op_sel_hi:[1,1,0]
    v_pk_fma_f32 v[160:161], v[160:161], v[220:221], v[220:221] op_sel:[0,1,0] op_sel_hi:[1,1,0]
    v_pk_fma_f32 v[162:163], v[162:163], v[220:221], v[220:221] op_sel:[0,1,0] op_sel_hi:[1,1,0]
    v_pk_fma_f32 v[164:165], v[164:165], v[220:221], v[220:221] op_sel:[0,1,0] op_sel_hi:[1,1,0]
    v_pk_fma_f32 v[166:167], v[166:167], v[220:221], v[220:221] op_sel:[0,1,0] op_sel_hi:[1,1,0]
    v_pk_fma_f32 v[168:169], v[168:169], v[220:221], v[220:221] op_sel:[0,1,0] op_sel_hi:[1,1,0]
    v_pk_fma_f32 v[170:171], v[170:171], v[220:221], v[220:221] op_sel:[0,1,0] op_sel_hi:[1,1,0]
    v_pk_fma_f32 v[172:173], v[172:173], v[220:221], v[220:221] op_sel:[0,1,0] op_sel_hi:[1,1,0]
    v_pk_fma_f32 v[174:175], v[174:175], v[220:221], v[220:221] op_sel:[0,1,0] op_sel_hi:[1,1,0]
    v_pk_fma_f32 v[176:177], v[176:177], v[220:221], v[220:221] op_sel:[0,1,0] op_sel_hi:[1,1,0]
    v_pk_fma_f32 v[178:179], v[178:179], v[220:221], v[220:221] op_sel:[0,1,0] op_sel_hi:[1,1,0]
    v_pk_fma_f32 v[180:181], v[180:181], v[220:221], v[220:221] op_sel:[0,1,0] op_sel_hi:[1,1,0]
    v_pk_fma_f32 v[182:183], v[182:183], v[220:221], v[220:221] op_sel:[0,1,0] op_sel_hi:[1,1,0]
    v_pk_fma_f32 v[184:185], v[184:185], v[220:221], v[220:221] op_sel:[0,1,0] op_sel_hi:[1,1,0]
    v_pk_fma_f32 v[186:187], v[186:187], v[220:221], v[220:221] op_sel:[0,1,0] op_sel_hi:[1,1,0]
    v_pk_fma_f32 v[188:189], v[188:189], v[220:221], v[220:221] op_sel:[0,1,0] op_sel_hi:[1,1,0]
    v_pk_fma_f32 v[190:191], v[190:191], v[220:221], v[220:221] op_sel:[0,1,0] op_sel_hi:[1,1,0]
    v_pk_fma_f32 v[192:193], v[192:193], v[220:221], v[220:221] op_sel:[0,1,0] op_sel_hi:[1,1,0]
    v_pk_fma_f32 v[194:195], v[194:195], v[220:221], v[220:221] op_sel:[0,1,0] op_sel_hi:[1,1,0]
    v_pk_fma_f32 v[196:197], v[196:197], v[220:221], v[220:221] op_sel:[0,1,0] op_sel_hi:[1,1,0]
    v_pk_fma_f32 v[198:199], v[198:199], v[220:221], v[220:221] op_sel:[0,1,0] op_sel_hi:[1,1,0]
    v_pk_fma_f32 v[200:201], v[200:201], v[220:221], v[220:221] op_sel:[0,1,0] op_sel_hi:[1,1,0]
    v_pk_fma_f32 v[202:203], v[202:203], v[220:221], v[220:221] op_sel:[0,1,0] op_sel_hi:[1,1,0]
    v_pk_fma_f32 v[204:205], v[204:205], v[220:221], v[220:221] op_sel:[0,1,0] op_sel_hi:[1,1,0]
    v_pk_fma_f32 v[206:207], v[206:207], v[220:221], v[220:221] op_sel:[0,1,0] op_sel_hi:[1,1,0]
    v_pk_fma_f32 v[208:209], v[208:209], v[220:221], v[220:221] op_sel:[0,1,0] op_sel_hi:[1,1,0]
    v_pk_fma_f32 v[210:211], v[210:211], v[220:221], v[220:221] op_sel:[0,1,0] op_sel_hi:[1,1,0]
    v_pk_fma_f32 v[212:213], v[212:213], v[220:221], v[220:221] op_sel:[0,1,0] op_sel_hi:[1,1,0]
    v_pk_fma_f32 v[214:215], v[214:215], v[220:221], v[220:221] op_sel:[0,1,0] op_sel_hi:[1,1,0]
    v_accvgpr_write_b32 a152, v216
    v_accvgpr_write_b32 a153, v217
    v_accvgpr_write_b32 a154, v218
    v_accvgpr_write_b32 a155, v219
    s_waitcnt vmcnt(10)
    s_cmp_ge_u32 s12, 19
    s_cbranch_scc1 L_g1c
    v_mov_b32 v228, 0
    v_mov_b32 v229, 0
    v_mov_b32 v230, 0
    v_mov_b32 v231, 0
    v_mov_b32 v236, 0
    v_mov_b32 v237, 0
    v_mov_b32 v238, 0
    v_mov_b32_e64 v239, 0
    v_accvgpr_read_b32 v247, a132
    v_lshlrev_b32_e64 v247, 16, v247
    v_mul_f32_e64 v250, -v247, s96
    v_exp_f32_e64 v250, v250
    v_accvgpr_read_b32 v248, a133
    v_lshlrev_b32_e64 v248, 16, v248
    v_mul_f32_e64 v251, -v248, s96
    v_exp_f32_e64 v251, v251
    v_accvgpr_read_b32 v249, a134
    v_lshlrev_b32_e64 v249, 16, v249
    v_mul_f32_e64 v235, -v249, s96
    v_exp_f32 v235, v235
    v_add_f32 v250, 1.0, v250
    v_rcp_f32 v250, v250
    v_add_f32 v251, 1.0, v251
    v_rcp_f32 v251, v251
    v_add_f32 v235, 1.0, v235
    v_rcp_f32_e64 v235, v235
    s_mul_i32 s14, s12, 21504
    s_lshl_b32 s9, s42, 9
    s_add_u32 s14, s14, s9
    s_add_u32 s14, s14, 524288
    v_mul_f32_e64 v247, v247, v250
    v_cvt_pk_bf16_f32 v247, v247, v247
    v_and_b32 v250, s100, v247
    v_lshrrev_b32 v247, 16, v247
    v_mul_f32_e64 v248, v248, v251
    v_cvt_pk_bf16_f32 v248, v248, v248
    v_and_b32 v251, s100, v248
    v_lshrrev_b32 v248, 16, v248
    v_mul_f32_e64 v249, v249, v235
    v_cvt_pk_bf16_f32 v249, v249, v249
    v_and_b32 v235, s100, v249
    v_lshrrev_b32 v249, 16, v249
    v_accvgpr_read_b32 v240, a120
    v_accvgpr_read_b32 v241, a121
    v_accvgpr_read_b32 v242, a122
    v_accvgpr_read_b32 v243, a123
    v_dot2c_f32_bf16 v228, v240, v247
    v_dot2c_f32_bf16 v229, v240, v250
    v_dot2c_f32_bf16 v230, v241, v247
    v_dot2c_f32_bf16 v231, v241, v250
    v_dot2c_f32_bf16 v236, v242, v247
    v_dot2c_f32_bf16 v237, v242, v250
    v_dot2c_f32_bf16 v238, v243, v247
    v_dot2c_f32_bf16 v239, v243, v250
    v_accvgpr_read_b32 v240, a124
    v_accvgpr_read_b32 v241, a125
    v_accvgpr_read_b32 v242, a126
    v_accvgpr_read_b32 v243, a127
    v_dot2c_f32_bf16 v228, v240, v248
    v_dot2c_f32_bf16 v229, v240, v251
    v_dot2c_f32_bf16 v230, v241, v248
    v_dot2c_f32_bf16 v231, v241, v251
    v_dot2c_f32_bf16 v236, v242, v248
    v_dot2c_f32_bf16 v237, v242, v251
    v_dot2c_f32_bf16 v238, v243, v248
    v_dot2c_f32_bf16 v239, v243, v251
    v_accvgpr_read_b32 v240, a128
    v_accvgpr_read_b32 v241, a129
    v_accvgpr_read_b32 v242, a130
    v_accvgpr_read_b32 v243, a131
    v_dot2c_f32_bf16 v228, v240, v249
    v_dot2c_f32_bf16 v229, v240, v235
    v_dot2c_f32_bf16 v230, v241, v249
    v_dot2c_f32_bf16 v231, v241, v235
    v_dot2c_f32_bf16 v236, v242, v249
    v_dot2c_f32_bf16 v237, v242, v235
    v_dot2c_f32_bf16 v238, v243, v249
    v_dot2c_f32_bf16 v239, v243, v235
    v_and_b32 v240, 7, v255
    v_lshlrev_b32 v240, 6, v240
    v_lshrrev_b32_e64 v241, 4, v255
    v_lshl_add_u32 v240, v241, 4, v240
    v_permlane32_swap_b32 v228, v236
    v_permlane32_swap_b32 v229, v237
    v_permlane32_swap_b32 v230, v238
    v_permlane32_swap_b32 v231, v239
    v_add_f32 v228, v228, v236
    v_add_f32 v229, v229, v237
    v_add_f32 v230, v230, v238
    v_add_f32 v231, v231, v239
    s_nop 0
    v_permlane16_swap_b32 v228, v230
    v_permlane16_swap_b32 v229, v231
    v_add_f32 v228, v228, v230
    v_add_f32 v230, v229, v231
    v_mov_b32 v229, s88
    v_mov_b32_e64 v231, s88
    v_add_f32_dpp v228, v228, v228 row_ror:8 row_mask:0xf bank_mask:0xf
    v_add_f32_dpp v230, v230, v230 row_ror:8 row_mask:0xf bank_mask:0xf
    s_mov_b32 exec_lo, 0x00ff00ff
    s_mov_b32 exec_hi, 0x00ff00ff
    buffer_store_dwordx4 v[228:231], v240, s[84:87], s14 offen sc1
    s_mov_b64 exec, -1
L_g1c:
    s_cmp_eq_u32 s3, 0
    s_cselect_b32 s12, s43, 999
    s_add_u32 s12, s12, 56
    s_mov_b32 s8, s2
    s_mov_b32 s2, s40
    s_mov_b32 s11, s37
    s_cmp_ge_u32 s3, 2
    s_cselect_b32 s42, 1, 0
    v_mov_b32 v216, v252
    v_mov_b32 v217, v244
    v_mov_b32 v218, v255
    v_mov_b32 v219, v245
    s_waitcnt vmcnt(4)
L_s0:
    v_xor_b32 v225, s88, v225
    v_xor_b32 v227, s88, v227
    v_or_b32 v225, v225, v227
    v_cmp_ne_u32 vcc, 0, v225
    s_add_u32 s95, s95, 1
    s_cmp_gt_u32 s95, 200000
    s_cbranch_scc1 L_s0x
    s_cbranch_vccz L_s0x
    buffer_load_dwordx2 v[224:225], v232, s[84:87], s8 offen sc1
    buffer_load_dwordx2 v[226:227], v232, s[84:87], s8 offen offset:1792 sc1
    s_waitcnt vmcnt(0)
    s_branch L_s0
L_s0x:
    v_and_b32 v225, s100, v224
    v_lshlrev_b32 v224, 16, v224
    v_and_b32 v227, s100, v226
    v_lshlrev_b32 v226, 16, v226
    ds_write_b64 v233, v[224:225]
    ds_write_b64 v233, v[226:227] offset:1792
    s_mov_b32 s10, 688128
    s_add_u32 s10, s10, s1
    s_nop 0
    s_add_u32 m0, s0, 18432
    s_add_u32 s15, s10, 896
    buffer_load_dwordx4 v216, s[48:51], s15 offen  lds
    s_add_u32 m0, s0, 19456
    s_add_u32 s15, s10, 1792
    buffer_load_dwordx4 v216, s[48:51], s15 offen  lds
    s_mov_b32 s10, 860160
    s_add_u32 s10, s10, s1
    s_nop 0
    s_add_u32 m0, s0, 20480
    s_add_u32 s15, s10, 896
    buffer_load_dwordx4 v216, s[48:51], s15 offen  lds
    s_add_u32 m0, s0, 21504
    s_add_u32 s15, s10, 1792
    buffer_load_dwordx4 v216, s[48:51], s15 offen  lds
    s_mov_b32 s10, 1032192
    s_add_u32 s10, s10, s1
    s_nop 0
    s_add_u32 m0, s0, 22528
    s_add_u32 s15, s10, 896
    buffer_load_dwordx4 v216, s[48:51], s15 offen  lds
    s_add_u32 m0, s0, 23552
    s_add_u32 s15, s10, 1792
    buffer_load_dwordx4 v216, s[48:51], s15 offen  lds
    s_lshl_b32 s8, s6, 4
    s_add_u32 s8, s8, s7
    s_mul_i32 s9, s8, 1664
    s_mul_i32 s8, s8, 6272
    s_mov_b64 s[52:53], s[60:61]
    s_cmp_eq_u32 s3, 2
    s_cselect_b64 s[52:53], s[64:65], s[52:53]
    s_cmp_eq_u32 s3, 3
    s_cselect_b64 s[52:53], s[68:69], s[52:53]
    s_mov_b32 s54, 1605632
    s_cmp_eq_u32 s3, 0
    s_cselect_b64 s[52:53], s[56:57], s[52:53]
    s_cselect_b32 s54, 401408, s54
    s_cselect_b32 s8, s9, s8
    s_cselect_b32 s9, 12, 48
    v_min_u32 v240, s9, v255
    v_lshlrev_b32_e64 v240, 7, v240
    buffer_load_dword a200, v240, s[52:55], s8 offen
    v_add_u32 v254, 57344, v223
    v_add_u32 v255, 114688, v223
    s_lshr_b32 s8, s6, 1
    s_and_b32 s9, s6, 1
    s_lshl_b32 s9, s9, 4
    s_add_u32 s9, s9, s7
    s_lshr_b32 s41, s8, 2
    s_lshl_b32 s41, s41, 3
    s_lshr_b32 s10, s9, 2
    s_add_u32 s41, s41, s10
    s_and_b32 s8, s8, 3
    s_lshl_b32 s8, s8, 2
    s_and_b32 s9, s9, 3
    s_add_u32 s40, s8, s9
    s_waitcnt lgkmcnt(0)
    s_barrier
    v_lshrrev_b32_e64 v240, 5, v255
    v_bfe_u32 v241, v255, 4, 1
    v_bfe_u32 v242, v255, 2, 2
    v_and_b32_e64 v243, 3, v255
    ds_read_b128 v[224:227], v222 offset:0
    ds_read_b128 v[228:231], v222 offset:16
    ds_read_b32 v240, v246 offset:1792
    ds_read_b32 v241, v246 offset:1920
    ds_read_b32 v242, v246 offset:2048
    ds_read_b32 v243, v246 offset:2176
    ds_read_b32 v244, v246 offset:2304
    ds_read_b32 v245, v246 offset:2432
    ds_read_b32 v247, v246 offset:2688
    ds_read_b32 v248, v246 offset:2816
    ds_read_b32 v249, v246 offset:2944
    ds_read_b32 v250, v246 offset:3072
    ds_read_b32 v251, v246 offset:3200
    ds_read_b32 v252, v246 offset:3328
    ds_read_b32 v253, v246 offset:3456
    ds_read_b32 v246, v246 offset:2560
    ds_read_b64_tr_b16 a[48:49], v255 offset:0
    ds_read_b64_tr_b16 a[50:51], v255 offset:256
    ds_read_b64_tr_b16 a[52:53], v255 offset:1024
    ds_read_b64_tr_b16 a[54:55], v255 offset:1280
    s_lshl_b32 s10, s3, 10
    s_waitcnt lgkmcnt(4)
    ds_read_b128 v[232:235], v222 offset:64
    ds_read_b128 v[236:239], v222 offset:80
    ds_read_b64_tr_b16 a[56:57], v255 offset:2048
    v_fmac_f32_dpp v224, v240, v0 row_newbcast:0 row_mask:0xf bank_mask:0xf
    v_fmac_f32_dpp v225, v240, v1 row_newbcast:1 row_mask:0xf bank_mask:0xf
    v_fmac_f32_dpp v226, v240, v2 row_newbcast:2 row_mask:0xf bank_mask:0xf
    v_fmac_f32_dpp v227, v240, v3 row_newbcast:3 row_mask:0xf bank_mask:0xf
    v_fmac_f32_dpp v228, v240, v4 row_newbcast:4 row_mask:0xf bank_mask:0xf
    v_fmac_f32_dpp v229, v240, v5 row_newbcast:5 row_mask:0xf bank_mask:0xf
    ds_read_b64_tr_b16 a[58:59], v255 offset:2304
    ds_read_b64_tr_b16 a[60:61], v255 offset:3072
    ds_read_b64_tr_b16 a[62:63], v255 offset:3328
    v_fmac_f32_dpp v230, v240, v6 row_newbcast:6 row_mask:0xf bank_mask:0xf
    v_fmac_f32_dpp v231, v240, v7 row_newbcast:7 row_mask:0xf bank_mask:0xf
    v_cvt_pk_bf16_f32 v0, v224, v225
    v_cvt_pk_bf16_f32 v1, v226, v227
    v_cvt_pk_bf16_f32 v2, v228, v229
    v_cvt_pk_bf16_f32 v3, v230, v231
    s_waitcnt lgkmcnt(4)
    s_nop 0
    v_mfma_f32_32x32x16_bf16 a[0:15], a[48:51], v[0:3], 0
    ds_read_b128 v[224:227], v222 offset:128
    ds_read_b128 v[228:231], v222 offset:144
    ds_read_b64_tr_b16 a[64:65], v255 offset:4096
    v_fmac_f32_dpp v232, v240, v8 row_newbcast:8 row_mask:0xf bank_mask:0xf
    v_fmac_f32_dpp v233, v240, v9 row_newbcast:9 row_mask:0xf bank_mask:0xf
    v_fmac_f32_dpp v234, v240, v10 row_newbcast:10 row_mask:0xf bank_mask:0xf
    v_fmac_f32_dpp v235, v240, v11 row_newbcast:11 row_mask:0xf bank_mask:0xf
    v_fmac_f32_dpp v236, v240, v12 row_newbcast:12 row_mask:0xf bank_mask:0xf
    v_fmac_f32_dpp v237, v240, v13 row_newbcast:13 row_mask:0xf bank_mask:0xf
    v_mfma_f32_32x32x16_bf16 a[16:31], v[0:3], a[52:55], 0
    ds_read_b64_tr_b16 a[66:67], v255 offset:4352
    ds_read_b64_tr_b16 a[68:69], v255 offset:5120
    ds_read_b64_tr_b16 a[70:71], v255 offset:5376
    v_fmac_f32_dpp v238, v240, v14 row_newbcast:14 row_mask:0xf bank_mask:0xf
    v_fmac_f32_dpp v239, v240, v15 row_newbcast:15 row_mask:0xf bank_mask:0xf
    v_cvt_pk_bf16_f32 v4, v232, v233
    v_cvt_pk_bf16_f32 v5, v234, v235
    v_cvt_pk_bf16_f32 v6, v236, v237
    v_cvt_pk_bf16_f32 v7, v238, v239
    s_waitcnt lgkmcnt(4)
    s_nop 0
    v_mfma_f32_32x32x16_bf16 a[0:15], a[56:59], v[4:7], a[0:15]
    ds_read_b128 v[232:235], v222 offset:192
    ds_read_b128 v[236:239], v222 offset:208
    ds_read_b64_tr_b16 a[48:49], v255 offset:6144
    v_fmac_f32_dpp v224, v241, v16 row_newbcast:0 row_mask:0xf bank_mask:0xf
    v_fmac_f32_dpp v225, v241, v17 row_newbcast:1 row_mask:0xf bank_mask:0xf
    v_fmac_f32_dpp v226, v241, v18 row_newbcast:2 row_mask:0xf bank_mask:0xf
    v_fmac_f32_dpp v227, v241, v19 row_newbcast:3 row_mask:0xf bank_mask:0xf
    v_fmac_f32_dpp v228, v241, v20 row_newbcast:4 row_mask:0xf bank_mask:0xf
    v_fmac_f32_dpp v229, v241, v21 row_newbcast:5 row_mask:0xf bank_mask:0xf
    v_mfma_f32_32x32x16_bf16 a[16:31], v[4:7], a[60:63], a[16:31]
    ds_read_b64_tr_b16 a[50:51], v255 offset:6400
    ds_read_b64_tr_b16 a[52:53], v255 offset:7168
    ds_read_b64_tr_b16 a[54:55], v255 offset:7424
    v_fmac_f32_dpp v230, v241, v22 row_newbcast:6 row_mask:0xf bank_mask:0xf
    v_fmac_f32_dpp v231, v241, v23 row_newbcast:7 row_mask:0xf bank_mask:0xf
    v_cvt_pk_bf16_f32 v8, v224, v225
    v_cvt_pk_bf16_f32 v9, v226, v227
    v_cvt_pk_bf16_f32 v10, v228, v229
    v_cvt_pk_bf16_f32 v11, v230, v231
    s_waitcnt lgkmcnt(4)
    s_nop 0
    v_mfma_f32_32x32x16_bf16 a[0:15], a[64:67], v[8:11], a[0:15]
    ds_read_b128 v[224:227], v222 offset:256
    ds_read_b128 v[228:231], v222 offset:272
    ds_read_b64_tr_b16 a[56:57], v223 offset:12288
    v_fmac_f32_dpp v232, v241, v24 row_newbcast:8 row_mask:0xf bank_mask:0xf
    v_fmac_f32_dpp v233, v241, v25 row_newbcast:9 row_mask:0xf bank_mask:0xf
    v_fmac_f32_dpp v234, v241, v26 row_newbcast:10 row_mask:0xf bank_mask:0xf
    v_fmac_f32_dpp v235, v241, v27 row_newbcast:11 row_mask:0xf bank_mask:0xf
    v_fmac_f32_dpp v236, v241, v28 row_newbcast:12 row_mask:0xf bank_mask:0xf
    v_fmac_f32_dpp v237, v241, v29 row_newbcast:13 row_mask:0xf bank_mask:0xf
    v_mfma_f32_32x32x16_bf16 a[16:31], v[8:11], a[68:71], a[16:31]
    ds_read_b64_tr_b16 a[58:59], v223 offset:12544
    ds_read_b64_tr_b16 a[60:61], v223 offset:13312
    ds_read_b64_tr_b16 a[62:63], v223 offset:13568
    v_fmac_f32_dpp v238, v241, v30 row_newbcast:14 row_mask:0xf bank_mask:0xf
    v_fmac_f32_dpp v239, v241, v31 row_newbcast:15 row_mask:0xf bank_mask:0xf
    v_cvt_pk_bf16_f32 v12, v232, v233
    v_cvt_pk_bf16_f32 v13, v234, v235
    v_cvt_pk_bf16_f32 v14, v236, v237
    v_cvt_pk_bf16_f32 v15, v238, v239
    s_waitcnt lgkmcnt(4)
    s_nop 0
    v_mfma_f32_32x32x16_bf16 a[0:15], a[48:51], v[12:15], a[0:15]
    ds_read_b128 v[232:235], v222 offset:320
    ds_read_b128 v[236:239], v222 offset:336
    ds_read_b64_tr_b16 a[64:65], v223 offset:40960
    v_fmac_f32_dpp v224, v242, v32 row_newbcast:0 row_mask:0xf bank_mask:0xf
    v_fmac_f32_dpp v225, v242, v33 row_newbcast:1 row_mask:0xf bank_mask:0xf
    v_fmac_f32_dpp v226, v242, v34 row_newbcast:2 row_mask:0xf bank_mask:0xf
    v_fmac_f32_dpp v227, v242, v35 row_newbcast:3 row_mask:0xf bank_mask:0xf
    v_fmac_f32_dpp v228, v242, v36 row_newbcast:4 row_mask:0xf bank_mask:0xf
    v_fmac_f32_dpp v229, v242, v37 row_newbcast:5 row_mask:0xf bank_mask:0xf
    v_mfma_f32_32x32x16_bf16 a[16:31], v[12:15], a[52:55], a[16:31]
    ds_read_b64_tr_b16 a[66:67], v223 offset:41216
    ds_read_b64_tr_b16 a[68:69], v223 offset:41984
    ds_read_b64_tr_b16 a[70:71], v223 offset:42240
    v_fmac_f32_dpp v230, v242, v38 row_newbcast:6 row_mask:0xf bank_mask:0xf
    v_fmac_f32_dpp v231, v242, v39 row_newbcast:7 row_mask:0xf bank_mask:0xf
    v_cvt_pk_bf16_f32 v16, v224, v225
    v_cvt_pk_bf16_f32 v17, v226, v227
    v_cvt_pk_bf16_f32 v18, v228, v229
    v_cvt_pk_bf16_f32 v19, v230, v231
    s_waitcnt lgkmcnt(4)
    s_nop 0
    v_mfma_f32_32x32x16_bf16 a[0:15], a[56:59], v[16:19], a[0:15]
    ds_read_b128 v[224:227], v222 offset:384
    ds_read_b128 v[228:231], v222 offset:400
    ds_read_b64_tr_b16 a[48:49], v254 offset:12288
    v_fmac_f32_dpp v232, v242, v40 row_newbcast:8 row_mask:0xf bank_mask:0xf
    v_fmac_f32_dpp v233, v242, v41 row_newbcast:9 row_mask:0xf bank_mask:0xf
    v_fmac_f32_dpp v234, v242, v42 row_newbcast:10 row_mask:0xf bank_mask:0xf
    v_fmac_f32_dpp v235, v242, v43 row_newbcast:11 row_mask:0xf bank_mask:0xf
    v_fmac_f32_dpp v236, v242, v44 row_newbcast:12 row_mask:0xf bank_mask:0xf
    v_fmac_f32_dpp v237, v242, v45 row_newbcast:13 row_mask:0xf bank_mask:0xf
    v_mfma_f32_32x32x16_bf16 a[16:31], v[16:19], a[60:63], a[16:31]
    ds_read_b64_tr_b16 a[50:51], v254 offset:12544
    ds_read_b64_tr_b16 a[52:53], v254 offset:13312
    ds_read_b64_tr_b16 a[54:55], v254 offset:13568
    v_fmac_f32_dpp v238, v242, v46 row_newbcast:14 row_mask:0xf bank_mask:0xf
    v_fmac_f32_dpp v239, v242, v47 row_newbcast:15 row_mask:0xf bank_mask:0xf
    v_cvt_pk_bf16_f32 v20, v232, v233
    v_cvt_pk_bf16_f32 v21, v234, v235
    v_cvt_pk_bf16_f32 v22, v236, v237
    v_cvt_pk_bf16_f32 v23, v238, v239
    s_waitcnt lgkmcnt(4)
    s_nop 0
    v_mfma_f32_32x32x16_bf16 a[0:15], a[64:67], v[20:23], a[0:15]
    ds_read_b128 v[232:235], v222 offset:448
    ds_read_b128 v[236:239], v222 offset:464
    ds_read_b64_tr_b16 a[56:57], v254 offset:40960
    v_fmac_f32_dpp v224, v243, v48 row_newbcast:0 row_mask:0xf bank_mask:0xf
    v_fmac_f32_dpp v225, v243, v49 row_newbcast:1 row_mask:0xf bank_mask:0xf
    v_fmac_f32_dpp v226, v243, v50 row_newbcast:2 row_mask:0xf bank_mask:0xf
    v_fmac_f32_dpp v227, v243, v51 row_newbcast:3 row_mask:0xf bank_mask:0xf
    v_fmac_f32_dpp v228, v243, v52 row_newbcast:4 row_mask:0xf bank_mask:0xf
    v_fmac_f32_dpp v229, v243, v53 row_newbcast:5 row_mask:0xf bank_mask:0xf
    v_mfma_f32_32x32x16_bf16 a[16:31], v[20:23], a[68:71], a[16:31]
    ds_read_b64_tr_b16 a[58:59], v254 offset:41216
    ds_read_b64_tr_b16 a[60:61], v254 offset:41984
    ds_read_b64_tr_b16 a[62:63], v254 offset:42240
    v_fmac_f32_dpp v230, v243, v54 row_newbcast:6 row_mask:0xf bank_mask:0xf
    v_fmac_f32_dpp v231, v243, v55 row_newbcast:7 row_mask:0xf bank_mask:0xf
    v_cvt_pk_bf16_f32 v24, v224, v225
    v_cvt_pk_bf16_f32 v25, v226, v227
    v_cvt_pk_bf16_f32 v26, v228, v229
    v_cvt_pk_bf16_f32 v27, v230, v231
    s_waitcnt vmcnt(7)
    s_barrier
    s_waitcnt lgkmcnt(4)
    s_nop 0
    v_mfma_f32_32x32x16_bf16 a[0:15], a[48:51], v[24:27], a[0:15]
    ds_read_b128 v[224:227], v222 offset:512
    ds_read_b128 v[228:231], v222 offset:528
    ds_read_b64_tr_b16 a[64:65], v223 offset:14336
    v_fmac_f32_dpp v232, v243, v56 row_newbcast:8 row_mask:0xf bank_mask:0xf
    v_fmac_f32_dpp v233, v243, v57 row_newbcast:9 row_mask:0xf bank_mask:0xf
    v_fmac_f32_dpp v234, v243, v58 row_newbcast:10 row_mask:0xf bank_mask:0xf
    v_fmac_f32_dpp v235, v243, v59 row_newbcast:11 row_mask:0xf bank_mask:0xf
    v_fmac_f32_dpp v236, v243, v60 row_newbcast:12 row_mask:0xf bank_mask:0xf
    v_fmac_f32_dpp v237, v243, v61 row_newbcast:13 row_mask:0xf bank_mask:0xf
    v_mfma_f32_32x32x16_bf16 a[16:31], v[24:27], a[52:55], a[16:31]
    ds_read_b64_tr_b16 a[66:67], v223 offset:14592
    ds_read_b64_tr_b16 a[68:69], v223 offset:15360
    ds_read_b64_tr_b16 a[70:71], v223 offset:15616
    v_fmac_f32_dpp v238, v243, v62 row_newbcast:14 row_mask:0xf bank_mask:0xf
    v_fmac_f32_dpp v239, v243, v63 row_newbcast:15 row_mask:0xf bank_mask:0xf
    v_cvt_pk_bf16_f32 v28, v232, v233
    v_cvt_pk_bf16_f32 v29, v234, v235
    v_cvt_pk_bf16_f32 v30, v236, v237
    v_cvt_pk_bf16_f32 v31, v238, v239
    s_waitcnt lgkmcnt(4)
    s_nop 0
    v_mfma_f32_32x32x16_bf16 a[0:15], a[56:59], v[28:31], a[0:15]
    ds_read_b128 v[232:235], v222 offset:576
    ds_read_b128 v[236:239], v222 offset:592
    ds_read_b64_tr_b16 a[48:49], v223 offset:43008
    v_fmac_f32_dpp v224, v244, v64 row_newbcast:0 row_mask:0xf bank_mask:0xf
    v_fmac_f32_dpp v225, v244, v65 row_newbcast:1 row_mask:0xf bank_mask:0xf
    v_fmac_f32_dpp v226, v244, v66 row_newbcast:2 row_mask:0xf bank_mask:0xf
    v_fmac_f32_dpp v227, v244, v67 row_newbcast:3 row_mask:0xf bank_mask:0xf
    v_fmac_f32_dpp v228, v244, v68 row_newbcast:4 row_mask:0xf bank_mask:0xf
    v_fmac_f32_dpp v229, v244, v69 row_newbcast:5 row_mask:0xf bank_mask:0xf
    v_mfma_f32_32x32x16_bf16 a[16:31], v[28:31], a[60:63], a[16:31]
    ds_read_b64_tr_b16 a[50:51], v223 offset:43264
    ds_read_b64_tr_b16 a[52:53], v223 offset:44032
    ds_read_b64_tr_b16 a[54:55], v223 offset:44288
    v_fmac_f32_dpp v230, v244, v70 row_newbcast:6 row_mask:0xf bank_mask:0xf
    v_fmac_f32_dpp v231, v244, v71 row_newbcast:7 row_mask:0xf bank_mask:0xf
    v_cvt_pk_bf16_f32 v32, v224, v225
    v_cvt_pk_bf16_f32 v33, v226, v227
    v_cvt_pk_bf16_f32 v34, v228, v229
    v_cvt_pk_bf16_f32 v35, v230, v231
    s_waitcnt lgkmcnt(4)
    s_nop 0
    v_mfma_f32_32x32x16_bf16 a[0:15], a[64:67], v[32:35], a[0:15]
    ds_read_b128 v[224:227], v222 offset:640
    ds_read_b128 v[228:231], v222 offset:656
    ds_read_b64_tr_b16 a[56:57], v254 offset:14336
    v_fmac_f32_dpp v232, v244, v72 row_newbcast:8 row_mask:0xf bank_mask:0xf
    v_fmac_f32_dpp v233, v244, v73 row_newbcast:9 row_mask:0xf bank_mask:0xf
    v_fmac_f32_dpp v234, v244, v74 row_newbcast:10 row_mask:0xf bank_mask:0xf
    v_fmac_f32_dpp v235, v244, v75 row_newbcast:11 row_mask:0xf bank_mask:0xf
    v_fmac_f32_dpp v236, v244, v76 row_newbcast:12 row_mask:0xf bank_mask:0xf
    v_fmac_f32_dpp v237, v244, v77 row_newbcast:13 row_mask:0xf bank_mask:0xf
    v_mfma_f32_32x32x16_bf16 a[16:31], v[32:35], a[68:71], a[16:31]
    ds_read_b64_tr_b16 a[58:59], v254 offset:14592
    ds_read_b64_tr_b16 a[60:61], v254 offset:15360
    ds_read_b64_tr_b16 a[62:63], v254 offset:15616
    s_mov_b32 s14, 0
    s_add_u32 s14, s14, s1
    s_add_u32 m0, s10, 122880
    s_add_u32 s15, s14, 0
    s_nop 0
    buffer_load_dwordx4 v216, s[48:51], s15 offen  lds
    v_fmac_f32_dpp v238, v244, v78 row_newbcast:14 row_mask:0xf bank_mask:0xf
    v_fmac_f32_dpp v239, v244, v79 row_newbcast:15 row_mask:0xf bank_mask:0xf
    v_cvt_pk_bf16_f32 v36, v232, v233
    v_cvt_pk_bf16_f32 v37, v234, v235
    v_cvt_pk_bf16_f32 v38, v236, v237
    v_cvt_pk_bf16_f32 v39, v238, v239
    s_waitcnt lgkmcnt(4)
    s_nop 0
    v_mfma_f32_32x32x16_bf16 a[0:15], a[48:51], v[36:39], a[0:15]
    ds_read_b128 v[232:235], v222 offset:704
    ds_read_b128 v[236:239], v222 offset:720
    ds_read_b64_tr_b16 a[64:65], v254 offset:43008
    v_fmac_f32_dpp v224, v245, v80 row_newbcast:0 row_mask:0xf bank_mask:0xf
    v_fmac_f32_dpp v225, v245, v81 row_newbcast:1 row_mask:0xf bank_mask:0xf
    v_fmac_f32_dpp v226, v245, v82 row_newbcast:2 row_mask:0xf bank_mask:0xf
    v_fmac_f32_dpp v227, v245, v83 row_newbcast:3 row_mask:0xf bank_mask:0xf
    v_fmac_f32_dpp v228, v245, v84 row_newbcast:4 row_mask:0xf bank_mask:0xf
    v_fmac_f32_dpp v229, v245, v85 row_newbcast:5 row_mask:0xf bank_mask:0xf
    v_mfma_f32_32x32x16_bf16 a[16:31], v[36:39], a[52:55], a[16:31]
    ds_read_b64_tr_b16 a[66:67], v254 offset:43264
    ds_read_b64_tr_b16 a[68:69], v254 offset:44032
    ds_read_b64_tr_b16 a[70:71], v254 offset:44288
    v_fmac_f32_dpp v230, v245, v86 row_newbcast:6 row_mask:0xf bank_mask:0xf
    v_fmac_f32_dpp v231, v245, v87 row_newbcast:7 row_mask:0xf bank_mask:0xf
    v_cvt_pk_bf16_f32 v40, v224, v225
    v_cvt_pk_bf16_f32 v41, v226, v227
    v_cvt_pk_bf16_f32 v42, v228, v229
    v_cvt_pk_bf16_f32 v43, v230, v231
    s_waitcnt lgkmcnt(4)
    s_nop 0
    v_mfma_f32_32x32x16_bf16 a[0:15], a[56:59], v[40:43], a[0:15]
    ds_read_b128 v[224:227], v222 offset:768
    ds_read_b128 v[228:231], v222 offset:784
    ds_read_b64_tr_b16 a[48:49], v223 offset:16384
    v_fmac_f32_dpp v232, v245, v88 row_newbcast:8 row_mask:0xf bank_mask:0xf
    v_fmac_f32_dpp v233, v245, v89 row_newbcast:9 row_mask:0xf bank_mask:0xf
    v_fmac_f32_dpp v234, v245, v90 row_newbcast:10 row_mask:0xf bank_mask:0xf
    v_fmac_f32_dpp v235, v245, v91 row_newbcast:11 row_mask:0xf bank_mask:0xf
    v_fmac_f32_dpp v236, v245, v92 row_newbcast:12 row_mask:0xf bank_mask:0xf
    v_fmac_f32_dpp v237, v245, v93 row_newbcast:13 row_mask:0xf bank_mask:0xf
    v_mfma_f32_32x32x16_bf16 a[16:31], v[40:43], a[60:63], a[16:31]
    ds_read_b64_tr_b16 a[50:51], v223 offset:16640
    ds_read_b64_tr_b16 a[52:53], v223 offset:17408
    ds_read_b64_tr_b16 a[54:55], v223 offset:17664
    s_mov_b32 s14, 172032
    s_add_u32 s14, s14, s1
    s_add_u32 m0, s10, 126976
    s_add_u32 s15, s14, 0
    buffer_load_dwordx4 v216, s[48:51], s15 offen  lds
    v_fmac_f32_dpp v238, v245, v94 row_newbcast:14 row_mask:0xf bank_mask:0xf
    v_fmac_f32_dpp v239, v245, v95 row_newbcast:15 row_mask:0xf bank_mask:0xf
    v_cvt_pk_bf16_f32 v44, v232, v233
    v_cvt_pk_bf16_f32 v45, v234, v235
    v_cvt_pk_bf16_f32 v46, v236, v237
    v_cvt_pk_bf16_f32 v47, v238, v239
    s_waitcnt lgkmcnt(4)
    s_nop 0
    v_mfma_f32_32x32x16_bf16 a[0:15], a[64:67], v[44:47], a[0:15]
    ds_read_b128 v[232:235], v222 offset:832
    ds_read_b128 v[236:239], v222 offset:848
    ds_read_b64_tr_b16 a[56:57], v223 offset:45056
    v_fmac_f32_dpp v224, v246, v96 row_newbcast:0 row_mask:0xf bank_mask:0xf
    v_fmac_f32_dpp v225, v246, v97 row_newbcast:1 row_mask:0xf bank_mask:0xf
    v_fmac_f32_dpp v226, v246, v98 row_newbcast:2 row_mask:0xf bank_mask:0xf
    v_fmac_f32_dpp v227, v246, v99 row_newbcast:3 row_mask:0xf bank_mask:0xf
    v_fmac_f32_dpp v228, v246, v100 row_newbcast:4 row_mask:0xf bank_mask:0xf
    v_fmac_f32_dpp v229, v246, v101 row_newbcast:5 row_mask:0xf bank_mask:0xf
    v_mfma_f32_32x32x16_bf16 a[16:31], v[44:47], a[68:71], a[16:31]
    ds_read_b64_tr_b16 a[58:59], v223 offset:45312
    ds_read_b64_tr_b16 a[60:61], v223 offset:46080
    ds_read_b64_tr_b16 a[62:63], v223 offset:46336
    v_fmac_f32_dpp v230, v246, v102 row_newbcast:6 row_mask:0xf bank_mask:0xf
    v_fmac_f32_dpp v231, v246, v103 row_newbcast:7 row_mask:0xf bank_mask:0xf
    v_cvt_pk_bf16_f32 v48, v224, v225
    v_cvt_pk_bf16_f32 v49, v226, v227
    v_cvt_pk_bf16_f32 v50, v228, v229
    v_cvt_pk_bf16_f32 v51, v230, v231
    s_waitcnt lgkmcnt(4)
    s_nop 0
    v_mfma_f32_32x32x16_bf16 a[0:15], a[48:51], v[48:51], a[0:15]
    ds_read_b128 v[224:227], v222 offset:896
    ds_read_b128 v[228:231], v222 offset:912
    ds_read_b64_tr_b16 a[64:65], v254 offset:16384
    v_fmac_f32_dpp v232, v246, v104 row_newbcast:8 row_mask:0xf bank_mask:0xf
    v_fmac_f32_dpp v233, v246, v105 row_newbcast:9 row_mask:0xf bank_mask:0xf
    v_fmac_f32_dpp v234, v246, v106 row_newbcast:10 row_mask:0xf bank_mask:0xf
    v_fmac_f32_dpp v235, v246, v107 row_newbcast:11 row_mask:0xf bank_mask:0xf
    v_fmac_f32_dpp v236, v246, v108 row_newbcast:12 row_mask:0xf bank_mask:0xf
    v_fmac_f32_dpp v237, v246, v109 row_newbcast:13 row_mask:0xf bank_mask:0xf
    v_mfma_f32_32x32x16_bf16 a[16:31], v[48:51], a[52:55], a[16:31]
    ds_read_b64_tr_b16 a[66:67], v254 offset:16640
    ds_read_b64_tr_b16 a[68:69], v254 offset:17408
    ds_read_b64_tr_b16 a[70:71], v254 offset:17664
    s_mov_b32 s14, 344064
    s_add_u32 s14, s14, s1
    s_add_u32 m0, s10, 131072
    s_add_u32 s15, s14, 0
    buffer_load_dwordx4 v216, s[48:51], s15 offen  lds
    v_fmac_f32_dpp v238, v246, v110 row_newbcast:14 row_mask:0xf bank_mask:0xf
    v_fmac_f32_dpp v239, v246, v111 row_newbcast:15 row_mask:0xf bank_mask:0xf
    v_cvt_pk_bf16_f32 v52, v232, v233
    v_cvt_pk_bf16_f32 v53, v234, v235
    v_cvt_pk_bf16_f32 v54, v236, v237
    v_cvt_pk_bf16_f32 v55, v238, v239
    s_waitcnt lgkmcnt(4)
    s_nop 0
    v_mfma_f32_32x32x16_bf16 a[0:15], a[56:59], v[52:55], a[0:15]
    ds_read_b128 v[232:235], v222 offset:960
    ds_read_b128 v[236:239], v222 offset:976
    ds_read_b64_tr_b16 a[48:49], v254 offset:45056
    v_fmac_f32_dpp v224, v247, v112 row_newbcast:0 row_mask:0xf bank_mask:0xf
    v_fmac_f32_dpp v225, v247, v113 row_newbcast:1 row_mask:0xf bank_mask:0xf
    v_fmac_f32_dpp v226, v247, v114 row_newbcast:2 row_mask:0xf bank_mask:0xf
    v_fmac_f32_dpp v227, v247, v115 row_newbcast:3 row_mask:0xf bank_mask:0xf
    v_fmac_f32_dpp v228, v247, v116 row_newbcast:4 row_mask:0xf bank_mask:0xf
    v_fmac_f32_dpp v229, v247, v117 row_newbcast:5 row_mask:0xf bank_mask:0xf
    v_mfma_f32_32x32x16_bf16 a[16:31], v[52:55], a[60:63], a[16:31]
    ds_read_b64_tr_b16 a[50:51], v254 offset:45312
    ds_read_b64_tr_b16 a[52:53], v254 offset:46080
    ds_read_b64_tr_b16 a[54:55], v254 offset:46336
    v_fmac_f32_dpp v230, v247, v118 row_newbcast:6 row_mask:0xf bank_mask:0xf
    v_fmac_f32_dpp v231, v247, v119 row_newbcast:7 row_mask:0xf bank_mask:0xf
    v_cvt_pk_bf16_f32 v56, v224, v225
    v_cvt_pk_bf16_f32 v57, v226, v227
    v_cvt_pk_bf16_f32 v58, v228, v229
    v_cvt_pk_bf16_f32 v59, v230, v231
    s_waitcnt vmcnt(4)
    s_barrier
    s_waitcnt lgkmcnt(4)
    s_nop 0
    v_mfma_f32_32x32x16_bf16 a[0:15], a[64:67], v[56:59], a[0:15]
    ds_read_b128 v[224:227], v222 offset:1024
    ds_read_b128 v[228:231], v222 offset:1040
    ds_read_b64_tr_b16 a[56:57], v223 offset:18432
    v_fmac_f32_dpp v232, v247, v120 row_newbcast:8 row_mask:0xf bank_mask:0xf
    v_fmac_f32_dpp v233, v247, v121 row_newbcast:9 row_mask:0xf bank_mask:0xf
    v_fmac_f32_dpp v234, v247, v122 row_newbcast:10 row_mask:0xf bank_mask:0xf
    v_fmac_f32_dpp v235, v247, v123 row_newbcast:11 row_mask:0xf bank_mask:0xf
    v_fmac_f32_dpp v236, v247, v124 row_newbcast:12 row_mask:0xf bank_mask:0xf
    v_fmac_f32_dpp v237, v247, v125 row_newbcast:13 row_mask:0xf bank_mask:0xf
    v_mfma_f32_32x32x16_bf16 a[16:31], v[56:59], a[68:71], a[16:31]
    ds_read_b64_tr_b16 a[58:59], v223 offset:18688
    ds_read_b64_tr_b16 a[60:61], v223 offset:19456
    ds_read_b64_tr_b16 a[62:63], v223 offset:19712
    s_mov_b32 s14, 516096
    s_add_u32 s14, s14, s1
    s_add_u32 m0, s10, 135168
    s_add_u32 s15, s14, 0
    buffer_load_dwordx4 v216, s[48:51], s15 offen  lds
    v_fmac_f32_dpp v238, v247, v126 row_newbcast:14 row_mask:0xf bank_mask:0xf
    v_fmac_f32_dpp v239, v247, v127 row_newbcast:15 row_mask:0xf bank_mask:0xf
    v_cvt_pk_bf16_f32 v60, v232, v233
    v_cvt_pk_bf16_f32 v61, v234, v235
    v_cvt_pk_bf16_f32 v62, v236, v237
    v_cvt_pk_bf16_f32 v63, v238, v239
    s_waitcnt lgkmcnt(4)
    s_nop 0
    v_mfma_f32_32x32x16_bf16 a[0:15], a[48:51], v[60:63], a[0:15]
    ds_read_b128 v[232:235], v222 offset:1088
    ds_read_b128 v[236:239], v222 offset:1104
    ds_read_b64_tr_b16 a[64:65], v223 offset:47104
    v_fmac_f32_dpp v224, v248, v128 row_newbcast:0 row_mask:0xf bank_mask:0xf
    v_fmac_f32_dpp v225, v248, v129 row_newbcast:1 row_mask:0xf bank_mask:0xf
    v_fmac_f32_dpp v226, v248, v130 row_newbcast:2 row_mask:0xf bank_mask:0xf
    v_fmac_f32_dpp v227, v248, v131 row_newbcast:3 row_mask:0xf bank_mask:0xf
    v_fmac_f32_dpp v228, v248, v132 row_newbcast:4 row_mask:0xf bank_mask:0xf
    v_fmac_f32_dpp v229, v248, v133 row_newbcast:5 row_mask:0xf bank_mask:0xf
    v_mfma_f32_32x32x16_bf16 a[16:31], v[60:63], a[52:55], a[16:31]
    ds_read_b64_tr_b16 a[66:67], v223 offset:47360
    ds_read_b64_tr_b16 a[68:69], v223 offset:48128
    ds_read_b64_tr_b16 a[70:71], v223 offset:48384
    v_fmac_f32_dpp v230, v248, v134 row_newbcast:6 row_mask:0xf bank_mask:0xf
    v_fmac_f32_dpp v231, v248, v135 row_newbcast:7 row_mask:0xf bank_mask:0xf
    v_cvt_pk_bf16_f32 v64, v224, v225
    v_cvt_pk_bf16_f32 v65, v226, v227
    v_cvt_pk_bf16_f32 v66, v228, v229
    v_cvt_pk_bf16_f32 v67, v230, v231
    s_waitcnt lgkmcnt(4)
    s_nop 0
    v_mfma_f32_32x32x16_bf16 a[0:15], a[56:59], v[64:67], a[0:15]
    ds_read_b128 v[224:227], v222 offset:1152
    ds_read_b128 v[228:231], v222 offset:1168
    ds_read_b64_tr_b16 a[48:49], v254 offset:18432
    v_fmac_f32_dpp v232, v248, v136 row_newbcast:8 row_mask:0xf bank_mask:0xf
    v_fmac_f32_dpp v233, v248, v137 row_newbcast:9 row_mask:0xf bank_mask:0xf
    v_fmac_f32_dpp v234, v248, v138 row_newbcast:10 row_mask:0xf bank_mask:0xf
    v_fmac_f32_dpp v235, v248, v139 row_newbcast:11 row_mask:0xf bank_mask:0xf
    v_fmac_f32_dpp v236, v248, v140 row_newbcast:12 row_mask:0xf bank_mask:0xf
    v_fmac_f32_dpp v237, v248, v141 row_newbcast:13 row_mask:0xf bank_mask:0xf
    v_mfma_f32_32x32x16_bf16 a[16:31], v[64:67], a[60:63], a[16:31]
    ds_read_b64_tr_b16 a[50:51], v254 offset:18688
    ds_read_b64_tr_b16 a[52:53], v254 offset:19456
    ds_read_b64_tr_b16 a[54:55], v254 offset:19712
    s_mov_b32 s14, 688128
    s_add_u32 s14, s14, s1
    s_add_u32 m0, s10, 139264
    s_add_u32 s15, s14, 0
    buffer_load_dwordx4 v216, s[48:51], s15 offen  lds
    v_fmac_f32_dpp v238, v248, v142 row_newbcast:14 row_mask:0xf bank_mask:0xf
    v_fmac_f32_dpp v239, v248, v143 row_newbcast:15 row_mask:0xf bank_mask:0xf
    v_cvt_pk_bf16_f32 v68, v232, v233
    v_cvt_pk_bf16_f32 v69, v234, v235
    v_cvt_pk_bf16_f32 v70, v236, v237
    v_cvt_pk_bf16_f32 v71, v238, v239
    s_waitcnt lgkmcnt(4)
    s_nop 0
    v_mfma_f32_32x32x16_bf16 a[0:15], a[64:67], v[68:71], a[0:15]
    ds_read_b128 v[232:235], v222 offset:1216
    ds_read_b128 v[236:239], v222 offset:1232
    ds_read_b64_tr_b16 a[56:57], v254 offset:47104
    v_fmac_f32_dpp v224, v249, v144 row_newbcast:0 row_mask:0xf bank_mask:0xf
    v_fmac_f32_dpp v225, v249, v145 row_newbcast:1 row_mask:0xf bank_mask:0xf
    v_fmac_f32_dpp v226, v249, v146 row_newbcast:2 row_mask:0xf bank_mask:0xf
    v_fmac_f32_dpp v227, v249, v147 row_newbcast:3 row_mask:0xf bank_mask:0xf
    v_fmac_f32_dpp v228, v249, v148 row_newbcast:4 row_mask:0xf bank_mask:0xf
    v_fmac_f32_dpp v229, v249, v149 row_newbcast:5 row_mask:0xf bank_mask:0xf
    v_mfma_f32_32x32x16_bf16 a[16:31], v[68:71], a[68:71], a[16:31]
    ds_read_b64_tr_b16 a[58:59], v254 offset:47360
    ds_read_b64_tr_b16 a[60:61], v254 offset:48128
    ds_read_b64_tr_b16 a[62:63], v254 offset:48384
    v_fmac_f32_dpp v230, v249, v150 row_newbcast:6 row_mask:0xf bank_mask:0xf
    v_fmac_f32_dpp v231, v249, v151 row_newbcast:7 row_mask:0xf bank_mask:0xf
    v_cvt_pk_bf16_f32 v72, v224, v225
    v_cvt_pk_bf16_f32 v73, v226, v227
    v_cvt_pk_bf16_f32 v74, v228, v229
    v_cvt_pk_bf16_f32 v75, v230, v231
    s_waitcnt lgkmcnt(4)
    s_nop 0
    v_mfma_f32_32x32x16_bf16 a[0:15], a[48:51], v[72:75], a[0:15]
    ds_read_b128 v[224:227], v222 offset:1280
    ds_read_b128 v[228:231], v222 offset:1296
    ds_read_b64_tr_b16 a[64:65], v223 offset:20480
    v_fmac_f32_dpp v232, v249, v152 row_newbcast:8 row_mask:0xf bank_mask:0xf
    v_fmac_f32_dpp v233, v249, v153 row_newbcast:9 row_mask:0xf bank_mask:0xf
    v_fmac_f32_dpp v234, v249, v154 row_newbcast:10 row_mask:0xf bank_mask:0xf
    v_fmac_f32_dpp v235, v249, v155 row_newbcast:11 row_mask:0xf bank_mask:0xf
    v_fmac_f32_dpp v236, v249, v156 row_newbcast:12 row_mask:0xf bank_mask:0xf
    v_fmac_f32_dpp v237, v249, v157 row_newbcast:13 row_mask:0xf bank_mask:0xf
    v_mfma_f32_32x32x16_bf16 a[16:31], v[72:75], a[52:55], a[16:31]
    ds_read_b64_tr_b16 a[66:67], v223 offset:20736
    ds_read_b64_tr_b16 a[68:69], v223 offset:21504
    ds_read_b64_tr_b16 a[70:71], v223 offset:21760
    s_mov_b32 s14, 860160
    s_add_u32 s14, s14, s1
    s_add_u32 m0, s10, 143360
    s_add_u32 s15, s14, 0
    buffer_load_dwordx4 v216, s[48:51], s15 offen  lds
    v_fmac_f32_dpp v238, v249, v158 row_newbcast:14 row_mask:0xf bank_mask:0xf
    v_fmac_f32_dpp v239, v249, v159 row_newbcast:15 row_mask:0xf bank_mask:0xf
    v_cvt_pk_bf16_f32 v76, v232, v233
    v_cvt_pk_bf16_f32 v77, v234, v235
    v_cvt_pk_bf16_f32 v78, v236, v237
    v_cvt_pk_bf16_f32 v79, v238, v239
    s_waitcnt lgkmcnt(4)
    s_nop 0
    v_mfma_f32_32x32x16_bf16 a[0:15], a[56:59], v[76:79], a[0:15]
    ds_read_b128 v[232:235], v222 offset:1344
    ds_read_b128 v[236:239], v222 offset:1360
    ds_read_b64_tr_b16 a[48:49], v223 offset:49152
    v_fmac_f32_dpp v224, v250, v160 row_newbcast:0 row_mask:0xf bank_mask:0xf
    v_fmac_f32_dpp v225, v250, v161 row_newbcast:1 row_mask:0xf bank_mask:0xf
    v_fmac_f32_dpp v226, v250, v162 row_newbcast:2 row_mask:0xf bank_mask:0xf
    v_fmac_f32_dpp v227, v250, v163 row_newbcast:3 row_mask:0xf bank_mask:0xf
    v_fmac_f32_dpp v228, v250, v164 row_newbcast:4 row_mask:0xf bank_mask:0xf
    v_fmac_f32_dpp v229, v250, v165 row_newbcast:5 row_mask:0xf bank_mask:0xf
    v_mfma_f32_32x32x16_bf16 a[16:31], v[76:79], a[60:63], a[16:31]
    ds_read_b64_tr_b16 a[50:51], v223 offset:49408
    ds_read_b64_tr_b16 a[52:53], v223 offset:50176
    ds_read_b64_tr_b16 a[54:55], v223 offset:50432
    v_fmac_f32_dpp v230, v250, v166 row_newbcast:6 row_mask:0xf bank_mask:0xf
    v_fmac_f32_dpp v231, v250, v167 row_newbcast:7 row_mask:0xf bank_mask:0xf
    v_cvt_pk_bf16_f32 v80, v224, v225
    v_cvt_pk_bf16_f32 v81, v226, v227
    v_cvt_pk_bf16_f32 v82, v228, v229
    v_cvt_pk_bf16_f32 v83, v230, v231
    s_waitcnt lgkmcnt(4)
    s_nop 0
    v_mfma_f32_32x32x16_bf16 a[0:15], a[64:67], v[80:83], a[0:15]
    ds_read_b128 v[224:227], v222 offset:1408
    ds_read_b128 v[228:231], v222 offset:1424
    ds_read_b64_tr_b16 a[56:57], v254 offset:20480
    v_fmac_f32_dpp v232, v250, v168 row_newbcast:8 row_mask:0xf bank_mask:0xf
    v_fmac_f32_dpp v233, v250, v169 row_newbcast:9 row_mask:0xf bank_mask:0xf
    v_fmac_f32_dpp v234, v250, v170 row_newbcast:10 row_mask:0xf bank_mask:0xf
    v_fmac_f32_dpp v235, v250, v171 row_newbcast:11 row_mask:0xf bank_mask:0xf
    v_fmac_f32_dpp v236, v250, v172 row_newbcast:12 row_mask:0xf bank_mask:0xf
    v_fmac_f32_dpp v237, v250, v173 row_newbcast:13 row_mask:0xf bank_mask:0xf
    v_mfma_f32_32x32x16_bf16 a[16:31], v[80:83], a[68:71], a[16:31]
    ds_read_b64_tr_b16 a[58:59], v254 offset:20736
    ds_read_b64_tr_b16 a[60:61], v254 offset:21504
    ds_read_b64_tr_b16 a[62:63], v254 offset:21760
    s_mov_b32 s14, 1032192
    s_add_u32 s14, s14, s1
    s_add_u32 m0, s10, 147456
    s_add_u32 s15, s14, 0
    buffer_load_dwordx4 v216, s[48:51], s15 offen  lds
    v_fmac_f32_dpp v238, v250, v174 row_newbcast:14 row_mask:0xf bank_mask:0xf
    v_fmac_f32_dpp v239, v250, v175 row_newbcast:15 row_mask:0xf bank_mask:0xf
    v_cvt_pk_bf16_f32 v84, v232, v233
    v_cvt_pk_bf16_f32 v85, v234, v235
    v_cvt_pk_bf16_f32 v86, v236, v237
    v_cvt_pk_bf16_f32 v87, v238, v239
    s_cmp_eq_u32 s42, 0
    s_cbranch_scc1 PP_1
    s_add_u32 m0, s0, 0
    s_add_u32 s15, s11, 0
    buffer_load_dwordx4 v217, s[60:63], s15 offen  lds
    s_add_u32 m0, s0, 4096
    s_nop 0
    buffer_load_dwordx4 v217, s[64:67], s15 offen lds
PP_1:
    s_waitcnt lgkmcnt(4)
    v_mfma_f32_32x32x16_bf16 a[0:15], a[48:51], v[84:87], a[0:15]
    ds_read_b128 v[232:235], v222 offset:1472
    ds_read_b128 v[236:239], v222 offset:1488
    ds_read_b64_tr_b16 a[64:65], v254 offset:49152
    v_fmac_f32_dpp v224, v251, v176 row_newbcast:0 row_mask:0xf bank_mask:0xf
    v_fmac_f32_dpp v225, v251, v177 row_newbcast:1 row_mask:0xf bank_mask:0xf
    v_fmac_f32_dpp v226, v251, v178 row_newbcast:2 row_mask:0xf bank_mask:0xf
    v_fmac_f32_dpp v227, v251, v179 row_newbcast:3 row_mask:0xf bank_mask:0xf
    v_fmac_f32_dpp v228, v251, v180 row_newbcast:4 row_mask:0xf bank_mask:0xf
    v_fmac_f32_dpp v229, v251, v181 row_newbcast:5 row_mask:0xf bank_mask:0xf
    v_mfma_f32_32x32x16_bf16 a[16:31], v[84:87], a[52:55], a[16:31]
    ds_read_b64_tr_b16 a[66:67], v254 offset:49408
    ds_read_b64_tr_b16 a[68:69], v254 offset:50176
    ds_read_b64_tr_b16 a[70:71], v254 offset:50432
    v_fmac_f32_dpp v230, v251, v182 row_newbcast:6 row_mask:0xf bank_mask:0xf
    v_fmac_f32_dpp v231, v251, v183 row_newbcast:7 row_mask:0xf bank_mask:0xf
    v_cvt_pk_bf16_f32 v88, v224, v225
    v_cvt_pk_bf16_f32 v89, v226, v227
    v_cvt_pk_bf16_f32 v90, v228, v229
    v_cvt_pk_bf16_f32 v91, v230, v231
    s_cmp_eq_u32 s42, 0
    s_cbranch_scc1 PP_2
    s_add_u32 m0, s0, 1024
    s_add_u32 s15, s11, 14336
    buffer_load_dwordx4 v217, s[60:63], s15 offen  lds
    s_add_u32 m0, s0, 5120
    s_nop 0
    buffer_load_dwordx4 v217, s[64:67], s15 offen lds
PP_2:
    s_waitcnt lgkmcnt(4)
    v_mfma_f32_32x32x16_bf16 a[0:15], a[56:59], v[88:91], a[0:15]
    ds_read_b128 v[224:227], v222 offset:1536
    ds_read_b128 v[228:231], v222 offset:1552
    ds_read_b64_tr_b16 a[48:49], v223 offset:22528
    v_fmac_f32_dpp v232, v251, v184 row_newbcast:8 row_mask:0xf bank_mask:0xf
    v_fmac_f32_dpp v233, v251, v185 row_newbcast:9 row_mask:0xf bank_mask:0xf
    v_fmac_f32_dpp v234, v251, v186 row_newbcast:10 row_mask:0xf bank_mask:0xf
    v_fmac_f32_dpp v235, v251, v187 row_newbcast:11 row_mask:0xf bank_mask:0xf
    v_fmac_f32_dpp v236, v251, v188 row_newbcast:12 row_mask:0xf bank_mask:0xf
    v_fmac_f32_dpp v237, v251, v189 row_newbcast:13 row_mask:0xf bank_mask:0xf
    v_mfma_f32_32x32x16_bf16 a[16:31], v[88:91], a[60:63], a[16:31]
    ds_read_b64_tr_b16 a[50:51], v223 offset:22784
    ds_read_b64_tr_b16 a[52:53], v223 offset:23552
    ds_read_b64_tr_b16 a[54:55], v223 offset:23808
    v_fmac_f32_dpp v238, v251, v190 row_newbcast:14 row_mask:0xf bank_mask:0xf
    v_fmac_f32_dpp v239, v251, v191 row_newbcast:15 row_mask:0xf bank_mask:0xf
    v_cvt_pk_bf16_f32 v92, v232, v233
    v_cvt_pk_bf16_f32 v93, v234, v235
    v_cvt_pk_bf16_f32 v94, v236, v237
    v_cvt_pk_bf16_f32 v95, v238, v239
    s_cmp_eq_u32 s42, 0
    s_cbranch_scc1 PP_3
    s_add_u32 m0, s0, 2048
    s_add_u32 s15, s11, 28672
    buffer_load_dwordx4 v217, s[60:63], s15 offen  lds
    s_add_u32 m0, s0, 6144
    s_nop 0
    buffer_load_dwordx4 v217, s[64:67], s15 offen lds
PP_3:
    s_waitcnt lgkmcnt(4)
    v_mfma_f32_32x32x16_bf16 a[0:15], a[64:67], v[92:95], a[0:15]
    ds_read_b128 v[232:235], v222 offset:1600
    ds_read_b128 v[236:239], v222 offset:1616
    ds_read_b64_tr_b16 a[56:57], v223 offset:51200
    v_fmac_f32_dpp v224, v252, v192 row_newbcast:0 row_mask:0xf bank_mask:0xf
    v_fmac_f32_dpp v225, v252, v193 row_newbcast:1 row_mask:0xf bank_mask:0xf
    v_fmac_f32_dpp v226, v252, v194 row_newbcast:2 row_mask:0xf bank_mask:0xf
    v_fmac_f32_dpp v227, v252, v195 row_newbcast:3 row_mask:0xf bank_mask:0xf
    v_fmac_f32_dpp v228, v252, v196 row_newbcast:4 row_mask:0xf bank_mask:0xf
    v_fmac_f32_dpp v229, v252, v197 row_newbcast:5 row_mask:0xf bank_mask:0xf
    v_mfma_f32_32x32x16_bf16 a[16:31], v[92:95], a[68:71], a[16:31]
    ds_read_b64_tr_b16 a[58:59], v223 offset:51456
    ds_read_b64_tr_b16 a[60:61], v223 offset:52224
    ds_read_b64_tr_b16 a[62:63], v223 offset:52480
    v_fmac_f32_dpp v230, v252, v198 row_newbcast:6 row_mask:0xf bank_mask:0xf
    v_fmac_f32_dpp v231, v252, v199 row_newbcast:7 row_mask:0xf bank_mask:0xf
    v_cvt_pk_bf16_f32 v96, v224, v225
    v_cvt_pk_bf16_f32 v97, v226, v227
    v_cvt_pk_bf16_f32 v98, v228, v229
    v_cvt_pk_bf16_f32 v99, v230, v231
    s_cmp_eq_u32 s42, 0
    s_cbranch_scc1 PP_4
    s_add_u32 m0, s0, 3072
    s_add_u32 s15, s11, 43008
    buffer_load_dwordx4 v217, s[60:63], s15 offen  lds
    s_add_u32 m0, s0, 7168
    s_nop 0
    buffer_load_dwordx4 v217, s[64:67], s15 offen lds
PP_4:
    s_waitcnt lgkmcnt(4)
    v_mfma_f32_32x32x16_bf16 a[0:15], a[48:51], v[96:99], a[0:15]
    ds_read_b128 v[224:227], v222 offset:1664
    ds_read_b128 v[228:231], v222 offset:1680
    ds_read_b64_tr_b16 a[64:65], v254 offset:22528
    v_fmac_f32_dpp v232, v252, v200 row_newbcast:8 row_mask:0xf bank_mask:0xf
    v_fmac_f32_dpp v233, v252, v201 row_newbcast:9 row_mask:0xf bank_mask:0xf
    v_fmac_f32_dpp v234, v252, v202 row_newbcast:10 row_mask:0xf bank_mask:0xf
    v_fmac_f32_dpp v235, v252, v203 row_newbcast:11 row_mask:0xf bank_mask:0xf
    v_fmac_f32_dpp v236, v252, v204 row_newbcast:12 row_mask:0xf bank_mask:0xf
    v_fmac_f32_dpp v237, v252, v205 row_newbcast:13 row_mask:0xf bank_mask:0xf
    v_mfma_f32_32x32x16_bf16 a[16:31], v[96:99], a[52:55], a[16:31]
    ds_read_b64_tr_b16 a[66:67], v254 offset:22784
    ds_read_b64_tr_b16 a[68:69], v254 offset:23552
    ds_read_b64_tr_b16 a[70:71], v254 offset:23808
    v_fmac_f32_dpp v238, v252, v206 row_newbcast:14 row_mask:0xf bank_mask:0xf
    v_fmac_f32_dpp v239, v252, v207 row_newbcast:15 row_mask:0xf bank_mask:0xf
    v_cvt_pk_bf16_f32 v100, v232, v233
    v_cvt_pk_bf16_f32 v101, v234, v235
    v_cvt_pk_bf16_f32 v102, v236, v237
    v_cvt_pk_bf16_f32 v103, v238, v239
    s_cmp_eq_u32 s42, 0
    s_cbranch_scc1 PP_5
    s_add_u32 m0, s0, 8192
    s_add_u32 s15, s2, 0
    s_nop 0
    buffer_load_dwordx4 v219, s[68:71], s15 offen  lds
    s_add_u32 m0, s0, 9216
    s_add_u32 s15, s2, 7168
    buffer_load_dwordx4 v219, s[68:71], s15 offen  lds
PP_5:
    v_accvgpr_read_b32 v116, a152
    v_accvgpr_read_b32 v117, a153
    v_accvgpr_read_b32 v118, a154
    v_accvgpr_read_b32 v119, a155
    v_lshlrev_b32 v112, 16, v116
    v_and_b32 v113, s100, v116
    v_lshlrev_b32 v114, 16, v117
    v_and_b32 v115, s100, v117
    v_lshlrev_b32 v116, 16, v118
    v_and_b32 v117, s100, v118
    v_lshlrev_b32 v118, 16, v119
    v_and_b32 v119, s100, v119
    v_pk_fma_f32 v[112:113], v[112:113], v[220:221], v[220:221] op_sel:[0,1,0] op_sel_hi:[1,1,0]
    v_pk_fma_f32 v[114:115], v[114:115], v[220:221], v[220:221] op_sel:[0,1,0] op_sel_hi:[1,1,0]
    v_pk_fma_f32 v[116:117], v[116:117], v[220:221], v[220:221] op_sel:[0,1,0] op_sel_hi:[1,1,0]
    v_pk_fma_f32 v[118:119], v[118:119], v[220:221], v[220:221] op_sel:[0,1,0] op_sel_hi:[1,1,0]
    s_waitcnt lgkmcnt(4)
    s_nop 0
    v_mfma_f32_32x32x16_bf16 a[0:15], a[56:59], v[100:103], a[0:15]
    ds_read_b128 v[232:235], v222 offset:1728
    ds_read_b128 v[236:239], v222 offset:1744
    ds_read_b64_tr_b16 a[48:49], v254 offset:51200
    v_fmac_f32_dpp v224, v253, v208 row_newbcast:0 row_mask:0xf bank_mask:0xf
    v_fmac_f32_dpp v225, v253, v209 row_newbcast:1 row_mask:0xf bank_mask:0xf
    v_fmac_f32_dpp v226, v253, v210 row_newbcast:2 row_mask:0xf bank_mask:0xf
    v_fmac_f32_dpp v227, v253, v211 row_newbcast:3 row_mask:0xf bank_mask:0xf
    v_fmac_f32_dpp v228, v253, v212 row_newbcast:4 row_mask:0xf bank_mask:0xf
    v_fmac_f32_dpp v229, v253, v213 row_newbcast:5 row_mask:0xf bank_mask:0xf
    v_mfma_f32_32x32x16_bf16 a[16:31], v[100:103], a[60:63], a[16:31]
    ds_read_b64_tr_b16 a[50:51], v254 offset:51456
    ds_read_b64_tr_b16 a[52:53], v254 offset:52224
    ds_read_b64_tr_b16 a[54:55], v254 offset:52480
    v_fmac_f32_dpp v230, v253, v214 row_newbcast:6 row_mask:0xf bank_mask:0xf
    v_fmac_f32_dpp v231, v253, v215 row_newbcast:7 row_mask:0xf bank_mask:0xf
    v_cvt_pk_bf16_f32 v104, v224, v225
    v_cvt_pk_bf16_f32 v105, v226, v227
    v_cvt_pk_bf16_f32 v106, v228, v229
    v_cvt_pk_bf16_f32 v107, v230, v231
    s_cmp_eq_u32 s42, 0
    s_cbranch_scc1 PP_6
    s_add_u32 m0, s0, 10240
    s_add_u32 s15, s2, 14336
    buffer_load_dwordx4 v219, s[68:71], s15 offen  lds
    s_add_u32 m0, s0, 11264
    s_add_u32 s15, s2, 21504
    buffer_load_dwordx4 v219, s[68:71], s15 offen  lds
PP_6:
    s_waitcnt lgkmcnt(4)
    s_nop 0
    v_mfma_f32_32x32x16_bf16 a[0:15], a[64:67], v[104:107], a[0:15]
    v_fmac_f32_dpp v232, v253, v112 row_newbcast:8 row_mask:0xf bank_mask:0xf
    v_fmac_f32_dpp v233, v253, v113 row_newbcast:9 row_mask:0xf bank_mask:0xf
    v_fmac_f32_dpp v234, v253, v114 row_newbcast:10 row_mask:0xf bank_mask:0xf
    v_fmac_f32_dpp v235, v253, v115 row_newbcast:11 row_mask:0xf bank_mask:0xf
    v_fmac_f32_dpp v236, v253, v116 row_newbcast:12 row_mask:0xf bank_mask:0xf
    v_fmac_f32_dpp v237, v253, v117 row_newbcast:13 row_mask:0xf bank_mask:0xf
    v_mfma_f32_32x32x16_bf16 a[16:31], v[104:107], a[68:71], a[16:31]
    v_fmac_f32_dpp v238, v253, v118 row_newbcast:14 row_mask:0xf bank_mask:0xf
    v_fmac_f32_dpp v239, v253, v119 row_newbcast:15 row_mask:0xf bank_mask:0xf
    v_cvt_pk_bf16_f32 v108, v232, v233
    v_cvt_pk_bf16_f32 v109, v234, v235
    v_cvt_pk_bf16_f32 v110, v236, v237
    v_cvt_pk_bf16_f32 v111, v238, v239
    s_waitcnt lgkmcnt(0)
    s_nop 0
    v_mfma_f32_32x32x16_bf16 a[0:15], a[48:51], v[108:111], a[0:15]
    v_mfma_f32_32x32x16_bf16 a[16:31], v[108:111], a[52:55], a[16:31]
    v_mbcnt_lo_u32_b32 v255, -1, 0
    v_mbcnt_hi_u32_b32 v255, -1, v255
    v_mov_b32 v254, 0
    v_lshrrev_b32 v240, 5, v255
    v_bfe_u32 v241, v255, 4, 1
    v_bfe_u32 v242, v255, 2, 2
    v_and_b32_e64 v243, 3, v255
    v_lshl_add_u32 v240, v240, 2, v242
    v_mul_u32_u24_e64 v240, 56, v240
    v_lshl_add_u32 v240, v241, 5, v240
    v_lshl_add_u32 v240, v243, 3, v240
    v_add_u32 v240, 159744, v240
    ds_read_b64_tr_b16 a[96:97], v240 offset:0
    ds_read_b64_tr_b16 a[98:99], v240 offset:448
    ds_read_b64_tr_b16 a[100:101], v240 offset:896
    ds_read_b64_tr_b16 a[102:103], v240 offset:1344
    v_accvgpr_read_b32 v112, a0
    v_accvgpr_read_b32 v113, a1
    v_accvgpr_read_b32 v114, a2
    v_accvgpr_read_b32 v115, a3
    v_accvgpr_read_b32 v116, a4
    v_accvgpr_read_b32 v117, a5
    v_accvgpr_read_b32 v118, a6
    v_accvgpr_read_b32 v119, a7
    v_accvgpr_read_b32 v120, a8
    v_accvgpr_read_b32 v121, a9
    v_accvgpr_read_b32 v122, a10
    v_accvgpr_read_b32 v123, a11
    v_accvgpr_read_b32 v124, a12
    v_accvgpr_read_b32 v125, a13
    v_accvgpr_read_b32 v126, a14
    v_accvgpr_read_b32 v127, a15
    v_cvt_pk_bf16_f32 v128, v112, v113
    v_cvt_pk_bf16_f32 v129, v114, v115
    v_cvt_pk_bf16_f32 v130, v116, v117
    v_cvt_pk_bf16_f32 v131, v118, v119
    v_cvt_pk_bf16_f32 v132, v120, v121
    v_cvt_pk_bf16_f32 v133, v122, v123
    v_cvt_pk_bf16_f32 v134, v124, v125
    v_cvt_pk_bf16_f32 v135, v126, v127
    s_waitcnt lgkmcnt(0)
    s_mov_b64 exec, s[98:99]
    v_accvgpr_write_b32 a102, 0
    v_accvgpr_write_b32 a103, 0
    s_mov_b64 exec, -1
    s_nop 0
    v_mfma_f32_32x32x16_bf16 v[136:151], a[96:99], v[128:131], 0
    v_mfma_f32_32x32x16_bf16 v[136:151], a[100:103], v[132:135], v[136:151]
    v_accvgpr_read_b32 v152, a16
    v_accvgpr_read_b32 v153, a17
    v_accvgpr_read_b32 v154, a18
    v_accvgpr_read_b32 v155, a19
    v_accvgpr_read_b32 v156, a20
    v_accvgpr_read_b32 v157, a21
    v_accvgpr_read_b32 v158, a22
    v_accvgpr_read_b32 v159, a23
    v_accvgpr_read_b32 v160, a24
    v_accvgpr_read_b32 v161, a25
    v_accvgpr_read_b32 v162, a26
    v_accvgpr_read_b32 v163, a27
    v_accvgpr_read_b32 v164, a28
    v_accvgpr_read_b32 v165, a29
    v_accvgpr_read_b32 v166, a30
    v_accvgpr_read_b32 v167, a31
    v_cvt_pk_bf16_f32 v168, v152, v153
    v_cvt_pk_bf16_f32 v169, v154, v155
    v_cvt_pk_bf16_f32 v170, v156, v157
    v_cvt_pk_bf16_f32 v171, v158, v159
    v_cvt_pk_bf16_f32 v172, v160, v161
    v_cvt_pk_bf16_f32 v173, v162, v163
    v_cvt_pk_bf16_f32 v174, v164, v165
    v_cvt_pk_bf16_f32 v175, v166, v167
    s_mov_b32 exec_lo, 0x10000000
    s_mov_b32 exec_hi, 0x10000000
    v_mov_b32 v168, s101
    v_mov_b32 v169, s101
    v_mov_b32 v170, s101
    v_mov_b32 v171, s101
    v_mov_b32 v172, s101
    v_mov_b32 v173, s101
    v_mov_b32 v174, s101
    v_mov_b32 v175, s101
    s_mov_b64 exec, -1
    s_lshl_b32 s8, s3, 11
    s_add_u32 s8, s8, 114688
    v_lshl_add_u32 v244, v255, 4, s8
    s_barrier
    v_lshrrev_b32 v250, 5, v255
    v_and_b32_e64 v251, 31, v255
    v_mul_u32_u24 v251, 896, v251
    v_lshl_add_u32 v251, v250, 3, v251
    s_and_b32 s10, s7, 1
    s_lshl_b32 s10, s10, 1
    s_lshr_b32 s15, s3, 1
    s_add_u32 s10, s10, s15
    s_lshl_b32 s8, s6, 2
    s_add_u32 s8, s8, s10
    s_mul_i32 s8, s8, 28672
    s_and_b32 s10, s7, 14
    s_and_b32 s15, s3, 1
    s_add_u32 s10, s10, s15
    s_lshl_b32 s10, s10, 6
    s_add_u32 s10, s10, s8
    s_nop 0
    buffer_load_dwordx2 a[240:241], v251, s[44:47], s10 offen offset:0
    buffer_load_dwordx2 a[242:243], v251, s[44:47], s10 offen offset:16
    buffer_load_dwordx2 a[244:245], v251, s[44:47], s10 offen offset:32
    buffer_load_dwordx2 a[246:247], v251, s[44:47], s10 offen offset:48
    ds_write_b128 v244, v[168:171]
    ds_write_b128 v244, v[172:175] offset:1024
    v_and_b32_e64 v244, 1, v255
    v_bfe_u32 v245, v255, 1, 1
    v_lshl_or_b32 v244, v245, 3, v244
    v_bfe_u32 v245, v255, 3, 1
    v_lshl_or_b32 v244, v245, 2, v244
    v_bfe_u32 v245, v255, 2, 1
    v_lshl_or_b32 v244, v245, 1, v244
    v_lshrrev_b32 v245, 5, v255
    v_xor_b32 v244, v244, v245
    v_and_b32 v245, 31, v255
    v_lshlrev_b32_e64 v245, 7, v245
    s_lshl_b32 s8, s3, 12
    s_add_u32 s8, s8, 98304
    v_add_u32 v245, s8, v245
    s_mov_b64 exec, s[98:99]
    v_mov_b32 v148, v144
    v_mov_b32 v149, v145
    v_mov_b32 v150, v146
    v_mov_b32_e64 v151, v147
    s_mov_b64 exec, -1
    v_max3_f32 v208, v136, v137, v138
    v_max3_f32 v210, -v136, -v137, -v138
    v_max3_f32 v208, v208, v139, v140
    v_max3_f32 v210, v210, -v139, -v140
    v_max3_f32 v208, v208, v141, v142
    v_max3_f32 v210, v210, -v141, -v142
    v_max3_f32 v208, v208, v143, v144
    v_max3_f32 v210, v210, -v143, -v144
    v_max3_f32 v208, v208, v145, v146
    v_max3_f32 v210, v210, -v145, -v146
    v_max3_f32 v208, v208, v147, v148
    v_max3_f32 v210, v210, -v147, -v148
    v_max3_f32 v208, v208, v149, v150
    v_max3_f32 v210, v210, -v149, -v150
    v_max_f32_e64 v208, v208, v151
    v_max_f32_e64 v210, v210, -v151
    s_nop 1
    v_permlane32_swap_b32 v208, v210
    v_max_f32 v208, v208, v210
    v_mov_b32 v210, v208
    s_nop 1
    v_permlane32_swap_b32 v208, v210
    v_mul_f32_e64 v208, -v208, s96
    v_mul_f32_e64 v210, -v210, s96
    v_pk_fma_f32 v[152:153], v[136:137], s[96:97], v[208:209] op_sel_hi:[1,1,0]
    v_pk_fma_f32 v[176:177], v[136:137], s[96:97], v[210:211] op_sel_hi:[1,1,0] neg_lo:[1,0,0] neg_hi:[1,0,0]
    v_pk_fma_f32 v[154:155], v[138:139], s[96:97], v[208:209] op_sel_hi:[1,1,0]
    v_pk_fma_f32 v[178:179], v[138:139], s[96:97], v[210:211] op_sel_hi:[1,1,0] neg_lo:[1,0,0] neg_hi:[1,0,0]
    v_pk_fma_f32 v[156:157], v[140:141], s[96:97], v[208:209] op_sel_hi:[1,1,0]
    v_pk_fma_f32 v[180:181], v[140:141], s[96:97], v[210:211] op_sel_hi:[1,1,0] neg_lo:[1,0,0] neg_hi:[1,0,0]
    v_pk_fma_f32 v[158:159], v[142:143], s[96:97], v[208:209] op_sel_hi:[1,1,0]
    v_pk_fma_f32 v[182:183], v[142:143], s[96:97], v[210:211] op_sel_hi:[1,1,0] neg_lo:[1,0,0] neg_hi:[1,0,0]
    v_pk_fma_f32 v[160:161], v[144:145], s[96:97], v[208:209] op_sel_hi:[1,1,0]
    v_pk_fma_f32 v[184:185], v[144:145], s[96:97], v[210:211] op_sel_hi:[1,1,0] neg_lo:[1,0,0] neg_hi:[1,0,0]
    v_pk_fma_f32 v[162:163], v[146:147], s[96:97], v[208:209] op_sel_hi:[1,1,0]
    v_pk_fma_f32 v[186:187], v[146:147], s[96:97], v[210:211] op_sel_hi:[1,1,0] neg_lo:[1,0,0] neg_hi:[1,0,0]
    v_pk_fma_f32 v[164:165], v[148:149], s[96:97], v[208:209] op_sel_hi:[1,1,0]
    v_pk_fma_f32 v[188:189], v[148:149], s[96:97], v[210:211] op_sel_hi:[1,1,0] neg_lo:[1,0,0] neg_hi:[1,0,0]
    v_pk_fma_f32 v[166:167], v[150:151], s[96:97], v[208:209] op_sel_hi:[1,1,0]
    v_pk_fma_f32 v[190:191], v[150:151], s[96:97], v[210:211] op_sel_hi:[1,1,0] neg_lo:[1,0,0] neg_hi:[1,0,0]
    v_exp_f32 v152, v152
    v_exp_f32 v176, v176
    v_exp_f32 v153, v153
    v_exp_f32 v177, v177
    v_exp_f32 v154, v154
    v_exp_f32 v178, v178
    v_exp_f32 v155, v155
    v_exp_f32 v179, v179
    v_exp_f32 v156, v156
    v_exp_f32 v180, v180
    v_exp_f32 v157, v157
    v_exp_f32 v181, v181
    v_exp_f32 v158, v158
    v_exp_f32 v182, v182
    v_exp_f32 v159, v159
    v_exp_f32 v183, v183
    v_exp_f32 v160, v160
    v_exp_f32 v184, v184
    v_exp_f32 v161, v161
    v_exp_f32 v185, v185
    v_exp_f32 v162, v162
    v_exp_f32 v186, v186
    v_exp_f32 v163, v163
    v_exp_f32 v187, v187
    v_exp_f32 v164, v164
    v_exp_f32 v188, v188
    v_exp_f32 v165, v165
    v_exp_f32 v189, v189
    v_exp_f32 v166, v166
    v_exp_f32 v190, v190
    v_exp_f32 v167, v167
    v_exp_f32 v191, v191
    s_mov_b64 exec, s[98:99]
    v_mov_b32 v164, 0
    v_mov_b32 v188, 0
    v_mov_b32 v165, 0
    v_mov_b32 v189, 0
    v_mov_b32 v166, 0
    v_mov_b32 v190, 0
    v_mov_b32 v167, 0
    v_mov_b32 v191, 0
    s_mov_b64 exec, -1
    v_pk_add_f32 v[208:209], v[152:153], v[154:155]
    v_pk_add_f32 v[210:211], v[176:177], v[178:179]
    v_pk_add_f32 v[208:209], v[208:209], v[156:157]
    v_pk_add_f32 v[210:211], v[210:211], v[180:181]
    v_pk_add_f32 v[208:209], v[208:209], v[158:159]
    v_pk_add_f32 v[210:211], v[210:211], v[182:183]
    v_pk_add_f32 v[208:209], v[208:209], v[160:161]
    v_pk_add_f32 v[210:211], v[210:211], v[184:185]
    v_pk_add_f32 v[208:209], v[208:209], v[162:163]
    v_pk_add_f32 v[210:211], v[210:211], v[186:187]
    v_pk_add_f32 v[208:209], v[208:209], v[164:165]
    v_pk_add_f32 v[210:211], v[210:211], v[188:189]
    v_pk_add_f32 v[208:209], v[208:209], v[166:167]
    v_pk_add_f32 v[210:211], v[210:211], v[190:191]
    v_add_f32 v208, v208, v209
    v_add_f32 v210, v210, v211
    s_nop 1
    v_permlane32_swap_b32 v208, v210
    v_add_f32 v208, v208, v210
    v_mov_b32 v210, v208
    s_nop 1
    v_permlane32_swap_b32 v208, v210
    v_rcp_f32 v208, v208
    v_rcp_f32 v210, v210
    v_pk_mul_f32 v[152:153], v[152:153], v[208:209] op_sel_hi:[1,0]
    v_pk_mul_f32 v[176:177], v[176:177], v[210:211] op_sel_hi:[1,0]
    v_pk_mul_f32 v[154:155], v[154:155], v[208:209] op_sel_hi:[1,0]
    v_pk_mul_f32 v[178:179], v[178:179], v[210:211] op_sel_hi:[1,0]
    v_pk_mul_f32 v[156:157], v[156:157], v[208:209] op_sel_hi:[1,0]
    v_pk_mul_f32 v[180:181], v[180:181], v[210:211] op_sel_hi:[1,0]
    v_pk_mul_f32 v[158:159], v[158:159], v[208:209] op_sel_hi:[1,0]
    v_pk_mul_f32 v[182:183], v[182:183], v[210:211] op_sel_hi:[1,0]
    v_pk_mul_f32 v[160:161], v[160:161], v[208:209] op_sel_hi:[1,0]
    v_pk_mul_f32 v[184:185], v[184:185], v[210:211] op_sel_hi:[1,0]
    v_pk_mul_f32 v[162:163], v[162:163], v[208:209] op_sel_hi:[1,0]
    v_pk_mul_f32 v[186:187], v[186:187], v[210:211] op_sel_hi:[1,0]
    v_pk_mul_f32 v[164:165], v[164:165], v[208:209] op_sel_hi:[1,0]
    v_pk_mul_f32 v[188:189], v[188:189], v[210:211] op_sel_hi:[1,0]
    v_pk_mul_f32 v[166:167], v[166:167], v[208:209] op_sel_hi:[1,0]
    v_pk_mul_f32 v[190:191], v[190:191], v[210:211] op_sel_hi:[1,0]
    v_cvt_pk_bf16_f32 v192, v152, v153
    v_cvt_pk_bf16_f32 v200, v176, v177
    v_cvt_pk_bf16_f32 v193, v154, v155
    v_cvt_pk_bf16_f32 v201, v178, v179
    v_cvt_pk_bf16_f32 v194, v156, v157
    v_cvt_pk_bf16_f32 v202, v180, v181
    v_cvt_pk_bf16_f32 v195, v158, v159
    v_cvt_pk_bf16_f32 v203, v182, v183
    v_cvt_pk_bf16_f32 v196, v160, v161
    v_cvt_pk_bf16_f32 v204, v184, v185
    v_cvt_pk_bf16_f32 v197, v162, v163
    v_cvt_pk_bf16_f32 v205, v186, v187
    v_cvt_pk_bf16_f32 v198, v164, v165
    v_cvt_pk_bf16_f32 v206, v188, v189
    v_cvt_pk_bf16_f32 v199, v166, v167
    v_cvt_pk_bf16_f32 v207, v190, v191
    v_xor_b32_e64 v246, 0, v244
    v_lshl_add_u32 v246, v246, 3, v245
    ds_write_b64 v246, v[192:193]
    v_xor_b32_e64 v246, 2, v244
    v_lshl_add_u32 v246, v246, 3, v245
    ds_write_b64 v246, v[194:195]
    v_xor_b32_e64 v246, 4, v244
    v_lshl_add_u32 v246, v246, 3, v245
    ds_write_b64 v246, v[196:197]
    v_xor_b32_e64 v246, 6, v244
    v_lshl_add_u32 v246, v246, 3, v245
    ds_write_b64 v246, v[198:199]
    v_xor_b32_e64 v246, 8, v244
    v_lshl_add_u32 v246, v246, 3, v245
    ds_write_b64 v246, v[200:201]
    v_xor_b32_e64 v246, 10, v244
    v_lshl_add_u32 v246, v246, 3, v245
    ds_write_b64 v246, v[202:203]
    v_xor_b32_e64 v246, 12, v244
    v_lshl_add_u32 v246, v246, 3, v245
    ds_write_b64 v246, v[204:205]
    v_xor_b32_e64 v246, 14, v244
    v_lshl_add_u32 v246, v246, 3, v245
    ds_write_b64 v246, v[206:207]
    s_cmp_eq_u32 s42, 0
    s_cbranch_scc1 L_wqa
    s_waitcnt vmcnt(16)
    s_branch L_wqb
L_wqa:
    s_waitcnt vmcnt(4)
L_wqb:
    v_lshlrev_b32 v246, 4, v255
    s_waitcnt lgkmcnt(0)
    s_barrier
    s_cmp_ge_u32 s3, 2
    s_cbranch_scc1 L_kv_skip
    v_lshrrev_b32_e64 v244, 5, v255
    v_bfe_u32 v245, v255, 2, 2
    v_lshl_add_u32 v243, v244, 2, v245
    v_lshlrev_b32_e64 v243, 7, v243
    v_add_u32 v243, 98304, v243
    v_lshlrev_b32_e64 v244, 1, v244
    v_bfe_u32 v245, v255, 2, 1
    v_or_b32_e64 v244, v244, v245
    v_bfe_u32 v245, v255, 3, 1
    v_lshl_or_b32 v244, v245, 3, v244
    v_bfe_u32 v245, v255, 4, 1
    v_lshlrev_b32 v245, 2, v245
    v_and_b32 v247, 3, v255
    v_or_b32 v245, v245, v247
    s_lshl_b32 s8, s3, 3
    v_or_b32 v245, s8, v245
    v_xor_b32 v244, v244, v245
    v_lshl_add_u32 v245, v244, 3, v243
    v_xor_b32_e64 v244, 4, v244
    v_lshl_add_u32 v244, v244, 3, v243
    v_add_u32 v243, 114688, v246
    ds_read_b64_tr_b16 v[112:113], v245 offset:0
    ds_read_b64_tr_b16 v[114:115], v244 offset:1024
    ds_read_b128 v[144:147], v243 offset:0
    ds_read_b64_tr_b16 v[116:117], v245 offset:2048
    ds_read_b64_tr_b16 v[118:119], v244 offset:3072
    ds_read_b128 v[148:151], v243 offset:1024
    ds_read_b64_tr_b16 v[120:121], v245 offset:4096
    ds_read_b64_tr_b16 v[122:123], v244 offset:5120
    ds_read_b128 v[152:155], v243 offset:2048
    ds_read_b64_tr_b16 v[124:125], v245 offset:6144
    ds_read_b64_tr_b16 v[126:127], v244 offset:7168
    ds_read_b128 v[156:159], v243 offset:3072
    ds_read_b64_tr_b16 v[128:129], v245 offset:8192
    ds_read_b64_tr_b16 v[130:131], v244 offset:9216
    ds_read_b128 v[160:163], v243 offset:4096
    ds_read_b64_tr_b16 v[132:133], v245 offset:10240
    ds_read_b64_tr_b16 v[134:135], v244 offset:11264
    ds_read_b128 v[164:167], v243 offset:5120
    ds_read_b64_tr_b16 v[136:137], v245 offset:12288
    ds_read_b64_tr_b16 v[138:139], v244 offset:13312
    ds_read_b128 v[168:171], v243 offset:6144
    ds_read_b64_tr_b16 v[140:141], v245 offset:14336
    ds_read_b64_tr_b16 v[142:143], v244 offset:15360
    ds_read_b128 v[172:175], v243 offset:7168
    s_lshl_b32 s8, s4, 4
    s_add_u32 s8, s8, s5
    s_lshl_b32 s8, s8, 12
    s_lshl_b32 s9, s3, 11
    s_add_u32 s8, s8, s9
    s_add_u32 s8, s8, 1048576
    s_lshl_b32 s10, s4, 1
    s_add_u32 s10, s10, s3
    s_lshl_b32 s10, s10, 8
    s_lshl_b32 s9, s5, 3
    s_add_u32 s10, s10, s9
    s_add_u32 s10, s10, 16384
    v_mov_b32 v200, s89
    v_mov_b32_e64 v202, s89
    s_waitcnt lgkmcnt(15)
    v_mfma_f32_32x32x16_bf16 v[176:191], v[112:115], v[144:147], 0
    s_waitcnt lgkmcnt(15)
    v_mfma_f32_32x32x16_bf16 v[176:191], v[116:119], v[148:151], v[176:191]
    s_waitcnt lgkmcnt(15)
    v_mfma_f32_32x32x16_bf16 v[176:191], v[120:123], v[152:155], v[176:191]
    s_waitcnt lgkmcnt(12)
    v_mfma_f32_32x32x16_bf16 v[176:191], v[124:127], v[156:159], v[176:191]
    s_waitcnt lgkmcnt(9)
    v_mfma_f32_32x32x16_bf16 v[176:191], v[128:131], v[160:163], v[176:191]
    s_waitcnt lgkmcnt(6)
    v_mfma_f32_32x32x16_bf16 v[176:191], v[132:135], v[164:167], v[176:191]
    s_waitcnt lgkmcnt(3)
    v_mfma_f32_32x32x16_bf16 v[176:191], v[136:139], v[168:171], v[176:191]
    s_waitcnt lgkmcnt(0)
    v_mfma_f32_32x32x16_bf16 v[176:191], v[140:143], v[172:175], v[176:191]
    s_nop 11
    v_cvt_pk_bf16_f32 v192, v176, v177
    v_cvt_pk_bf16_f32 v193, v178, v179
    v_cvt_pk_bf16_f32 v194, v180, v181
    v_cvt_pk_bf16_f32 v195, v182, v183
    v_cvt_pk_bf16_f32 v196, v184, v185
    v_cvt_pk_bf16_f32 v197, v186, v187
    v_cvt_pk_bf16_f32 v198, v188, v189
    v_cvt_pk_bf16_f32 v199, v190, v191
    buffer_store_dwordx4 v[192:195], v246, s[84:87], s8 offen sc1
    buffer_store_dwordx4 v[196:199], v246, s[84:87], s8 offen offset:1024 sc1
    v_add3_u32 v201, v192, v193, v194
    v_add_u32_e64 v201, v201, v195
    v_add3_u32 v203, v196, v197, v198
    v_add_u32_e64 v203, v203, v199
    v_add_u32_dpp v201, v201, v201 row_shr:1 row_mask:0xf bank_mask:0xf bound_ctrl:0
    s_nop 0
    v_add_u32_dpp v203, v203, v203 row_shr:1 row_mask:0xf bank_mask:0xf bound_ctrl:0
    v_add_u32_dpp v201, v201, v201 row_shr:2 row_mask:0xf bank_mask:0xf bound_ctrl:0
    s_nop 0
    v_add_u32_dpp v203, v203, v203 row_shr:2 row_mask:0xf bank_mask:0xf bound_ctrl:0
    v_add_u32_dpp v201, v201, v201 row_shr:4 row_mask:0xf bank_mask:0xf bound_ctrl:0
    s_nop 0
    v_add_u32_dpp v203, v203, v203 row_shr:4 row_mask:0xf bank_mask:0xf bound_ctrl:0
    v_add_u32_dpp v201, v201, v201 row_shr:8 row_mask:0xf bank_mask:0xf bound_ctrl:0
    s_nop 0
    v_add_u32_dpp v203, v203, v203 row_shr:8 row_mask:0xf bank_mask:0xf bound_ctrl:0
    v_add_u32_dpp v201, v201, v201 row_bcast:15 row_mask:0xa bank_mask:0xf
    s_nop 0
    v_add_u32_dpp v203, v203, v203 row_bcast:15 row_mask:0xa bank_mask:0xf
    v_add_u32_dpp v201, v201, v201 row_bcast:31 row_mask:0xc bank_mask:0xf
    s_nop 0
    v_add_u32_dpp v203, v203, v203 row_bcast:31 row_mask:0xc bank_mask:0xf
    s_mov_b32 exec_lo, 0
    s_brev_b32 exec_hi, 1
    buffer_store_dwordx2 v[200:201], v254, s[84:87], s10 offen offset:0 sc1
    s_mov_b64 exec, -1
    s_mov_b32 exec_lo, 0
    s_brev_b32 exec_hi, 1
    buffer_store_dwordx2 v[202:203], v254, s[84:87], s10 offen offset:128 sc1
    s_mov_b64 exec, -1
    s_sub_u32 s8, s12, 56
    s_cmp_ge_u32 s8, 112
    s_cbranch_scc1 L_g2l
    v_lshrrev_b32 v234, 3, v255
    v_min_u32 v235, 2, v234
    v_mul_u32_u24 v234, 21504, v234
    v_mul_u32_u24 v235, 21504, v235
    v_and_b32_e64 v238, 7, v255
    v_lshl_add_u32 v234, v238, 4, v234
    v_lshl_add_u32 v235, v238, 4, v235
    s_lshl_b32 s8, s12, 7
    s_nop 0
    s_add_u32 s8, s8, 524288
    buffer_load_dwordx4 v[228:231], v234, s[84:87], s8 offen sc1
    s_add_u32 s8, s8, 172032
    buffer_load_dwordx4 v[236:239], v234, s[84:87], s8 offen sc1
    s_add_u32 s8, s8, 172032
    buffer_load_dwordx4 v[248:251], v235, s[84:87], s8 offen sc1
L_g2l:
    s_lshr_b32 s8, s7, 1
    s_lshl_b32 s8, s8, 7
    s_lshl_b32 s10, s3, 10
    s_mul_i32 s9, s3, 7168
    s_add_u32 s8, s8, s9
    s_cmp_ge_u32 s7, 14
    s_cselect_b32 s8, 0x4000000, s8
    v_lshrrev_b32 v247, 3, v255
    v_bfe_u32 v245, v255, 4, 1
    v_lshlrev_b32 v245, 2, v245
    v_and_b32 v244, 7, v255
    v_xor_b32_e64 v245, v245, v244
    v_mul_u32_u24 v247, 896, v247
    v_lshl_add_u32 v247, v245, 4, v247
    v_lshrrev_b32_e64 v222, 5, v255
    v_bfe_u32 v223, v255, 4, 1
    v_bfe_u32 v224, v255, 2, 2
    v_and_b32_e64 v225, 3, v255
    v_lshl_add_u32 v222, v222, 3, v224
    v_lshlrev_b32_e64 v222, 6, v222
    v_lshl_add_u32 v222, v223, 5, v222
    v_lshl_add_u32 v222, v225, 3, v222
    v_add_u32 v222, 114688, v222
    ds_read_b64_tr_b16 a[48:49], v222 offset:8192
    ds_read_b64_tr_b16 a[50:51], v222 offset:8448
    ds_read_b64_tr_b16 a[52:53], v222 offset:9216
    ds_read_b64_tr_b16 a[54:55], v222 offset:9472
    ds_read_b64_tr_b16 a[56:57], v222 offset:10240
    ds_read_b64_tr_b16 a[58:59], v222 offset:10496
    ds_read_b64_tr_b16 a[60:61], v222 offset:11264
    ds_read_b64_tr_b16 a[62:63], v222 offset:11520
    s_waitcnt lgkmcnt(6)
    v_mfma_f32_32x32x16_bf16 v[112:127], a[48:51], v[0:3], 0
    ds_read_b64_tr_b16 a[64:65], v222 offset:12288
    ds_read_b64_tr_b16 a[66:67], v222 offset:12544
    s_add_u32 m0, s10, 0
    s_add_u32 s15, s8, 0
    buffer_load_dwordx4 v247, s[56:59], s15 offen  lds
    s_waitcnt lgkmcnt(6)
    v_mfma_f32_32x32x16_bf16 v[112:127], a[52:55], v[4:7], v[112:127]
    ds_read_b64_tr_b16 a[68:69], v222 offset:13312
    ds_read_b64_tr_b16 a[70:71], v222 offset:13568
    s_add_u32 m0, s10, 2048
    s_add_u32 s15, s8, 14336
    buffer_load_dwordx4 v247, s[56:59], s15 offen  lds
    s_waitcnt lgkmcnt(6)
    s_nop 0
    v_mfma_f32_32x32x16_bf16 v[112:127], a[56:59], v[8:11], v[112:127]
    ds_read_b64_tr_b16 a[48:49], v222 offset:14336
    ds_read_b64_tr_b16 a[50:51], v222 offset:14592
    s_add_u32 m0, s10, 4096
    s_add_u32 s15, s8, 28672
    buffer_load_dwordx4 v247, s[56:59], s15 offen  lds
    s_waitcnt lgkmcnt(6)
    s_nop 0
    v_mfma_f32_32x32x16_bf16 v[112:127], a[60:63], v[12:15], v[112:127]
    ds_read_b64_tr_b16 a[52:53], v222 offset:15360
    ds_read_b64_tr_b16 a[54:55], v222 offset:15616
    s_add_u32 m0, s10, 6144
    s_add_u32 s15, s8, 43008
    buffer_load_dwordx4 v247, s[56:59], s15 offen  lds
    s_waitcnt lgkmcnt(6)
    s_nop 0
    v_mfma_f32_32x32x16_bf16 v[112:127], a[64:67], v[16:19], v[112:127]
    ds_read_b64_tr_b16 a[56:57], v222 offset:16384
    ds_read_b64_tr_b16 a[58:59], v222 offset:16640
    s_add_u32 m0, s10, 8192
    s_add_u32 s15, s8, 57344
    buffer_load_dwordx4 v247, s[56:59], s15 offen  lds
    s_waitcnt lgkmcnt(6)
    s_nop 0
    v_mfma_f32_32x32x16_bf16 v[112:127], a[68:71], v[20:23], v[112:127]
    ds_read_b64_tr_b16 a[60:61], v222 offset:17408
    ds_read_b64_tr_b16 a[62:63], v222 offset:17664
    s_add_u32 m0, s10, 10240
    s_add_u32 s15, s8, 71680
    buffer_load_dwordx4 v247, s[56:59], s15 offen  lds
    s_waitcnt lgkmcnt(6)
    s_nop 0
    v_mfma_f32_32x32x16_bf16 v[112:127], a[48:51], v[24:27], v[112:127]
    ds_read_b64_tr_b16 a[64:65], v222 offset:18432
    ds_read_b64_tr_b16 a[66:67], v222 offset:18688
    s_add_u32 m0, s10, 12288
    s_add_u32 s15, s8, 86016
    buffer_load_dwordx4 v247, s[56:59], s15 offen  lds
    s_waitcnt lgkmcnt(6)
    s_nop 0
    v_mfma_f32_32x32x16_bf16 v[112:127], a[52:55], v[28:31], v[112:127]
    ds_read_b64_tr_b16 a[68:69], v222 offset:19456
    ds_read_b64_tr_b16 a[70:71], v222 offset:19712
    s_add_u32 m0, s10, 14336
    s_add_u32 s15, s8, 100352
    buffer_load_dwordx4 v247, s[56:59], s15 offen  lds
    s_waitcnt lgkmcnt(6)
    s_nop 0
    v_mfma_f32_32x32x16_bf16 v[112:127], a[56:59], v[32:35], v[112:127]
    ds_read_b64_tr_b16 a[48:49], v222 offset:20480
    ds_read_b64_tr_b16 a[50:51], v222 offset:20736
    s_add_u32 m0, s10, 16384
    s_add_u32 s15, s8, 114688
    buffer_load_dwordx4 v247, s[56:59], s15 offen  lds
    s_waitcnt lgkmcnt(6)
    s_nop 0
    v_mfma_f32_32x32x16_bf16 v[112:127], a[60:63], v[36:39], v[112:127]
    ds_read_b64_tr_b16 a[52:53], v222 offset:21504
    ds_read_b64_tr_b16 a[54:55], v222 offset:21760
    s_add_u32 m0, s10, 18432
    s_add_u32 s15, s8, 129024
    buffer_load_dwordx4 v247, s[56:59], s15 offen  lds
    s_waitcnt lgkmcnt(6)
    s_nop 0
    v_mfma_f32_32x32x16_bf16 v[112:127], a[64:67], v[40:43], v[112:127]
    ds_read_b64_tr_b16 a[56:57], v222 offset:22528
    ds_read_b64_tr_b16 a[58:59], v222 offset:22784
    s_add_u32 m0, s10, 20480
    s_add_u32 s15, s8, 143360
    buffer_load_dwordx4 v247, s[56:59], s15 offen  lds
    s_waitcnt lgkmcnt(6)
    s_nop 0
    v_mfma_f32_32x32x16_bf16 v[112:127], a[68:71], v[44:47], v[112:127]
    ds_read_b64_tr_b16 a[60:61], v222 offset:23552
    ds_read_b64_tr_b16 a[62:63], v222 offset:23808
    s_add_u32 m0, s10, 22528
    s_add_u32 s15, s8, 157696
    buffer_load_dwordx4 v247, s[56:59], s15 offen  lds
    s_waitcnt lgkmcnt(6)
    s_nop 0
    v_mfma_f32_32x32x16_bf16 v[112:127], a[48:51], v[48:51], v[112:127]
    ds_read_b64_tr_b16 a[64:65], v222 offset:24576
    ds_read_b64_tr_b16 a[66:67], v222 offset:24832
    s_add_u32 m0, s10, 24576
    s_add_u32 s15, s8, 172032
    buffer_load_dwordx4 v247, s[56:59], s15 offen  lds
    s_waitcnt lgkmcnt(6)
    s_nop 0
    v_mfma_f32_32x32x16_bf16 v[112:127], a[52:55], v[52:55], v[112:127]
    ds_read_b64_tr_b16 a[68:69], v222 offset:25600
    ds_read_b64_tr_b16 a[70:71], v222 offset:25856
    s_add_u32 m0, s10, 26624
    s_add_u32 s15, s8, 186368
    buffer_load_dwordx4 v247, s[56:59], s15 offen  lds
    s_waitcnt lgkmcnt(6)
    s_nop 0
    v_mfma_f32_32x32x16_bf16 v[112:127], a[56:59], v[56:59], v[112:127]
    ds_read_b64_tr_b16 a[48:49], v222 offset:26624
    ds_read_b64_tr_b16 a[50:51], v222 offset:26880
    s_add_u32 m0, s10, 28672
    s_add_u32 s15, s8, 200704
    buffer_load_dwordx4 v247, s[56:59], s15 offen  lds
    s_waitcnt lgkmcnt(6)
    s_nop 0
    v_mfma_f32_32x32x16_bf16 v[112:127], a[60:63], v[60:63], v[112:127]
    ds_read_b64_tr_b16 a[52:53], v222 offset:27648
    ds_read_b64_tr_b16 a[54:55], v222 offset:27904
    s_add_u32 m0, s10, 30720
    s_add_u32 s15, s8, 215040
    buffer_load_dwordx4 v247, s[56:59], s15 offen  lds
    s_waitcnt lgkmcnt(6)
    s_nop 0
    v_mfma_f32_32x32x16_bf16 v[112:127], a[64:67], v[64:67], v[112:127]
    ds_read_b64_tr_b16 a[56:57], v222 offset:28672
    ds_read_b64_tr_b16 a[58:59], v222 offset:28928
    s_add_u32 m0, s10, 32768
    s_add_u32 s15, s8, 229376
    buffer_load_dwordx4 v247, s[56:59], s15 offen  lds
    s_waitcnt lgkmcnt(6)
    s_nop 0
    v_mfma_f32_32x32x16_bf16 v[112:127], a[68:71], v[68:71], v[112:127]
    ds_read_b64_tr_b16 a[60:61], v222 offset:29696
    ds_read_b64_tr_b16 a[62:63], v222 offset:29952
    s_add_u32 m0, s10, 34816
    s_add_u32 s15, s8, 243712
    buffer_load_dwordx4 v247, s[56:59], s15 offen  lds
    s_waitcnt lgkmcnt(6)
    s_nop 0
    v_mfma_f32_32x32x16_bf16 v[112:127], a[48:51], v[72:75], v[112:127]
    ds_read_b64_tr_b16 a[64:65], v222 offset:30720
    ds_read_b64_tr_b16 a[66:67], v222 offset:30976
    s_add_u32 m0, s10, 36864
    s_add_u32 s15, s8, 258048
    buffer_load_dwordx4 v247, s[56:59], s15 offen  lds
    s_waitcnt lgkmcnt(6)
    s_nop 0
    v_mfma_f32_32x32x16_bf16 v[112:127], a[52:55], v[76:79], v[112:127]
    ds_read_b64_tr_b16 a[68:69], v222 offset:31744
    ds_read_b64_tr_b16 a[70:71], v222 offset:32000
    s_add_u32 m0, s10, 38912
    s_add_u32 s15, s8, 272384
    buffer_load_dwordx4 v247, s[56:59], s15 offen  lds
    s_waitcnt lgkmcnt(6)
    s_nop 0
    v_mfma_f32_32x32x16_bf16 v[112:127], a[56:59], v[80:83], v[112:127]
    ds_read_b64_tr_b16 a[48:49], v222 offset:32768
    ds_read_b64_tr_b16 a[50:51], v222 offset:33024
    s_add_u32 m0, s10, 40960
    s_add_u32 s15, s8, 286720
    buffer_load_dwordx4 v247, s[56:59], s15 offen  lds
    s_waitcnt lgkmcnt(6)
    s_nop 0
    v_mfma_f32_32x32x16_bf16 v[112:127], a[60:63], v[84:87], v[112:127]
    ds_read_b64_tr_b16 a[52:53], v222 offset:33792
    ds_read_b64_tr_b16 a[54:55], v222 offset:34048
    s_add_u32 m0, s10, 43008
    s_add_u32 s15, s8, 301056
    buffer_load_dwordx4 v247, s[56:59], s15 offen  lds
    s_waitcnt lgkmcnt(6)
    s_nop 0
    v_mfma_f32_32x32x16_bf16 v[112:127], a[64:67], v[88:91], v[112:127]
    ds_read_b64_tr_b16 a[56:57], v222 offset:34816
    ds_read_b64_tr_b16 a[58:59], v222 offset:35072
    s_add_u32 m0, s10, 45056
    s_add_u32 s15, s8, 315392
    buffer_load_dwordx4 v247, s[56:59], s15 offen  lds
    s_waitcnt lgkmcnt(6)
    s_nop 0
    v_mfma_f32_32x32x16_bf16 v[112:127], a[68:71], v[92:95], v[112:127]
    ds_read_b64_tr_b16 a[60:61], v222 offset:35840
    ds_read_b64_tr_b16 a[62:63], v222 offset:36096
    s_add_u32 m0, s10, 47104
    s_add_u32 s15, s8, 329728
    buffer_load_dwordx4 v247, s[56:59], s15 offen  lds
    s_waitcnt lgkmcnt(6)
    v_mfma_f32_32x32x16_bf16 v[112:127], a[48:51], v[96:99], v[112:127]
    s_add_u32 m0, s10, 49152
    s_add_u32 s15, s8, 344064
    buffer_load_dwordx4 v247, s[56:59], s15 offen  lds
    s_waitcnt lgkmcnt(4)
    v_mfma_f32_32x32x16_bf16 v[112:127], a[52:55], v[100:103], v[112:127]
    s_add_u32 m0, s10, 51200
    s_add_u32 s15, s8, 358400
    buffer_load_dwordx4 v247, s[56:59], s15 offen  lds
    s_waitcnt lgkmcnt(2)
    v_mfma_f32_32x32x16_bf16 v[112:127], a[56:59], v[104:107], v[112:127]
    s_add_u32 m0, s10, 53248
    s_add_u32 s15, s8, 372736
    buffer_load_dwordx4 v247, s[56:59], s15 offen  lds
    s_waitcnt lgkmcnt(0)
    v_mfma_f32_32x32x16_bf16 v[112:127], a[60:63], v[108:111], v[112:127]
    s_add_u32 m0, s10, 55296
    s_add_u32 s15, s8, 387072
    buffer_load_dwordx4 v247, s[56:59], s15 offen  lds
    s_sub_u32 s8, s12, 56
    s_cmp_ge_u32 s8, 112
    s_cbranch_scc1 L_kv_j
    s_waitcnt vmcnt(28)
L_g2bl:
    v_xor_b32 v229, s88, v229
    v_xor_b32 v231, s88, v231
    v_xor_b32 v237, s88, v237
    v_xor_b32 v239, s88, v239
    v_xor_b32 v249, s88, v249
    v_xor_b32_e64 v251, s88, v251
    v_or3_b32 v229, v229, v231, v237
    v_or3_b32 v239, v239, v249, v251
    v_or_b32_e64 v229, v229, v239
    v_cmp_ne_u32 vcc, 0, v229
    s_add_u32 s95, s95, 1
    s_cmp_gt_u32 s95, 200000
    s_cbranch_scc1 L_g2xb
    s_cbranch_vccz L_g2xb
    s_lshl_b32 s8, s12, 7
    s_nop 0
    s_add_u32 s8, s8, 524288
    buffer_load_dwordx4 v[228:231], v234, s[84:87], s8 offen sc1
    s_add_u32 s8, s8, 172032
    buffer_load_dwordx4 v[236:239], v234, s[84:87], s8 offen sc1
    s_add_u32 s8, s8, 172032
    buffer_load_dwordx4 v[248:251], v235, s[84:87], s8 offen sc1
    s_waitcnt vmcnt(0)
    s_branch L_g2bl
L_g2xb:
    v_add_f32 v228, v228, v236
    v_add_f32 v230, v230, v238
    s_mov_b64 exec, 0xffffff
    v_add_f32 v228, v228, v248
    v_add_f32_e64 v230, v230, v250
    s_mov_b64 exec, -1
    s_mov_b32 s8, 0
    s_sub_u32 s9, s12, 28
    s_cmp_lt_u32 s9, 28
    s_cselect_b32 s8, 1.0, s8
    s_sub_u32 s9, s12, 112
    s_cmp_lt_u32 s9, 28
    s_cselect_b32 s8, 1.0, s8
    v_permlane32_swap_b32 v228, v230
    v_add_f32 v228, v228, v230
    v_mov_b32 v230, v228
    s_nop 1
    v_permlane16_swap_b32 v228, v230
    v_add_f32_e64 v228, v228, v230
    s_nop 1
    v_add_f32_dpp v228, v228, v228 row_ror:8 row_mask:0xf bank_mask:0xf
    v_mov_b32 v230, v228
    s_nop 1
    v_permlane32_swap_b32_e64 v228, v230
    v_cvt_pk_bf16_f32 v236, v228, v230
    v_lshlrev_b32 v228, 16, v236
    v_and_b32 v230, s100, v236
    v_add_f32 v228, s8, v228
    v_add_f32 v230, s8, v230
    v_cvt_pk_bf16_f32 v236, v228, v230
    v_mov_b32 v237, s88
    v_lshlrev_b32_e64 v238, 3, v255
    s_lshl_b32 s9, s12, 6
    s_add_u32 s9, s9, 4096
    s_mov_b64 exec, 0xff
    buffer_store_dwordx2 v[236:237], v238, s[84:87], s9 offen sc1
    s_mov_b64 exec, -1
    s_branch L_kv_j
L_kv_skip:
    s_mov_b32 s11, 0x4000000
    v_lshrrev_b32_e64 v240, 5, v255
    v_bfe_u32 v241, v255, 4, 1
    v_bfe_u32 v242, v255, 2, 2
    v_and_b32_e64 v243, 3, v255
    v_mul_u32_u24 v217, 224, v242
    v_lshl_add_u32 v217, v240, 10, v217
    v_lshl_add_u32 v217, v241, 12, v217
    v_lshl_add_u32 v217, v243, 3, v217
    v_add_u32_e64 v217, s0, v217
    v_lshl_add_u32 v240, v240, 2, v242
    v_lshlrev_b32_e64 v240, 7, v240
    v_lshl_add_u32 v240, v241, 5, v240
    v_lshl_add_u32 v240, v243, 3, v240
    v_add_u32 v240, s0, v240
    v_lshrrev_b32 v242, 1, v242
    v_lshl_add_u32 v241, v242, 6, v240
    v_xor_b32_e64 v242, 1, v242
    v_lshl_add_u32 v242, v242, 6, v240
    s_mul_i32 s8, s4, 196
    s_lshl_b32 s9, s5, 1
    s_add_u32 s9, s9, s3
    s_sub_u32 s9, s9, 2
    s_add_u32 s8, s8, s9
    s_lshl_b32 s8, s8, 10
    s_add_u32 s8, s8, 6291456
    s_lshl_b32 s9, s9, 2
    s_lshl_b32 s2, s4, 7
    s_add_u32 s2, s2, s9
    s_add_u32 s2, s2, 118784
    s_cmp_ge_u32 s5, 14
    s_cselect_b32 s2, 0x4000000, s2
    s_cselect_b32 s8, 0x4000000, s8
    s_waitcnt vmcnt(0)
    ds_read_b64_tr_b16 a[104:105], v217 offset:0
    ds_read_b64_tr_b16 a[106:107], v217 offset:2048
    ds_read_b64_tr_b16 a[108:109], v217 offset:32
    ds_read_b64_tr_b16 a[110:111], v217 offset:2080
    ds_read_b64_tr_b16 a[112:113], v217 offset:64
    ds_read_b64_tr_b16 a[114:115], v217 offset:2112
    ds_read_b64_tr_b16 a[116:117], v217 offset:96
    ds_read_b64_tr_b16 a[118:119], v217 offset:2144
    ds_read_b64_tr_b16 a[120:121], v217 offset:128
    ds_read_b64_tr_b16 a[122:123], v217 offset:2176
    ds_read_b64_tr_b16 a[124:125], v217 offset:160
    ds_read_b64_tr_b16 a[126:127], v217 offset:2208
    ds_read_b64_tr_b16 a[128:129], v217 offset:192
    ds_read_b64_tr_b16 a[130:131], v217 offset:2240
    ds_read_b64_tr_b16 a[132:133], v241 offset:8192
    ds_read_b64_tr_b16 a[134:135], v241 offset:9216
    ds_read_b64_tr_b16 a[136:137], v242 offset:8192
    ds_read_b64_tr_b16 a[138:139], v242 offset:9216
    ds_read_b64_tr_b16 a[140:141], v241 offset:10240
    ds_read_b64_tr_b16 a[142:143], v241 offset:11264
    ds_read_b64_tr_b16 a[144:145], v242 offset:10240
    ds_read_b64_tr_b16 a[146:147], v242 offset:11264
    s_waitcnt lgkmcnt(8)
    s_nop 0
    buffer_store_dwordx4 a[104:107], v246, s[84:87], s8 offen sc1
    s_add_u32 s8, s8, 28672
    buffer_store_dwordx4 a[108:111], v246, s[84:87], s8 offen sc1
    s_add_u32 s8, s8, 28672
    buffer_store_dwordx4 a[112:115], v246, s[84:87], s8 offen sc1
    s_add_u32 s8, s8, 28672
    buffer_store_dwordx4 a[116:119], v246, s[84:87], s8 offen sc1
    s_add_u32 s8, s8, 28672
    buffer_store_dwordx4 a[120:123], v246, s[84:87], s8 offen sc1
    s_add_u32 s8, s8, 28672
    buffer_store_dwordx4 a[124:127], v246, s[84:87], s8 offen sc1
    s_add_u32 s8, s8, 28672
    buffer_store_dwordx4 a[128:131], v246, s[84:87], s8 offen sc1
    s_cmp_ge_u32 s7, 14
    s_cbranch_scc1 L_ps
    s_cmp_ge_u32 s6, 14
    s_cbranch_scc1 L_ps
    s_lshl_b32 s8, s6, 1
    s_and_b32 s9, s7, 1
    s_add_u32 s8, s8, s9
    s_lshl_b32 s8, s8, 1
    s_add_u32 s8, s8, s3
    s_sub_u32 s8, s8, 2
    s_lshr_b32 s9, s7, 1
    s_lshl_b32 s11, s9, 6
    s_add_u32 s11, s11, s8
    s_lshl_b32 s11, s11, 2
    s_add_u32 s11, s11, 122880
    s_lshl_b32 s8, s8, 12
    s_mul_i32 s9, s9, 229376
    s_add_u32 s8, s8, s9
    s_add_u32 s8, s8, 9699328
    s_waitcnt lgkmcnt(0)
    buffer_store_dwordx4 a[132:135], v246, s[84:87], s8 offen offset:0 sc1
    buffer_store_dwordx4 a[136:139], v246, s[84:87], s8 offen offset:1024 sc1
    buffer_store_dwordx4 a[140:143], v246, s[84:87], s8 offen offset:2048 sc1
    buffer_store_dwordx4 a[144:147], v246, s[84:87], s8 offen offset:3072 sc1
L_ps:
    s_waitcnt lgkmcnt(0)
    v_lshrrev_b32_e64 v222, 5, v255
    v_bfe_u32 v223, v255, 4, 1
    v_bfe_u32 v224, v255, 2, 2
    v_and_b32_e64 v225, 3, v255
    v_lshl_add_u32 v222, v222, 3, v224
    v_lshlrev_b32_e64 v222, 6, v222
    v_lshl_add_u32 v222, v223, 5, v222
    v_lshl_add_u32 v222, v225, 3, v222
    v_add_u32 v222, 114688, v222
    ds_read_b64_tr_b16 a[48:49], v222 offset:8192
    ds_read_b64_tr_b16 a[50:51], v222 offset:8448
    ds_read_b64_tr_b16 a[52:53], v222 offset:9216
    ds_read_b64_tr_b16 a[54:55], v222 offset:9472
    ds_read_b64_tr_b16 a[56:57], v222 offset:10240
    ds_read_b64_tr_b16 a[58:59], v222 offset:10496
    ds_read_b64_tr_b16 a[60:61], v222 offset:11264
    ds_read_b64_tr_b16 a[62:63], v222 offset:11520
    s_waitcnt lgkmcnt(6)
    v_mfma_f32_32x32x16_bf16 v[112:127], a[48:51], v[0:3], 0
    ds_read_b64_tr_b16 a[64:65], v222 offset:12288
    ds_read_b64_tr_b16 a[66:67], v222 offset:12544
    s_waitcnt lgkmcnt(6)
    v_mfma_f32_32x32x16_bf16 v[112:127], a[52:55], v[4:7], v[112:127]
    ds_read_b64_tr_b16 a[68:69], v222 offset:13312
    ds_read_b64_tr_b16 a[70:71], v222 offset:13568
    s_waitcnt lgkmcnt(6)
    v_mfma_f32_32x32x16_bf16 v[112:127], a[56:59], v[8:11], v[112:127]
    ds_read_b64_tr_b16 a[48:49], v222 offset:14336
    ds_read_b64_tr_b16 a[50:51], v222 offset:14592
    s_waitcnt lgkmcnt(6)
    v_mfma_f32_32x32x16_bf16 v[112:127], a[60:63], v[12:15], v[112:127]
    ds_read_b64_tr_b16 a[52:53], v222 offset:15360
    ds_read_b64_tr_b16 a[54:55], v222 offset:15616
    s_waitcnt lgkmcnt(6)
    v_mfma_f32_32x32x16_bf16 v[112:127], a[64:67], v[16:19], v[112:127]
    ds_read_b64_tr_b16 a[56:57], v222 offset:16384
    ds_read_b64_tr_b16 a[58:59], v222 offset:16640
    s_waitcnt lgkmcnt(6)
    v_mfma_f32_32x32x16_bf16 v[112:127], a[68:71], v[20:23], v[112:127]
    ds_read_b64_tr_b16 a[60:61], v222 offset:17408
    ds_read_b64_tr_b16 a[62:63], v222 offset:17664
    s_waitcnt lgkmcnt(6)
    v_mfma_f32_32x32x16_bf16 v[112:127], a[48:51], v[24:27], v[112:127]
    ds_read_b64_tr_b16 a[64:65], v222 offset:18432
    ds_read_b64_tr_b16 a[66:67], v222 offset:18688
    s_waitcnt lgkmcnt(6)
    v_mfma_f32_32x32x16_bf16 v[112:127], a[52:55], v[28:31], v[112:127]
    ds_read_b64_tr_b16 a[68:69], v222 offset:19456
    ds_read_b64_tr_b16 a[70:71], v222 offset:19712
    s_waitcnt lgkmcnt(6)
    v_mfma_f32_32x32x16_bf16 v[112:127], a[56:59], v[32:35], v[112:127]
    ds_read_b64_tr_b16 a[48:49], v222 offset:20480
    ds_read_b64_tr_b16 a[50:51], v222 offset:20736
    s_waitcnt lgkmcnt(6)
    v_mfma_f32_32x32x16_bf16 v[112:127], a[60:63], v[36:39], v[112:127]
    ds_read_b64_tr_b16 a[52:53], v222 offset:21504
    ds_read_b64_tr_b16 a[54:55], v222 offset:21760
    s_waitcnt lgkmcnt(6)
    v_mfma_f32_32x32x16_bf16 v[112:127], a[64:67], v[40:43], v[112:127]
    ds_read_b64_tr_b16 a[56:57], v222 offset:22528
    ds_read_b64_tr_b16 a[58:59], v222 offset:22784
    s_waitcnt lgkmcnt(6)
    v_mfma_f32_32x32x16_bf16 v[112:127], a[68:71], v[44:47], v[112:127]
    ds_read_b64_tr_b16 a[60:61], v222 offset:23552
    ds_read_b64_tr_b16 a[62:63], v222 offset:23808
    s_waitcnt lgkmcnt(6)
    v_mfma_f32_32x32x16_bf16 v[112:127], a[48:51], v[48:51], v[112:127]
    ds_read_b64_tr_b16 a[64:65], v222 offset:24576
    ds_read_b64_tr_b16 a[66:67], v222 offset:24832
    s_waitcnt lgkmcnt(6)
    v_mfma_f32_32x32x16_bf16 v[112:127], a[52:55], v[52:55], v[112:127]
    ds_read_b64_tr_b16 a[68:69], v222 offset:25600
    ds_read_b64_tr_b16 a[70:71], v222 offset:25856
    s_waitcnt lgkmcnt(6)
    v_mfma_f32_32x32x16_bf16 v[112:127], a[56:59], v[56:59], v[112:127]
    ds_read_b64_tr_b16 a[48:49], v222 offset:26624
    ds_read_b64_tr_b16 a[50:51], v222 offset:26880
    s_waitcnt lgkmcnt(6)
    v_mfma_f32_32x32x16_bf16 v[112:127], a[60:63], v[60:63], v[112:127]
    ds_read_b64_tr_b16 a[52:53], v222 offset:27648
    ds_read_b64_tr_b16 a[54:55], v222 offset:27904
    s_waitcnt lgkmcnt(6)
    v_mfma_f32_32x32x16_bf16 v[112:127], a[64:67], v[64:67], v[112:127]
    ds_read_b64_tr_b16 a[56:57], v222 offset:28672
    ds_read_b64_tr_b16 a[58:59], v222 offset:28928
    s_waitcnt lgkmcnt(6)
    v_mfma_f32_32x32x16_bf16 v[112:127], a[68:71], v[68:71], v[112:127]
    ds_read_b64_tr_b16 a[60:61], v222 offset:29696
    ds_read_b64_tr_b16 a[62:63], v222 offset:29952
    s_waitcnt lgkmcnt(6)
    v_mfma_f32_32x32x16_bf16 v[112:127], a[48:51], v[72:75], v[112:127]
    ds_read_b64_tr_b16 a[64:65], v222 offset:30720
    ds_read_b64_tr_b16 a[66:67], v222 offset:30976
    s_waitcnt lgkmcnt(6)
    v_mfma_f32_32x32x16_bf16 v[112:127], a[52:55], v[76:79], v[112:127]
    ds_read_b64_tr_b16 a[68:69], v222 offset:31744
    ds_read_b64_tr_b16 a[70:71], v222 offset:32000
    s_waitcnt lgkmcnt(6)
    v_mfma_f32_32x32x16_bf16 v[112:127], a[56:59], v[80:83], v[112:127]
    ds_read_b64_tr_b16 a[48:49], v222 offset:32768
    ds_read_b64_tr_b16 a[50:51], v222 offset:33024
    s_waitcnt lgkmcnt(6)
    v_mfma_f32_32x32x16_bf16 v[112:127], a[60:63], v[84:87], v[112:127]
    ds_read_b64_tr_b16 a[52:53], v222 offset:33792
    ds_read_b64_tr_b16 a[54:55], v222 offset:34048
    s_waitcnt lgkmcnt(6)
    v_mfma_f32_32x32x16_bf16 v[112:127], a[64:67], v[88:91], v[112:127]
    ds_read_b64_tr_b16 a[56:57], v222 offset:34816
    ds_read_b64_tr_b16 a[58:59], v222 offset:35072
    s_waitcnt lgkmcnt(6)
    v_mfma_f32_32x32x16_bf16 v[112:127], a[68:71], v[92:95], v[112:127]
    ds_read_b64_tr_b16 a[60:61], v222 offset:35840
    ds_read_b64_tr_b16 a[62:63], v222 offset:36096
    s_waitcnt lgkmcnt(6)
    v_mfma_f32_32x32x16_bf16 v[112:127], a[48:51], v[96:99], v[112:127]
    s_waitcnt lgkmcnt(4)
    v_mfma_f32_32x32x16_bf16 v[112:127], a[52:55], v[100:103], v[112:127]
    s_waitcnt lgkmcnt(2)
    v_mfma_f32_32x32x16_bf16 v[112:127], a[56:59], v[104:107], v[112:127]
    s_waitcnt lgkmcnt(0)
    v_mfma_f32_32x32x16_bf16 v[112:127], a[60:63], v[108:111], v[112:127]
L_kv_j:
    s_nop 11
    s_nop 0
    v_cvt_pk_bf16_f32 v128, v112, v113
    v_cvt_pk_bf16_f32 v129, v114, v115
    v_cvt_pk_bf16_f32 v130, v116, v117
    v_cvt_pk_bf16_f32 v131, v118, v119
    v_cvt_pk_bf16_f32 v132, v120, v121
    v_cvt_pk_bf16_f32 v133, v122, v123
    v_cvt_pk_bf16_f32 v134, v124, v125
    v_cvt_pk_bf16_f32 v135, v126, v127
    v_mfma_f32_32x32x16_bf16 v[136:151], a[96:99], v[128:131], 0
    s_nop 0
    v_mfma_f32_32x32x16_bf16 v[136:151], a[100:103], v[132:135], v[136:151]
    s_mov_b64 exec, s[98:99]
    s_nop 10
    v_mov_b32 v148, v144
    v_mov_b32 v149, v145
    v_mov_b32 v150, v146
    v_mov_b32 v151, v147
    s_mov_b64 exec, -1
    v_max3_f32 v208, v136, v137, v138
    v_max3_f32 v210, -v136, -v137, -v138
    v_max3_f32 v208, v208, v139, v140
    v_max3_f32 v210, v210, -v139, -v140
    v_max3_f32 v208, v208, v141, v142
    v_max3_f32 v210, v210, -v141, -v142
    v_max3_f32 v208, v208, v143, v144
    v_max3_f32 v210, v210, -v143, -v144
    v_max3_f32 v208, v208, v145, v146
    v_max3_f32 v210, v210, -v145, -v146
    v_max3_f32 v208, v208, v147, v148
    v_max3_f32 v210, v210, -v147, -v148
    v_max3_f32 v208, v208, v149, v150
    v_max3_f32 v210, v210, -v149, -v150
    v_max_f32_e64 v208, v208, v151
    v_max_f32_e64 v210, v210, -v151
    s_nop 1
    v_permlane32_swap_b32 v208, v210
    v_max_f32 v208, v208, v210
    v_mov_b32 v210, v208
    s_nop 1
    v_permlane32_swap_b32 v208, v210
    v_mul_f32_e64 v208, -v208, s96
    v_mul_f32_e64 v210, -v210, s96
    v_pk_fma_f32 v[152:153], v[136:137], s[96:97], v[208:209] op_sel_hi:[1,1,0]
    v_pk_fma_f32 v[176:177], v[136:137], s[96:97], v[210:211] op_sel_hi:[1,1,0] neg_lo:[1,0,0] neg_hi:[1,0,0]
    v_pk_fma_f32 v[154:155], v[138:139], s[96:97], v[208:209] op_sel_hi:[1,1,0]
    v_pk_fma_f32 v[178:179], v[138:139], s[96:97], v[210:211] op_sel_hi:[1,1,0] neg_lo:[1,0,0] neg_hi:[1,0,0]
    v_pk_fma_f32 v[156:157], v[140:141], s[96:97], v[208:209] op_sel_hi:[1,1,0]
    v_pk_fma_f32 v[180:181], v[140:141], s[96:97], v[210:211] op_sel_hi:[1,1,0] neg_lo:[1,0,0] neg_hi:[1,0,0]
    v_pk_fma_f32 v[158:159], v[142:143], s[96:97], v[208:209] op_sel_hi:[1,1,0]
    v_pk_fma_f32 v[182:183], v[142:143], s[96:97], v[210:211] op_sel_hi:[1,1,0] neg_lo:[1,0,0] neg_hi:[1,0,0]
    v_pk_fma_f32 v[160:161], v[144:145], s[96:97], v[208:209] op_sel_hi:[1,1,0]
    v_pk_fma_f32 v[184:185], v[144:145], s[96:97], v[210:211] op_sel_hi:[1,1,0] neg_lo:[1,0,0] neg_hi:[1,0,0]
    v_pk_fma_f32 v[162:163], v[146:147], s[96:97], v[208:209] op_sel_hi:[1,1,0]
    v_pk_fma_f32 v[186:187], v[146:147], s[96:97], v[210:211] op_sel_hi:[1,1,0] neg_lo:[1,0,0] neg_hi:[1,0,0]
    v_pk_fma_f32 v[164:165], v[148:149], s[96:97], v[208:209] op_sel_hi:[1,1,0]
    v_pk_fma_f32 v[188:189], v[148:149], s[96:97], v[210:211] op_sel_hi:[1,1,0] neg_lo:[1,0,0] neg_hi:[1,0,0]
    v_pk_fma_f32 v[166:167], v[150:151], s[96:97], v[208:209] op_sel_hi:[1,1,0]
    v_pk_fma_f32 v[190:191], v[150:151], s[96:97], v[210:211] op_sel_hi:[1,1,0] neg_lo:[1,0,0] neg_hi:[1,0,0]
    v_exp_f32 v152, v152
    v_exp_f32 v176, v176
    v_exp_f32 v153, v153
    v_exp_f32 v177, v177
    v_exp_f32 v154, v154
    v_exp_f32 v178, v178
    v_exp_f32 v155, v155
    v_exp_f32 v179, v179
    v_exp_f32 v156, v156
    v_exp_f32 v180, v180
    v_exp_f32 v157, v157
    v_exp_f32 v181, v181
    v_exp_f32 v158, v158
    v_exp_f32 v182, v182
    v_exp_f32 v159, v159
    v_exp_f32 v183, v183
    v_exp_f32 v160, v160
    v_exp_f32 v184, v184
    v_exp_f32 v161, v161
    v_exp_f32 v185, v185
    v_exp_f32 v162, v162
    v_exp_f32 v186, v186
    v_exp_f32 v163, v163
    v_exp_f32 v187, v187
    v_exp_f32 v164, v164
    v_exp_f32 v188, v188
    v_exp_f32 v165, v165
    v_exp_f32 v189, v189
    v_exp_f32 v166, v166
    v_exp_f32 v190, v190
    v_exp_f32 v167, v167
    v_exp_f32 v191, v191
    s_mov_b64 exec, s[98:99]
    v_mov_b32 v164, 0
    v_mov_b32 v188, 0
    v_mov_b32 v165, 0
    v_mov_b32 v189, 0
    v_mov_b32 v166, 0
    v_mov_b32 v190, 0
    v_mov_b32 v167, 0
    v_mov_b32 v191, 0
    s_mov_b64 exec, -1
    v_pk_add_f32 v[208:209], v[152:153], v[154:155]
    v_pk_add_f32 v[210:211], v[176:177], v[178:179]
    v_pk_add_f32 v[208:209], v[208:209], v[156:157]
    v_pk_add_f32 v[210:211], v[210:211], v[180:181]
    v_pk_add_f32 v[208:209], v[208:209], v[158:159]
    v_pk_add_f32 v[210:211], v[210:211], v[182:183]
    v_pk_add_f32 v[208:209], v[208:209], v[160:161]
    v_pk_add_f32 v[210:211], v[210:211], v[184:185]
    s_cmp_lt_u32 s3, 2
    s_cbranch_scc1 L_pfl
    s_waitcnt vmcnt(0)
    v_mov_b32_e64 v244, s93
    s_mov_b64 exec, 1
    buffer_store_dword v244, v254, s[84:87], s2 offen sc1
    s_mov_b64 exec, -1
    v_mov_b32_e64 v244, s93
    s_mov_b64 exec, 1
    buffer_store_dword v244, v254, s[84:87], s11 offen sc1
    s_mov_b64 exec, -1
L_pfl:
    s_nop 0
    v_pk_add_f32 v[208:209], v[208:209], v[162:163]
    v_pk_add_f32 v[210:211], v[210:211], v[186:187]
    v_pk_add_f32 v[208:209], v[208:209], v[164:165]
    v_pk_add_f32 v[210:211], v[210:211], v[188:189]
    v_pk_add_f32 v[208:209], v[208:209], v[166:167]
    v_pk_add_f32 v[210:211], v[210:211], v[190:191]
    v_add_f32 v208, v208, v209
    v_add_f32 v210, v210, v211
    s_nop 1
    v_permlane32_swap_b32 v208, v210
    v_add_f32 v208, v208, v210
    v_mov_b32 v210, v208
    s_nop 1
    v_permlane32_swap_b32 v208, v210
    v_rcp_f32 v208, v208
    v_rcp_f32 v210, v210
    v_pk_mul_f32 v[152:153], v[152:153], v[208:209] op_sel_hi:[1,0]
    v_pk_mul_f32 v[176:177], v[176:177], v[210:211] op_sel_hi:[1,0]
    v_pk_mul_f32 v[154:155], v[154:155], v[208:209] op_sel_hi:[1,0]
    v_pk_mul_f32 v[178:179], v[178:179], v[210:211] op_sel_hi:[1,0]
    v_pk_mul_f32 v[156:157], v[156:157], v[208:209] op_sel_hi:[1,0]
    v_pk_mul_f32 v[180:181], v[180:181], v[210:211] op_sel_hi:[1,0]
    v_pk_mul_f32 v[158:159], v[158:159], v[208:209] op_sel_hi:[1,0]
    v_pk_mul_f32 v[182:183], v[182:183], v[210:211] op_sel_hi:[1,0]
    v_pk_mul_f32 v[160:161], v[160:161], v[208:209] op_sel_hi:[1,0]
    v_pk_mul_f32 v[184:185], v[184:185], v[210:211] op_sel_hi:[1,0]
    v_pk_mul_f32 v[162:163], v[162:163], v[208:209] op_sel_hi:[1,0]
    v_pk_mul_f32 v[186:187], v[186:187], v[210:211] op_sel_hi:[1,0]
    v_pk_mul_f32 v[164:165], v[164:165], v[208:209] op_sel_hi:[1,0]
    v_pk_mul_f32 v[188:189], v[188:189], v[210:211] op_sel_hi:[1,0]
    v_pk_mul_f32 v[166:167], v[166:167], v[208:209] op_sel_hi:[1,0]
    v_pk_mul_f32 v[190:191], v[190:191], v[210:211] op_sel_hi:[1,0]
    v_cvt_pk_bf16_f32 v192, v152, v153
    v_cvt_pk_bf16_f32 v200, v176, v177
    v_cvt_pk_bf16_f32 v193, v154, v155
    v_cvt_pk_bf16_f32 v201, v178, v179
    v_cvt_pk_bf16_f32 v194, v156, v157
    v_cvt_pk_bf16_f32 v202, v180, v181
    v_cvt_pk_bf16_f32 v195, v158, v159
    v_cvt_pk_bf16_f32 v203, v182, v183
    v_cvt_pk_bf16_f32 v196, v160, v161
    v_cvt_pk_bf16_f32 v204, v184, v185
    v_cvt_pk_bf16_f32 v197, v162, v163
    v_cvt_pk_bf16_f32 v205, v186, v187
    v_cvt_pk_bf16_f32 v198, v164, v165
    v_cvt_pk_bf16_f32 v206, v188, v189
    v_cvt_pk_bf16_f32 v199, v166, v167
    v_cvt_pk_bf16_f32 v207, v190, v191
    s_lshl_b32 s12, s3, 10
    s_mul_i32 s1, s40, 200704
    s_add_u32 s1, s1, s12
    s_add_u32 s1, s1, 6291456
    s_lshr_b32 s8, s7, 1
    s_min_u32 s9, s8, 6
    s_mul_i32 s0, s9, 229376
    s_mul_i32 s9, s3, 57344
    s_add_u32 s0, s0, s9
    s_add_u32 s0, s0, 9699328
    s_and_b32 s9, s3, 1
    s_lshl_b32 s9, s9, 10
    s_add_u32 s0, s0, s9
    s_xor_b32 s72, s0, 1024
    s_mov_b32 s43, s1
    s_mov_b32 s49, 0
    s_add_u32 s42, s12, 65536
    s_mov_b32 s14, 21
    s_lshl_b32 s8, s4, 2
    s_add_u32 s8, s8, s3
    s_lshl_b32 s8, s8, 7
    s_add_u32 s8, s8, 16384
    v_lshlrev_b32 v244, 3, v255
    s_lshl_b32 s48, s40, 7
    s_add_u32 s48, s48, 118784
    v_min_u32 v252, 27, v255
    v_lshlrev_b32_e64 v252, 2, v252
    s_lshr_b32 s10, s7, 1
    s_min_u32 s10, s10, 6
    s_lshl_b32 s10, s10, 8
    s_add_u32 s50, s10, 122880
    v_min_u32 v242, 55, v255
    v_lshlrev_b32 v242, 2, v242
    s_lshl_b32 s2, s4, 16
    s_add_u32 s2, s2, s12
    s_add_u32 s2, s2, 1048576
    v_mov_b32_e64 v250, 0
    s_mov_b64 exec, 0xffff
P_7:
    buffer_load_dwordx2 v[248:249], v244, s[84:87], s8 offen sc1
    s_waitcnt vmcnt(0)
    v_cmp_ne_u32 vcc, s89, v248
    s_add_u32 s95, s95, 1
    s_cmp_gt_u32 s95, 200000
    s_cbranch_scc1 PX_8
    s_cbranch_vccz PX_8
    s_sleep 1
    s_branch P_7
PX_8:
    v_sub_u32 v250, v250, v249
    s_mov_b64 exec, -1
L_sa_retry:
    s_add_u32 s15, s2, 0
    buffer_load_dwordx4 v[0:3], v246, s[84:87], s15 offen sc1
    s_add_u32 s15, s2, 4096
    buffer_load_dwordx4 v[4:7], v246, s[84:87], s15 offen sc1
    s_add_u32 s15, s2, 8192
    buffer_load_dwordx4 v[8:11], v246, s[84:87], s15 offen sc1
    s_add_u32 s15, s2, 12288
    buffer_load_dwordx4 v[12:15], v246, s[84:87], s15 offen sc1
    s_add_u32 s15, s2, 16384
    buffer_load_dwordx4 v[16:19], v246, s[84:87], s15 offen sc1
    s_add_u32 s15, s2, 20480
    buffer_load_dwordx4 v[20:23], v246, s[84:87], s15 offen sc1
    s_add_u32 s15, s2, 24576
    buffer_load_dwordx4 v[24:27], v246, s[84:87], s15 offen sc1
    s_add_u32 s15, s2, 28672
    buffer_load_dwordx4 v[28:31], v246, s[84:87], s15 offen sc1
    s_add_u32 s15, s2, 32768
    buffer_load_dwordx4 v[32:35], v246, s[84:87], s15 offen sc1
    s_add_u32 s15, s2, 36864
    buffer_load_dwordx4 v[36:39], v246, s[84:87], s15 offen sc1
    s_add_u32 s15, s2, 40960
    buffer_load_dwordx4 v[40:43], v246, s[84:87], s15 offen sc1
    s_add_u32 s15, s2, 45056
    buffer_load_dwordx4 v[44:47], v246, s[84:87], s15 offen sc1
    s_add_u32 s15, s2, 49152
    buffer_load_dwordx4 v[48:51], v246, s[84:87], s15 offen sc1
    s_add_u32 s15, s2, 53248
    buffer_load_dwordx4 v[52:55], v246, s[84:87], s15 offen sc1
    s_add_u32 s15, s2, 57344
    buffer_load_dwordx4 v[56:59], v246, s[84:87], s15 offen sc1
    s_add_u32 s15, s2, 61440
    buffer_load_dwordx4 v[60:63], v246, s[84:87], s15 offen sc1
    buffer_load_dword v253, v252, s[84:87], s48 offen sc1
    buffer_load_dword v243, v242, s[84:87], s50 offen sc1
    s_mov_b32 s10, 0x00003f80
    s_mov_b32 s11, 0x3f800000
    v_mov_b32 v251, v250
    v_mov_b32 v64, 0
    v_mov_b32 v65, 0
    v_mov_b32 v66, 0
    v_mov_b32 v67, 0
    v_mov_b32 v68, 0
    v_mov_b32 v69, 0
    v_mov_b32 v70, 0
    v_mov_b32 v71, 0
    s_waitcnt vmcnt(17)
    v_dot2c_f32_bf16 v64, s10, v0
    v_dot2c_f32_bf16 v65, s11, v0
    v_dot2c_f32_bf16 v66, s10, v1
    v_dot2c_f32_bf16 v67, s11, v1
    v_dot2c_f32_bf16 v68, s10, v2
    v_dot2c_f32_bf16 v69, s11, v2
    v_dot2c_f32_bf16 v70, s10, v3
    v_dot2c_f32_bf16_e64 v71, s11, v3
    v_add3_u32 v251, v251, v0, v1
    v_add3_u32 v251, v251, v2, v3
    s_waitcnt vmcnt(16)
    v_dot2c_f32_bf16 v64, s10, v4
    v_dot2c_f32_bf16 v65, s11, v4
    v_dot2c_f32_bf16 v66, s10, v5
    v_dot2c_f32_bf16 v67, s11, v5
    v_dot2c_f32_bf16 v68, s10, v6
    v_dot2c_f32_bf16 v69, s11, v6
    v_dot2c_f32_bf16 v70, s10, v7
    v_dot2c_f32_bf16_e64 v71, s11, v7
    v_add3_u32 v251, v251, v4, v5
    v_add3_u32 v251, v251, v6, v7
    s_waitcnt vmcnt(15)
    v_dot2c_f32_bf16 v64, s10, v8
    v_dot2c_f32_bf16 v65, s11, v8
    v_dot2c_f32_bf16 v66, s10, v9
    v_dot2c_f32_bf16 v67, s11, v9
    v_dot2c_f32_bf16 v68, s10, v10
    v_dot2c_f32_bf16 v69, s11, v10
    v_dot2c_f32_bf16 v70, s10, v11
    v_dot2c_f32_bf16_e64 v71, s11, v11
    v_add3_u32 v251, v251, v8, v9
    v_add3_u32 v251, v251, v10, v11
    s_waitcnt vmcnt(14)
    v_dot2c_f32_bf16 v64, s10, v12
    v_dot2c_f32_bf16 v65, s11, v12
    v_dot2c_f32_bf16 v66, s10, v13
    v_dot2c_f32_bf16 v67, s11, v13
    v_dot2c_f32_bf16 v68, s10, v14
    v_dot2c_f32_bf16 v69, s11, v14
    v_dot2c_f32_bf16 v70, s10, v15
    v_dot2c_f32_bf16_e64 v71, s11, v15
    v_add3_u32 v251, v251, v12, v13
    v_add3_u32 v251, v251, v14, v15
    s_waitcnt vmcnt(13)
    v_dot2c_f32_bf16 v64, s10, v16
    v_dot2c_f32_bf16 v65, s11, v16
    v_dot2c_f32_bf16 v66, s10, v17
    v_dot2c_f32_bf16 v67, s11, v17
    v_dot2c_f32_bf16 v68, s10, v18
    v_dot2c_f32_bf16 v69, s11, v18
    v_dot2c_f32_bf16 v70, s10, v19
    v_dot2c_f32_bf16_e64 v71, s11, v19
    v_add3_u32 v251, v251, v16, v17
    v_add3_u32 v251, v251, v18, v19
    s_waitcnt vmcnt(12)
    v_dot2c_f32_bf16 v64, s10, v20
    v_dot2c_f32_bf16 v65, s11, v20
    v_dot2c_f32_bf16 v66, s10, v21
    v_dot2c_f32_bf16 v67, s11, v21
    v_dot2c_f32_bf16 v68, s10, v22
    v_dot2c_f32_bf16 v69, s11, v22
    v_dot2c_f32_bf16 v70, s10, v23
    v_dot2c_f32_bf16_e64 v71, s11, v23
    v_add3_u32 v251, v251, v20, v21
    v_add3_u32 v251, v251, v22, v23
    s_waitcnt vmcnt(11)
    v_dot2c_f32_bf16 v64, s10, v24
    v_dot2c_f32_bf16 v65, s11, v24
    v_dot2c_f32_bf16 v66, s10, v25
    v_dot2c_f32_bf16 v67, s11, v25
    v_dot2c_f32_bf16 v68, s10, v26
    v_dot2c_f32_bf16 v69, s11, v26
    v_dot2c_f32_bf16 v70, s10, v27
    v_dot2c_f32_bf16_e64 v71, s11, v27
    v_add3_u32 v251, v251, v24, v25
    v_add3_u32 v251, v251, v26, v27
    s_waitcnt vmcnt(10)
    v_dot2c_f32_bf16 v64, s10, v28
    v_dot2c_f32_bf16 v65, s11, v28
    v_dot2c_f32_bf16 v66, s10, v29
    v_dot2c_f32_bf16 v67, s11, v29
    v_dot2c_f32_bf16 v68, s10, v30
    v_dot2c_f32_bf16 v69, s11, v30
    v_dot2c_f32_bf16 v70, s10, v31
    v_dot2c_f32_bf16_e64 v71, s11, v31
    v_add3_u32 v251, v251, v28, v29
    v_add3_u32 v251, v251, v30, v31
    s_waitcnt vmcnt(9)
    v_dot2c_f32_bf16 v64, s10, v32
    v_dot2c_f32_bf16 v65, s11, v32
    v_dot2c_f32_bf16 v66, s10, v33
    v_dot2c_f32_bf16 v67, s11, v33
    v_dot2c_f32_bf16 v68, s10, v34
    v_dot2c_f32_bf16 v69, s11, v34
    v_dot2c_f32_bf16 v70, s10, v35
    v_dot2c_f32_bf16_e64 v71, s11, v35
    v_add3_u32 v251, v251, v32, v33
    v_add3_u32 v251, v251, v34, v35
    s_waitcnt vmcnt(8)
    v_dot2c_f32_bf16 v64, s10, v36
    v_dot2c_f32_bf16 v65, s11, v36
    v_dot2c_f32_bf16 v66, s10, v37
    v_dot2c_f32_bf16 v67, s11, v37
    v_dot2c_f32_bf16 v68, s10, v38
    v_dot2c_f32_bf16 v69, s11, v38
    v_dot2c_f32_bf16 v70, s10, v39
    v_dot2c_f32_bf16_e64 v71, s11, v39
    v_add3_u32 v251, v251, v36, v37
    v_add3_u32 v251, v251, v38, v39
    s_waitcnt vmcnt(7)
    v_dot2c_f32_bf16 v64, s10, v40
    v_dot2c_f32_bf16 v65, s11, v40
    v_dot2c_f32_bf16 v66, s10, v41
    v_dot2c_f32_bf16 v67, s11, v41
    v_dot2c_f32_bf16 v68, s10, v42
    v_dot2c_f32_bf16 v69, s11, v42
    v_dot2c_f32_bf16 v70, s10, v43
    v_dot2c_f32_bf16_e64 v71, s11, v43
    v_add3_u32 v251, v251, v40, v41
    v_add3_u32 v251, v251, v42, v43
    s_waitcnt vmcnt(6)
    v_dot2c_f32_bf16 v64, s10, v44
    v_dot2c_f32_bf16 v65, s11, v44
    v_dot2c_f32_bf16 v66, s10, v45
    v_dot2c_f32_bf16 v67, s11, v45
    v_dot2c_f32_bf16 v68, s10, v46
    v_dot2c_f32_bf16 v69, s11, v46
    v_dot2c_f32_bf16 v70, s10, v47
    v_dot2c_f32_bf16_e64 v71, s11, v47
    v_add3_u32 v251, v251, v44, v45
    v_add3_u32 v251, v251, v46, v47
    s_waitcnt vmcnt(5)
    v_dot2c_f32_bf16 v64, s10, v48
    v_dot2c_f32_bf16 v65, s11, v48
    v_dot2c_f32_bf16 v66, s10, v49
    v_dot2c_f32_bf16 v67, s11, v49
    v_dot2c_f32_bf16 v68, s10, v50
    v_dot2c_f32_bf16 v69, s11, v50
    v_dot2c_f32_bf16 v70, s10, v51
    v_dot2c_f32_bf16_e64 v71, s11, v51
    v_add3_u32 v251, v251, v48, v49
    v_add3_u32 v251, v251, v50, v51
    s_waitcnt vmcnt(4)
    v_dot2c_f32_bf16 v64, s10, v52
    v_dot2c_f32_bf16 v65, s11, v52
    v_dot2c_f32_bf16 v66, s10, v53
    v_dot2c_f32_bf16 v67, s11, v53
    v_dot2c_f32_bf16 v68, s10, v54
    v_dot2c_f32_bf16 v69, s11, v54
    v_dot2c_f32_bf16 v70, s10, v55
    v_dot2c_f32_bf16_e64 v71, s11, v55
    v_add3_u32 v251, v251, v52, v53
    v_add3_u32 v251, v251, v54, v55
    s_waitcnt vmcnt(3)
    v_dot2c_f32_bf16 v64, s10, v56
    v_dot2c_f32_bf16 v65, s11, v56
    v_dot2c_f32_bf16 v66, s10, v57
    v_dot2c_f32_bf16 v67, s11, v57
    v_dot2c_f32_bf16 v68, s10, v58
    v_dot2c_f32_bf16 v69, s11, v58
    v_dot2c_f32_bf16 v70, s10, v59
    v_dot2c_f32_bf16_e64 v71, s11, v59
    v_add3_u32 v251, v251, v56, v57
    v_add3_u32 v251, v251, v58, v59
    s_waitcnt vmcnt(2)
    v_dot2c_f32_bf16 v64, s10, v60
    v_dot2c_f32_bf16 v65, s11, v60
    v_dot2c_f32_bf16 v66, s10, v61
    v_dot2c_f32_bf16 v67, s11, v61
    v_dot2c_f32_bf16 v68, s10, v62
    v_dot2c_f32_bf16 v69, s11, v62
    v_dot2c_f32_bf16 v70, s10, v63
    v_dot2c_f32_bf16_e64 v71, s11, v63
    v_add3_u32 v251, v251, v60, v61
    v_add3_u32 v251, v251, v62, v63
    s_nop 1
    s_nop 0
    v_add_u32_dpp v251, v251, v251 row_shr:1 row_mask:0xf bank_mask:0xf bound_ctrl:0
    v_cvt_pk_bf16_f32 v72, v64, v65
    v_cvt_pk_bf16_f32 v73, v66, v67
    v_add_u32_dpp v251, v251, v251 row_shr:2 row_mask:0xf bank_mask:0xf bound_ctrl:0
    v_cvt_pk_bf16_f32 v74, v68, v69
    v_cvt_pk_bf16_f32 v75, v70, v71
    v_add_u32_dpp v251, v251, v251 row_shr:4 row_mask:0xf bank_mask:0xf bound_ctrl:0
    v_add_u32 v245, 155648, v246
    v_add_u32_e64 v244, s12, v245
    v_add_u32_dpp v251, v251, v251 row_shr:8 row_mask:0xf bank_mask:0xf bound_ctrl:0
    ds_write_b128 v244, v[72:75]
    s_lshl_b32 s11, s5, 2
    v_add_u32_dpp v251, v251, v251 row_bcast:15 row_mask:0xa bank_mask:0xf
    s_add_u32 s9, s11, s3
    s_lshl_b32 s11, s9, 4
    v_add_u32_dpp v251, v251, v251 row_bcast:31 row_mask:0xc bank_mask:0xf
    s_add_u32 s11, s11, s4
    s_lshl_b32 s11, s11, 11
    v_readlane_b32 s8, v251, 63
    s_nop 0
    s_cmp_eq_u32 s8, 0
    s_cbranch_scc1 V_9
    s_add_u32 s95, s95, 1
    s_cmp_gt_u32 s95, 200000
    s_cbranch_scc1 V_9
    s_branch L_sa_retry
V_9:
    s_waitcnt lgkmcnt(0)
    s_barrier
    s_nop 0
    ds_read_b128 v[76:79], v245 offset:0
    ds_read_b128 v[80:83], v245 offset:1024
    ds_read_b128 v[84:87], v245 offset:2048
    ds_read_b128 v[88:91], v245 offset:3072
    s_add_u32 s8, s11, 2097152
    s_lshl_b32 s9, s9, 7
    s_lshl_b32 s10, s4, 3
    s_add_u32 s9, s9, s10
    s_add_u32 s9, s9, 24576
    v_mov_b32_e64 v248, s90
    s_waitcnt lgkmcnt(3)
    v_mfma_f32_32x32x16_bf16 v[96:111], v[76:79], v[192:195], 0
    s_waitcnt lgkmcnt(2)
    v_mfma_f32_32x32x16_bf16 v[96:111], v[80:83], v[196:199], v[96:111]
    s_waitcnt lgkmcnt(1)
    v_mfma_f32_32x32x16_bf16 v[96:111], v[84:87], v[200:203], v[96:111]
    s_waitcnt lgkmcnt(0)
    v_mfma_f32_32x32x16_bf16 v[96:111], v[88:91], v[204:207], v[96:111]
    s_nop 11
    v_mov_b32 v112, v108
    v_mov_b32 v114, v108
    s_nop 1
    v_permlane32_swap_b32 v112, v114
    v_add_f32 v114, 0x358637bd, v114
    v_rcp_f32 v114, v114
    s_nop 0
    v_pk_mul_f32 v[96:97], v[96:97], v[114:115] op_sel_hi:[1,0]
    v_pk_mul_f32 v[98:99], v[98:99], v[114:115] op_sel_hi:[1,0]
    v_pk_mul_f32 v[100:101], v[100:101], v[114:115] op_sel_hi:[1,0]
    v_pk_mul_f32 v[102:103], v[102:103], v[114:115] op_sel_hi:[1,0]
    v_pk_mul_f32 v[104:105], v[104:105], v[114:115] op_sel_hi:[1,0]
    v_pk_mul_f32 v[106:107], v[106:107], v[114:115] op_sel_hi:[1,0]
    v_pk_mul_f32 v[108:109], v[108:109], v[114:115] op_sel_hi:[1,0]
    v_pk_mul_f32 v[110:111], v[110:111], v[114:115] op_sel_hi:[1,0]
    v_cvt_pk_bf16_f32 v224, v96, v97
    v_cvt_pk_bf16_f32 v225, v98, v99
    v_cvt_pk_bf16_f32 v226, v100, v101
    v_cvt_pk_bf16_f32 v227, v102, v103
    v_cvt_pk_bf16_f32 v228, v104, v105
    v_cvt_pk_bf16_f32 v229, v106, v107
    v_cvt_pk_bf16_f32 v230, v108, v109
    v_cvt_pk_bf16_f32 v231, v110, v111
    s_mov_b64 exec, s[98:99]
    v_mov_b32 v230, 0
    v_mov_b32 v231, 0
    s_mov_b64 exec, -1
    buffer_store_dwordx4 v[224:227], v246, s[84:87], s8 offen sc1
    buffer_store_dwordx4 v[228:231], v246, s[84:87], s8 offen offset:1024 sc1
    v_add3_u32 v249, v224, v225, v226
    v_add3_u32 v249, v249, v227, v228
    v_add3_u32 v249, v249, v229, v230
    v_add_u32 v249, v249, v231
    s_nop 1
    v_add_u32_dpp v249, v249, v249 row_shr:1 row_mask:0xf bank_mask:0xf bound_ctrl:0
    s_nop 1
    v_add_u32_dpp v249, v249, v249 row_shr:2 row_mask:0xf bank_mask:0xf bound_ctrl:0
    s_nop 1
    v_add_u32_dpp v249, v249, v249 row_shr:4 row_mask:0xf bank_mask:0xf bound_ctrl:0
    s_nop 1
    v_add_u32_dpp v249, v249, v249 row_shr:8 row_mask:0xf bank_mask:0xf bound_ctrl:0
    s_nop 1
    v_add_u32_dpp v249, v249, v249 row_bcast:15 row_mask:0xa bank_mask:0xf
    s_nop 1
    v_add_u32_dpp v249, v249, v249 row_bcast:31 row_mask:0xc bank_mask:0xf
    s_mov_b32 exec_lo, 0
    s_brev_b32 exec_hi, 1
    buffer_store_dwordx2 v[248:249], v254, s[84:87], s9 offen offset:0 sc1
    s_mov_b64 exec, -1
    s_and_b32 s10, s7, 1
    s_lshl_b32 s10, s10, 1
    s_lshr_b32 s15, s3, 1
    s_add_u32 s10, s10, s15
    s_lshl_b32 s2, s6, 2
    s_add_u32 s2, s2, s10
    s_and_b32 s10, s7, 14
    s_and_b32 s15, s3, 1
    s_add_u32 s10, s10, s15
    s_lshl_b32 s11, s10, 5
    v_lshrrev_b32 v250, 5, v255
    v_lshlrev_b32_e64 v250, 4, v250
    s_lshl_b32 s10, s11, 2
    s_add_u32 s10, s10, 7680
    buffer_load_dwordx4 v[144:147], v250, s[84:87], s10 offen offset:0 sc1
    buffer_load_dwordx4 v[148:151], v250, s[84:87], s10 offen offset:32 sc1
    buffer_load_dwordx4 v[152:155], v250, s[84:87], s10 offen offset:64 sc1
    buffer_load_dwordx4 v[156:159], v250, s[84:87], s10 offen offset:96 sc1
    s_lshl_b32 s10, s11, 2
    s_nop 0
    s_add_u32 s10, s10, 11264
    buffer_load_dwordx4 v[160:163], v250, s[84:87], s10 offen offset:0 sc1
    buffer_load_dwordx4 v[164:167], v250, s[84:87], s10 offen offset:32 sc1
    buffer_load_dwordx4 v[168:171], v250, s[84:87], s10 offen offset:64 sc1
    buffer_load_dwordx4 v[172:175], v250, s[84:87], s10 offen offset:96 sc1
    s_lshl_b32 s10, s11, 2
    s_nop 0
    s_add_u32 s10, s10, 13056
    buffer_load_dwordx4 v[192:195], v250, s[84:87], s10 offen offset:0 sc1
    buffer_load_dwordx4 v[196:199], v250, s[84:87], s10 offen offset:32 sc1
    buffer_load_dwordx4 v[200:203], v250, s[84:87], s10 offen offset:64 sc1
    buffer_load_dwordx4 v[204:207], v250, s[84:87], s10 offen offset:96 sc1
    s_waitcnt vmcnt(15)
    v_cmp_ne_u32 vcc, s93, v253
    s_nop 0
    s_cbranch_vccz L_fw3
    s_mov_b64 exec, 0xfffffff
P_10:
    buffer_load_dword v253, v252, s[84:87], s48 offen sc1
    s_waitcnt vmcnt(0)
    v_cmp_ne_u32 vcc, s93, v253
    s_add_u32 s95, s95, 1
    s_cmp_gt_u32 s95, 200000
    s_cbranch_scc1 PX_11
    s_cbranch_vccz PX_11
    s_sleep 1
    s_branch P_10
PX_11:
    s_mov_b64 exec, -1
L_fw3:
    v_cmp_ne_u32 vcc, s93, v243
    s_nop 0
    s_cbranch_vccz L_fwd
    s_mov_b32 exec_lo, -1
    s_mov_b32 exec_hi, 0xffffff
P_12:
    buffer_load_dword v243, v242, s[84:87], s50 offen sc1
    s_waitcnt vmcnt(0)
    v_cmp_ne_u32 vcc, s93, v243
    s_add_u32 s95, s95, 1
    s_cmp_gt_u32 s95, 200000
    s_cbranch_scc1 PX_13
    s_cbranch_vccz PX_13
    s_sleep 1
    s_branch P_12
PX_13:
    s_mov_b64 exec, -1
L_fwd:
    v_lshrrev_b32_e64 v240, 5, v255
    v_bfe_u32 v241, v255, 4, 1
    v_bfe_u32 v242, v255, 2, 2
    v_and_b32_e64 v243, 3, v255
    v_lshl_add_u32 v240, v240, 2, v242
    v_lshlrev_b32_e64 v240, 7, v240
    v_lshl_add_u32 v240, v241, 5, v240
    v_lshl_add_u32 v240, v243, 3, v240
    v_lshrrev_b32 v242, 1, v242
    s_and_b32 s10, s3, 1
    v_xor_b32_e64 v242, s10, v242
    s_mov_b32 m0, s42
    s_sub_u32 s14, s14, 1
    buffer_load_dwordx4 v246, s[84:87], s43 offen sc1 lds
    s_add_u32 s42, s42, 4096
    s_add_u32 s43, s43, 4096
    v_lshl_add_u32 v240, v242, 6, v240
    s_mul_i32 s10, s10, 28672
    v_add_u32_e64 v241, s10, v240
    s_mov_b32 m0, s42
    s_sub_u32 s14, s14, 1
    buffer_load_dwordx4 v246, s[84:87], s43 offen sc1 lds
    s_add_u32 s42, s42, 4096
    s_add_u32 s43, s43, 4096
    s_sub_u32 s10, 28672, s10
    v_add_u32_e64 v240, s10, v240
    ds_read_b64_tr_b16 v[0:1], v241 offset:0
    s_mov_b32 m0, s42
    s_sub_u32 s14, s14, 1
    buffer_load_dwordx4 v246, s[84:87], s43 offen sc1 lds
    s_add_u32 s42, s42, 4096
    s_add_u32 s43, s43, 4096
    ds_read_b64_tr_b16 v[2:3], v241 offset:1024
    ds_read_b64_tr_b16 v[4:5], v241 offset:2048
    ds_read_b64_tr_b16 v[6:7], v241 offset:3072
    s_mov_b32 m0, s42
    s_sub_u32 s14, s14, 1
    buffer_load_dwordx4 v246, s[84:87], s43 offen sc1 lds
    s_add_u32 s42, s42, 4096
    s_add_u32 s43, s43, 4096
    ds_read_b64_tr_b16 v[8:9], v241 offset:3584
    ds_read_b64_tr_b16 v[10:11], v241 offset:4608
    ds_read_b64_tr_b16 v[12:13], v241 offset:5632
    s_add_u32 s15, s0, 0
    buffer_load_dwordx4 a[0:3], v246, s[84:87], s15 offen sc1
    ds_read_b64_tr_b16 v[14:15], v241 offset:6656
    ds_read_b64_tr_b16 v[16:17], v241 offset:7168
    ds_read_b64_tr_b16 v[18:19], v241 offset:8192
    s_add_u32 s15, s72, 0
    buffer_load_dwordx4 a[4:7], v246, s[84:87], s15 offen sc1
    ds_read_b64_tr_b16 v[20:21], v241 offset:9216
    ds_read_b64_tr_b16 v[22:23], v241 offset:10240
    ds_read_b64_tr_b16 v[24:25], v241 offset:10752
    s_add_u32 s15, s0, 2048
    buffer_load_dwordx4 a[8:11], v246, s[84:87], s15 offen sc1
    ds_read_b64_tr_b16 v[26:27], v241 offset:11776
    ds_read_b64_tr_b16 v[28:29], v241 offset:12800
    ds_read_b64_tr_b16 v[30:31], v241 offset:13824
    s_add_u32 s15, s72, 2048
    buffer_load_dwordx4 a[12:15], v246, s[84:87], s15 offen sc1
    ds_read_b64_tr_b16 v[32:33], v241 offset:14336
    ds_read_b64_tr_b16 v[34:35], v241 offset:15360
    ds_read_b64_tr_b16 v[36:37], v241 offset:16384
    s_add_u32 s15, s0, 4096
    buffer_load_dwordx4 a[16:19], v246, s[84:87], s15 offen sc1
    ds_read_b64_tr_b16 v[38:39], v241 offset:17408
    ds_read_b64_tr_b16 v[40:41], v241 offset:17920
    ds_read_b64_tr_b16 v[42:43], v241 offset:18944
    s_add_u32 s15, s72, 4096
    buffer_load_dwordx4 a[20:23], v246, s[84:87], s15 offen sc1
    ds_read_b64_tr_b16 v[44:45], v241 offset:19968
    ds_read_b64_tr_b16 v[46:47], v241 offset:20992
    ds_read_b64_tr_b16 v[48:49], v241 offset:21504
    s_add_u32 s15, s0, 6144
    buffer_load_dwordx4 a[24:27], v246, s[84:87], s15 offen sc1
    ds_read_b64_tr_b16 v[50:51], v241 offset:22528
    ds_read_b64_tr_b16 v[52:53], v241 offset:23552
    ds_read_b64_tr_b16 v[54:55], v241 offset:24576
    s_add_u32 s15, s72, 6144
    buffer_load_dwordx4 a[28:31], v246, s[84:87], s15 offen sc1
    ds_read_b64_tr_b16 v[56:57], v241 offset:25088
    ds_read_b64_tr_b16 v[58:59], v241 offset:26112
    ds_read_b64_tr_b16 v[60:61], v241 offset:27136
    s_add_u32 s15, s0, 8192
    buffer_load_dwordx4 a[32:35], v246, s[84:87], s15 offen sc1
    ds_read_b64_tr_b16 v[62:63], v241 offset:28160
    ds_read_b64_tr_b16 v[64:65], v240 offset:0
    ds_read_b64_tr_b16 v[66:67], v240 offset:1024
    s_add_u32 s15, s72, 8192
    buffer_load_dwordx4 a[36:39], v246, s[84:87], s15 offen sc1
    ds_read_b64_tr_b16 v[68:69], v240 offset:2048
    ds_read_b64_tr_b16 v[70:71], v240 offset:3072
    ds_read_b64_tr_b16 v[72:73], v240 offset:3584
    s_add_u32 s15, s0, 10240
    buffer_load_dwordx4 a[40:43], v246, s[84:87], s15 offen sc1
    ds_read_b64_tr_b16 v[74:75], v240 offset:4608
    ds_read_b64_tr_b16 v[76:77], v240 offset:5632
    ds_read_b64_tr_b16 v[78:79], v240 offset:6656
    s_add_u32 s15, s72, 10240
    buffer_load_dwordx4 a[44:47], v246, s[84:87], s15 offen sc1
    ds_read_b64_tr_b16 v[80:81], v240 offset:7168
    ds_read_b64_tr_b16 v[82:83], v240 offset:8192
    ds_read_b64_tr_b16 v[84:85], v240 offset:9216
    s_add_u32 s15, s0, 12288
    buffer_load_dwordx4 a[48:51], v246, s[84:87], s15 offen sc1
    ds_read_b64_tr_b16 v[86:87], v240 offset:10240
    ds_read_b64_tr_b16 v[88:89], v240 offset:10752
    ds_read_b64_tr_b16 v[90:91], v240 offset:11776
    s_add_u32 s15, s72, 12288
    buffer_load_dwordx4 a[52:55], v246, s[84:87], s15 offen sc1
    ds_read_b64_tr_b16 v[92:93], v240 offset:12800
    ds_read_b64_tr_b16 v[94:95], v240 offset:13824
    ds_read_b64_tr_b16 v[96:97], v240 offset:14336
    s_add_u32 s15, s0, 14336
    buffer_load_dwordx4 a[56:59], v246, s[84:87], s15 offen sc1
    ds_read_b64_tr_b16 v[98:99], v240 offset:15360
    ds_read_b64_tr_b16 v[100:101], v240 offset:16384
    ds_read_b64_tr_b16 v[102:103], v240 offset:17408
    s_add_u32 s15, s72, 14336
    buffer_load_dwordx4 a[60:63], v246, s[84:87], s15 offen sc1
    ds_read_b64_tr_b16 v[104:105], v240 offset:17920
    ds_read_b64_tr_b16 v[106:107], v240 offset:18944
    ds_read_b64_tr_b16 v[108:109], v240 offset:19968
    s_add_u32 s15, s0, 16384
    buffer_load_dwordx4 a[64:67], v246, s[84:87], s15 offen sc1
    ds_read_b64_tr_b16 v[110:111], v240 offset:20992
    ds_read_b64_tr_b16 v[112:113], v240 offset:21504
    ds_read_b64_tr_b16 v[114:115], v240 offset:22528
    s_add_u32 s15, s72, 16384
    buffer_load_dwordx4 a[68:71], v246, s[84:87], s15 offen sc1
    ds_read_b64_tr_b16 v[116:117], v240 offset:23552
    ds_read_b64_tr_b16 v[118:119], v240 offset:24576
    ds_read_b64_tr_b16 v[120:121], v240 offset:25088
    s_add_u32 s15, s0, 18432
    buffer_load_dwordx4 a[72:75], v246, s[84:87], s15 offen sc1
    ds_read_b64_tr_b16 v[122:123], v240 offset:26112
    ds_read_b64_tr_b16 v[124:125], v240 offset:27136
    ds_read_b64_tr_b16 v[126:127], v240 offset:28160
    s_add_u32 s15, s72, 18432
    buffer_load_dwordx4 a[76:79], v246, s[84:87], s15 offen sc1
    s_waitcnt vmcnt(24)
    s_cmp_ge_u32 s7, 14
    s_cbranch_scc1 L_p2b_alt
L_mv:
    v_mov_b32 v242, 0
    v_xor_b32 v145, s88, v145
    v_xor_b32 v147, s88, v147
    v_xor_b32 v149, s88, v149
    v_xor_b32 v151, s88, v151
    v_xor_b32 v153, s88, v153
    v_xor_b32 v155, s88, v155
    v_xor_b32 v157, s88, v157
    v_xor_b32 v159, s88, v159
    v_or3_b32 v242, v242, v145, v147
    v_or3_b32 v242, v242, v149, v151
    v_or3_b32 v242, v242, v153, v155
    v_or3_b32 v242, v242, v157, v159
    v_xor_b32 v161, s88, v161
    v_xor_b32 v163, s88, v163
    v_xor_b32 v165, s88, v165
    v_xor_b32 v167, s88, v167
    v_xor_b32 v169, s88, v169
    v_xor_b32 v171, s88, v171
    v_xor_b32 v173, s88, v173
    v_xor_b32 v175, s88, v175
    v_or3_b32 v242, v242, v161, v163
    v_or3_b32 v242, v242, v165, v167
    v_or3_b32 v242, v242, v169, v171
    v_or3_b32 v242, v242, v173, v175
    v_xor_b32 v193, s88, v193
    v_xor_b32 v195, s88, v195
    v_xor_b32 v197, s88, v197
    v_xor_b32 v199, s88, v199
    v_xor_b32 v201, s88, v201
    v_xor_b32 v203, s88, v203
    v_xor_b32 v205, s88, v205
    v_xor_b32 v207, s88, v207
    v_or3_b32 v242, v242, v193, v195
    v_or3_b32 v242, v242, v197, v199
    v_or3_b32 v242, v242, v201, v203
    v_or3_b32 v242, v242, v205, v207
    v_cmp_ne_u32 vcc, 0, v242
    s_add_u32 s95, s95, 1
    s_cmp_gt_u32 s95, 200000
    s_cbranch_scc1 L_mvx
    s_cbranch_vccz L_mvx
    s_lshl_b32 s10, s11, 2
    s_nop 0
    s_add_u32 s10, s10, 7680
    buffer_load_dwordx4 v[144:147], v250, s[84:87], s10 offen offset:0 sc1
    buffer_load_dwordx4 v[148:151], v250, s[84:87], s10 offen offset:32 sc1
    buffer_load_dwordx4 v[152:155], v250, s[84:87], s10 offen offset:64 sc1
    buffer_load_dwordx4 v[156:159], v250, s[84:87], s10 offen offset:96 sc1
    s_lshl_b32 s10, s11, 2
    s_nop 0
    s_add_u32 s10, s10, 11264
    buffer_load_dwordx4 v[160:163], v250, s[84:87], s10 offen offset:0 sc1
    buffer_load_dwordx4 v[164:167], v250, s[84:87], s10 offen offset:32 sc1
    buffer_load_dwordx4 v[168:171], v250, s[84:87], s10 offen offset:64 sc1
    buffer_load_dwordx4 v[172:175], v250, s[84:87], s10 offen offset:96 sc1
    s_lshl_b32 s10, s11, 2
    s_nop 0
    s_add_u32 s10, s10, 13056
    buffer_load_dwordx4 v[192:195], v250, s[84:87], s10 offen offset:0 sc1
    buffer_load_dwordx4 v[196:199], v250, s[84:87], s10 offen offset:32 sc1
    buffer_load_dwordx4 v[200:203], v250, s[84:87], s10 offen offset:64 sc1
    buffer_load_dwordx4 v[204:207], v250, s[84:87], s10 offen offset:96 sc1
    s_waitcnt vmcnt(0)
    s_branch L_mv
L_mvx:
    v_and_b32 v145, s100, v144
    v_lshlrev_b32 v144, 16, v144
    v_and_b32 v147, s100, v146
    v_lshlrev_b32 v146, 16, v146
    v_and_b32 v149, s100, v148
    v_lshlrev_b32 v148, 16, v148
    v_and_b32 v151, s100, v150
    v_lshlrev_b32 v150, 16, v150
    v_and_b32 v153, s100, v152
    v_lshlrev_b32 v152, 16, v152
    v_and_b32 v155, s100, v154
    v_lshlrev_b32 v154, 16, v154
    v_and_b32 v157, s100, v156
    v_lshlrev_b32 v156, 16, v156
    v_and_b32 v159, s100, v158
    v_lshlrev_b32 v158, 16, v158
    v_and_b32 v161, s100, v160
    v_lshlrev_b32 v160, 16, v160
    v_and_b32 v163, s100, v162
    v_lshlrev_b32 v162, 16, v162
    v_and_b32 v165, s100, v164
    v_lshlrev_b32 v164, 16, v164
    v_and_b32 v167, s100, v166
    v_lshlrev_b32 v166, 16, v166
    v_and_b32 v169, s100, v168
    v_lshlrev_b32 v168, 16, v168
    v_and_b32 v171, s100, v170
    v_lshlrev_b32 v170, 16, v170
    v_and_b32 v173, s100, v172
    v_lshlrev_b32 v172, 16, v172
    v_and_b32 v175, s100, v174
    v_lshlrev_b32 v174, 16, v174
    v_mov_b32 v224, v192
    v_mov_b32 v225, v194
    v_mov_b32 v226, v196
    v_mov_b32 v227, v198
    v_mov_b32 v228, v200
    v_mov_b32 v229, v202
    v_mov_b32 v230, v204
    v_mov_b32 v231, v206
    v_accvgpr_read_b32 v176, a240
    v_accvgpr_read_b32 v177, a241
    v_and_b32 v179, s100, v177
    v_lshlrev_b32 v178, 16, v177
    v_and_b32 v177, s100, v176
    v_lshlrev_b32 v176, 16, v176
    v_accvgpr_read_b32 v180, a242
    v_accvgpr_read_b32 v181, a243
    v_and_b32 v183, s100, v181
    v_lshlrev_b32 v182, 16, v181
    v_and_b32 v181, s100, v180
    v_lshlrev_b32 v180, 16, v180
    v_accvgpr_read_b32 v184, a244
    v_accvgpr_read_b32 v185, a245
    v_and_b32 v187, s100, v185
    v_lshlrev_b32 v186, 16, v185
    v_and_b32 v185, s100, v184
    v_lshlrev_b32 v184, 16, v184
    v_accvgpr_read_b32 v188, a246
    v_accvgpr_read_b32 v189, a247
    v_and_b32 v191, s100, v189
    v_lshlrev_b32 v190, 16, v189
    v_and_b32 v189, s100, v188
    v_lshlrev_b32 v188, 16, v188
    v_lshlrev_b32_e64 v244, 3, v255
    s_lshl_b32 s8, s2, 7
    s_and_b32 s9, s3, 1
    s_lshl_b32 s10, s9, 6
    s_add_u32 s8, s8, s10
    s_add_u32 s8, s8, 24576
    s_waitcnt lgkmcnt(0)
    s_barrier
    s_and_b32 s9, s3, 1
    s_lshl_b32 s10, s2, 15
    s_lshl_b32 s9, s9, 14
    s_add_u32 s10, s10, s9
    s_add_u32 s73, s10, 2097152
    s_lshl_b32 s74, s3, 14
    v_mov_b32 v243, 0
    s_mov_b64 exec, 0xff
    buffer_load_dwordx2 v[252:253], v244, s[84:87], s8 offen sc1
    s_mov_b64 exec, -1
    s_add_u32 m0, s74, 0
    s_add_u32 s15, s73, 0
    s_nop 0
    buffer_load_dwordx4 v246, s[84:87], s15 offen sc1 lds
    s_add_u32 m0, s74, 1024
    s_add_u32 s15, s73, 1024
    buffer_load_dwordx4 v246, s[84:87], s15 offen sc1 lds
    s_add_u32 m0, s74, 2048
    s_add_u32 s15, s73, 2048
    buffer_load_dwordx4 v246, s[84:87], s15 offen sc1 lds
    s_add_u32 m0, s74, 3072
    s_add_u32 s15, s73, 3072
    buffer_load_dwordx4 v246, s[84:87], s15 offen sc1 lds
    s_add_u32 m0, s74, 4096
    s_add_u32 s15, s73, 4096
    buffer_load_dwordx4 v246, s[84:87], s15 offen sc1 lds
    s_add_u32 m0, s74, 5120
    s_add_u32 s15, s73, 5120
    buffer_load_dwordx4 v246, s[84:87], s15 offen sc1 lds
    s_add_u32 m0, s74, 6144
    s_add_u32 s15, s73, 6144
    buffer_load_dwordx4 v246, s[84:87], s15 offen sc1 lds
    s_add_u32 m0, s74, 7168
    s_add_u32 s15, s73, 7168
    buffer_load_dwordx4 v246, s[84:87], s15 offen sc1 lds
    s_add_u32 m0, s74, 8192
    s_add_u32 s15, s73, 8192
    buffer_load_dwordx4 v246, s[84:87], s15 offen sc1 lds
    s_add_u32 m0, s74, 9216
    s_add_u32 s15, s73, 9216
    buffer_load_dwordx4 v246, s[84:87], s15 offen sc1 lds
    s_add_u32 m0, s74, 10240
    s_add_u32 s15, s73, 10240
    buffer_load_dwordx4 v246, s[84:87], s15 offen sc1 lds
    s_add_u32 m0, s74, 11264
    s_add_u32 s15, s73, 11264
    buffer_load_dwordx4 v246, s[84:87], s15 offen sc1 lds
    s_add_u32 m0, s74, 12288
    s_add_u32 s15, s73, 12288
    buffer_load_dwordx4 v246, s[84:87], s15 offen sc1 lds
    s_add_u32 m0, s74, 13312
    s_add_u32 s15, s73, 13312
    buffer_load_dwordx4 v246, s[84:87], s15 offen sc1 lds
    s_add_u32 m0, s74, 14336
    s_add_u32 s15, s73, 14336
    buffer_load_dwordx4 v246, s[84:87], s15 offen sc1 lds
    s_add_u32 m0, s74, 15360
    s_add_u32 s15, s73, 15360
    buffer_load_dwordx4 v246, s[84:87], s15 offen sc1 lds
    s_waitcnt vmcnt(16)
    s_mov_b64 exec, 0xff
    v_cmp_ne_u32 vcc, s90, v252
    v_sub_u32_e64 v243, v243, v253
    s_mov_b64 exec, -1
    s_cbranch_vccz H_14
    s_mov_b64 exec, 0xff
    v_add_u32 v243, v243, v253
    s_mov_b64 exec, -1
    s_mov_b64 exec, 0xff
P_15:
    buffer_load_dwordx2 v[252:253], v244, s[84:87], s8 offen sc1
    s_waitcnt vmcnt(0)
    v_cmp_ne_u32 vcc, s90, v252
    s_add_u32 s95, s95, 1
    s_cmp_gt_u32 s95, 200000
    s_cbranch_scc1 PX_16
    s_cbranch_vccz PX_16
    s_sleep 1
    s_branch P_15
PX_16:
    v_sub_u32_e64 v243, v243, v253
    s_mov_b64 exec, -1
L_sb_retry:
    s_add_u32 m0, s74, 0
    s_add_u32 s15, s73, 0
    buffer_load_dwordx4 v246, s[84:87], s15 offen sc1 lds
    s_add_u32 m0, s74, 1024
    s_add_u32 s15, s73, 1024
    buffer_load_dwordx4 v246, s[84:87], s15 offen sc1 lds
    s_add_u32 m0, s74, 2048
    s_add_u32 s15, s73, 2048
    buffer_load_dwordx4 v246, s[84:87], s15 offen sc1 lds
    s_add_u32 m0, s74, 3072
    s_add_u32 s15, s73, 3072
    buffer_load_dwordx4 v246, s[84:87], s15 offen sc1 lds
    s_add_u32 m0, s74, 4096
    s_add_u32 s15, s73, 4096
    buffer_load_dwordx4 v246, s[84:87], s15 offen sc1 lds
    s_add_u32 m0, s74, 5120
    s_add_u32 s15, s73, 5120
    buffer_load_dwordx4 v246, s[84:87], s15 offen sc1 lds
    s_add_u32 m0, s74, 6144
    s_add_u32 s15, s73, 6144
    buffer_load_dwordx4 v246, s[84:87], s15 offen sc1 lds
    s_add_u32 m0, s74, 7168
    s_add_u32 s15, s73, 7168
    buffer_load_dwordx4 v246, s[84:87], s15 offen sc1 lds
    s_add_u32 m0, s74, 8192
    s_add_u32 s15, s73, 8192
    buffer_load_dwordx4 v246, s[84:87], s15 offen sc1 lds
    s_add_u32 m0, s74, 9216
    s_add_u32 s15, s73, 9216
    buffer_load_dwordx4 v246, s[84:87], s15 offen sc1 lds
    s_add_u32 m0, s74, 10240
    s_add_u32 s15, s73, 10240
    buffer_load_dwordx4 v246, s[84:87], s15 offen sc1 lds
    s_add_u32 m0, s74, 11264
    s_add_u32 s15, s73, 11264
    buffer_load_dwordx4 v246, s[84:87], s15 offen sc1 lds
    s_add_u32 m0, s74, 12288
    s_add_u32 s15, s73, 12288
    buffer_load_dwordx4 v246, s[84:87], s15 offen sc1 lds
    s_add_u32 m0, s74, 13312
    s_add_u32 s15, s73, 13312
    buffer_load_dwordx4 v246, s[84:87], s15 offen sc1 lds
    s_add_u32 m0, s74, 14336
    s_add_u32 s15, s73, 14336
    buffer_load_dwordx4 v246, s[84:87], s15 offen sc1 lds
    s_add_u32 m0, s74, 15360
    s_add_u32 s15, s73, 15360
    buffer_load_dwordx4 v246, s[84:87], s15 offen sc1 lds
H_14:
    v_mov_b32 v251, v243
    s_mov_b32 s9, s74
    v_add_u32_e64 v247, s9, v246
    s_xor_b32 s8, s9, 16384
    v_add_u32 v245, s8, v246
    s_waitcnt vmcnt(15)
    ds_read_b128 v[192:195], v247 offset:0
    s_waitcnt vmcnt(14)
    ds_read_b128 v[196:199], v247 offset:1024
    s_waitcnt vmcnt(13)
    ds_read_b128 v[200:203], v247 offset:2048
    s_waitcnt vmcnt(12)
    ds_read_b128 v[204:207], v247 offset:3072
    s_waitcnt vmcnt(11)
    ds_read_b128 v[208:211], v247 offset:4096
    s_waitcnt lgkmcnt(4)
    v_mfma_f32_32x32x16_bf16 v[128:143], v[0:3], v[192:195], 0
    v_add3_u32 v251, v251, v192, v193
    v_add3_u32 v251, v251, v194, v195
    s_waitcnt vmcnt(10)
    ds_read_b128 v[212:215], v247 offset:5120
    s_waitcnt lgkmcnt(4)
    v_mfma_f32_32x32x16_bf16 v[128:143], v[4:7], v[196:199], v[128:143]
    v_add3_u32 v251, v251, v196, v197
    v_add3_u32 v251, v251, v198, v199
    s_waitcnt vmcnt(9)
    ds_read_b128 v[216:219], v247 offset:6144
    s_waitcnt lgkmcnt(4)
    v_mfma_f32_32x32x16_bf16 v[128:143], v[8:11], v[200:203], v[128:143]
    v_add3_u32 v251, v251, v200, v201
    v_add3_u32 v251, v251, v202, v203
    s_waitcnt vmcnt(8)
    ds_read_b128 v[220:223], v247 offset:7168
    s_waitcnt lgkmcnt(4)
    v_mfma_f32_32x32x16_bf16 v[128:143], v[12:15], v[204:207], v[128:143]
    v_add3_u32 v251, v251, v204, v205
    v_add3_u32 v251, v251, v206, v207
    s_waitcnt vmcnt(7)
    ds_read_b128 v[192:195], v247 offset:8192
    s_waitcnt lgkmcnt(4)
    v_mfma_f32_32x32x16_bf16 v[128:143], v[16:19], v[208:211], v[128:143]
    v_add3_u32 v251, v251, v208, v209
    v_add3_u32 v251, v251, v210, v211
    s_waitcnt vmcnt(6)
    ds_read_b128 v[196:199], v247 offset:9216
    s_waitcnt lgkmcnt(4)
    v_mfma_f32_32x32x16_bf16 v[128:143], v[20:23], v[212:215], v[128:143]
    v_add3_u32 v251, v251, v212, v213
    v_add3_u32 v251, v251, v214, v215
    s_waitcnt vmcnt(5)
    ds_read_b128 v[200:203], v247 offset:10240
    s_waitcnt lgkmcnt(4)
    v_mfma_f32_32x32x16_bf16 v[128:143], v[24:27], v[216:219], v[128:143]
    v_add3_u32 v251, v251, v216, v217
    v_add3_u32 v251, v251, v218, v219
    s_waitcnt vmcnt(4)
    ds_read_b128 v[204:207], v247 offset:11264
    s_waitcnt lgkmcnt(4)
    v_mfma_f32_32x32x16_bf16 v[128:143], v[28:31], v[220:223], v[128:143]
    v_add3_u32 v251, v251, v220, v221
    v_add3_u32 v251, v251, v222, v223
    s_waitcnt vmcnt(3)
    ds_read_b128 v[208:211], v247 offset:12288
    s_waitcnt lgkmcnt(4)
    v_mfma_f32_32x32x16_bf16 v[128:143], v[32:35], v[192:195], v[128:143]
    v_add3_u32 v251, v251, v192, v193
    v_add3_u32 v251, v251, v194, v195
    s_waitcnt vmcnt(2)
    ds_read_b128 v[212:215], v247 offset:13312
    s_waitcnt lgkmcnt(4)
    v_mfma_f32_32x32x16_bf16 v[128:143], v[36:39], v[196:199], v[128:143]
    v_add3_u32 v251, v251, v196, v197
    v_add3_u32 v251, v251, v198, v199
    s_waitcnt vmcnt(1)
    ds_read_b128 v[216:219], v247 offset:14336
    s_waitcnt lgkmcnt(4)
    v_mfma_f32_32x32x16_bf16 v[128:143], v[40:43], v[200:203], v[128:143]
    v_add3_u32 v251, v251, v200, v201
    v_add3_u32 v251, v251, v202, v203
    s_waitcnt vmcnt(0)
    ds_read_b128 v[220:223], v247 offset:15360
    s_waitcnt lgkmcnt(4)
    v_mfma_f32_32x32x16_bf16 v[128:143], v[44:47], v[204:207], v[128:143]
    v_add3_u32 v251, v251, v204, v205
    v_add3_u32 v251, v251, v206, v207
    s_barrier
    ds_read_b128 v[192:195], v245 offset:0
    s_waitcnt lgkmcnt(4)
    v_mfma_f32_32x32x16_bf16 v[128:143], v[48:51], v[208:211], v[128:143]
    v_add3_u32 v251, v251, v208, v209
    v_add3_u32 v251, v251, v210, v211
    ds_read_b128 v[196:199], v245 offset:1024
    s_waitcnt lgkmcnt(4)
    v_mfma_f32_32x32x16_bf16 v[128:143], v[52:55], v[212:215], v[128:143]
    v_add3_u32 v251, v251, v212, v213
    v_add3_u32 v251, v251, v214, v215
    s_cmp_eq_u32 s14, 0
    s_cbranch_scc1 BG_17
    s_mov_b32 m0, s42
    s_sub_u32 s14, s14, 1
    buffer_load_dwordx4 v246, s[84:87], s43 offen sc1 lds
    s_add_u32 s42, s42, 4096
    s_add_u32 s43, s43, 4096
BG_17:
    ds_read_b128 v[200:203], v245 offset:2048
    s_waitcnt lgkmcnt(4)
    v_mfma_f32_32x32x16_bf16 v[128:143], v[56:59], v[216:219], v[128:143]
    v_add3_u32 v251, v251, v216, v217
    v_add3_u32 v251, v251, v218, v219
    ds_read_b128 v[204:207], v245 offset:3072
    s_waitcnt lgkmcnt(4)
    v_mfma_f32_32x32x16_bf16 v[128:143], v[60:63], v[220:223], v[128:143]
    v_add3_u32 v251, v251, v220, v221
    v_add3_u32 v251, v251, v222, v223
    ds_read_b128 v[208:211], v245 offset:4096
    s_waitcnt lgkmcnt(4)
    v_mfma_f32_32x32x16_bf16 v[128:143], v[64:67], v[192:195], v[128:143]
    s_cmp_eq_u32 s14, 0
    s_cbranch_scc1 BG_18
    s_mov_b32 m0, s42
    s_sub_u32 s14, s14, 1
    buffer_load_dwordx4 v246, s[84:87], s43 offen sc1 lds
    s_add_u32 s42, s42, 4096
    s_add_u32 s43, s43, 4096
BG_18:
    ds_read_b128 v[212:215], v245 offset:5120
    s_waitcnt lgkmcnt(4)
    v_mfma_f32_32x32x16_bf16 v[128:143], v[68:71], v[196:199], v[128:143]
    v_add_u32_dpp v251, v251, v251 row_shr:1 row_mask:0xf bank_mask:0xf bound_ctrl:0
    ds_read_b128 v[216:219], v245 offset:6144
    s_waitcnt lgkmcnt(4)
    v_mfma_f32_32x32x16_bf16 v[128:143], v[72:75], v[200:203], v[128:143]
    v_add_u32_dpp v251, v251, v251 row_shr:2 row_mask:0xf bank_mask:0xf bound_ctrl:0
    ds_read_b128 v[220:223], v245 offset:7168
    s_waitcnt lgkmcnt(4)
    v_mfma_f32_32x32x16_bf16 v[128:143], v[76:79], v[204:207], v[128:143]
    v_add_u32_dpp v251, v251, v251 row_shr:4 row_mask:0xf bank_mask:0xf bound_ctrl:0
    s_cmp_eq_u32 s14, 0
    s_cbranch_scc1 BG_19
    s_mov_b32 m0, s42
    s_sub_u32 s14, s14, 1
    buffer_load_dwordx4 v246, s[84:87], s43 offen sc1 lds
    s_add_u32 s42, s42, 4096
    s_add_u32 s43, s43, 4096
BG_19:
    ds_read_b128 v[192:195], v245 offset:8192
    s_waitcnt lgkmcnt(4)
    v_mfma_f32_32x32x16_bf16 v[128:143], v[80:83], v[208:211], v[128:143]
    v_add_u32_dpp v251, v251, v251 row_shr:8 row_mask:0xf bank_mask:0xf bound_ctrl:0
    ds_read_b128 v[196:199], v245 offset:9216
    s_waitcnt lgkmcnt(4)
    v_mfma_f32_32x32x16_bf16 v[128:143], v[84:87], v[212:215], v[128:143]
    v_add_u32_dpp v251, v251, v251 row_bcast:15 row_mask:0xa bank_mask:0xf
    ds_read_b128 v[200:203], v245 offset:10240
    s_waitcnt lgkmcnt(4)
    v_mfma_f32_32x32x16_bf16 v[128:143], v[88:91], v[216:219], v[128:143]
    v_add_u32_dpp v251, v251, v251 row_bcast:31 row_mask:0xc bank_mask:0xf
    s_cmp_eq_u32 s14, 0
    s_cbranch_scc1 BG_20
    s_mov_b32 m0, s42
    s_sub_u32 s14, s14, 1
    buffer_load_dwordx4 v246, s[84:87], s43 offen sc1 lds
    s_add_u32 s42, s42, 4096
    s_add_u32 s43, s43, 4096
BG_20:
    ds_read_b128 v[204:207], v245 offset:11264
    s_waitcnt lgkmcnt(4)
    v_mfma_f32_32x32x16_bf16 v[128:143], v[92:95], v[220:223], v[128:143]
    ds_read_b128 v[208:211], v245 offset:12288
    s_waitcnt lgkmcnt(4)
    v_mfma_f32_32x32x16_bf16 v[128:143], v[96:99], v[192:195], v[128:143]
    v_readlane_b32 s8, v251, 63
    v_mov_b32 v253, 155648
    v_add_u32 v242, s12, v253
    v_mov_b32_e64 v251, s8
    ds_write_b32 v242, v251
    ds_read_b128 v[212:215], v245 offset:13312
    s_waitcnt lgkmcnt(5)
    v_mfma_f32_32x32x16_bf16 v[128:143], v[100:103], v[196:199], v[128:143]
    s_cmp_eq_u32 s14, 0
    s_cbranch_scc1 BG_21
    s_mov_b32 m0, s42
    s_sub_u32 s14, s14, 1
    buffer_load_dwordx4 v246, s[84:87], s43 offen sc1 lds
    s_add_u32 s42, s42, 4096
    s_add_u32 s43, s43, 4096
BG_21:
    ds_read_b128 v[216:219], v245 offset:14336
    s_waitcnt lgkmcnt(4)
    v_mfma_f32_32x32x16_bf16 v[128:143], v[104:107], v[200:203], v[128:143]
    ds_read_b128 v[220:223], v245 offset:15360
    s_waitcnt lgkmcnt(4)
    v_mfma_f32_32x32x16_bf16 v[128:143], v[108:111], v[204:207], v[128:143]
    s_waitcnt lgkmcnt(3)
    v_mfma_f32_32x32x16_bf16 v[128:143], v[112:115], v[208:211], v[128:143]
    s_cmp_eq_u32 s14, 0
    s_cbranch_scc1 BG_22
    s_mov_b32 m0, s42
    s_sub_u32 s14, s14, 1
    buffer_load_dwordx4 v246, s[84:87], s43 offen sc1 lds
    s_add_u32 s42, s42, 4096
    s_add_u32 s43, s43, 4096
BG_22:
    s_waitcnt lgkmcnt(2)
    v_mfma_f32_32x32x16_bf16 v[128:143], v[116:119], v[212:215], v[128:143]
    s_waitcnt lgkmcnt(1)
    v_mfma_f32_32x32x16_bf16 v[128:143], v[120:123], v[216:219], v[128:143]
    s_waitcnt lgkmcnt(0)
    v_mfma_f32_32x32x16_bf16 v[128:143], v[124:127], v[220:223], v[128:143]
    s_cmp_eq_u32 s14, 0
    s_cbranch_scc1 BG_23
    s_mov_b32 m0, s42
    s_sub_u32 s14, s14, 1
    buffer_load_dwordx4 v246, s[84:87], s43 offen sc1 lds
    s_add_u32 s42, s42, 4096
    s_add_u32 s43, s43, 4096
BG_23:
    s_barrier
    ds_read_b32 v240, v253 offset:0
    ds_read_b32 v241, v253 offset:1024
    ds_read_b32 v248, v253 offset:2048
    ds_read_b32 v249, v253 offset:3072
    s_nop 4
    s_nop 0
    v_pk_fma_f32 v[128:129], v[128:129], v[144:145], v[176:177]
    v_pk_fma_f32 v[130:131], v[130:131], v[146:147], v[178:179]
    v_pk_fma_f32 v[132:133], v[132:133], v[148:149], v[180:181]
    v_pk_fma_f32 v[134:135], v[134:135], v[150:151], v[182:183]
    v_pk_fma_f32 v[136:137], v[136:137], v[152:153], v[184:185]
    v_pk_fma_f32 v[138:139], v[138:139], v[154:155], v[186:187]
    v_pk_fma_f32 v[140:141], v[140:141], v[156:157], v[188:189]
    v_pk_fma_f32 v[142:143], v[142:143], v[158:159], v[190:191]
    v_cvt_pk_bf16_f32 v232, v128, v129
    v_cvt_pk_bf16_f32 v233, v130, v131
    v_cvt_pk_bf16_f32 v234, v132, v133
    v_cvt_pk_bf16_f32 v235, v134, v135
    v_cvt_pk_bf16_f32 v236, v136, v137
    v_cvt_pk_bf16_f32 v237, v138, v139
    v_cvt_pk_bf16_f32 v238, v140, v141
    v_cvt_pk_bf16_f32 v239, v142, v143
    v_mov_b32 v208, 0
    v_mov_b32 v210, 0
    v_lshlrev_b32 v128, 16, v232
    v_and_b32 v129, s100, v232
    v_lshlrev_b32 v130, 16, v233
    v_and_b32 v131, s100, v233
    v_lshlrev_b32 v132, 16, v234
    v_and_b32 v133, s100, v234
    v_lshlrev_b32 v134, 16, v235
    v_and_b32 v135, s100, v235
    v_lshlrev_b32 v136, 16, v236
    v_and_b32 v137, s100, v236
    v_lshlrev_b32 v138, 16, v237
    v_and_b32 v139, s100, v237
    v_lshlrev_b32 v140, 16, v238
    v_and_b32 v141, s100, v238
    v_lshlrev_b32 v142, 16, v239
    v_and_b32 v143, s100, v239
    v_pk_mul_f32 v[128:129], v[128:129], v[160:161]
    v_pk_mul_f32 v[130:131], v[130:131], v[162:163]
    v_pk_mul_f32 v[132:133], v[132:133], v[164:165]
    v_pk_mul_f32 v[134:135], v[134:135], v[166:167]
    v_pk_mul_f32 v[136:137], v[136:137], v[168:169]
    v_pk_mul_f32 v[138:139], v[138:139], v[170:171]
    v_pk_mul_f32 v[140:141], v[140:141], v[172:173]
    v_pk_mul_f32 v[142:143], v[142:143], v[174:175]
    v_cvt_pk_bf16_f32 v200, v128, v129
    v_cvt_pk_bf16_f32 v201, v130, v131
    v_cvt_pk_bf16_f32 v202, v132, v133
    v_cvt_pk_bf16_f32 v203, v134, v135
    v_cvt_pk_bf16_f32 v204, v136, v137
    v_cvt_pk_bf16_f32 v205, v138, v139
    v_cvt_pk_bf16_f32 v206, v140, v141
    v_cvt_pk_bf16_f32 v207, v142, v143
    s_lshr_b32 s8, s11, 5
    s_mul_i32 s10, s2, 28
    s_lshl_b32 s9, s8, 1
    s_add_u32 s10, s10, s9
    s_lshl_b32 s10, s10, 10
    s_add_u32 s10, s10, 4194304
    s_waitcnt lgkmcnt(0)
    v_or3_b32 v240, v240, v241, v248
    v_or_b32_e64 v240, v240, v249
    s_nop 0
    v_readfirstlane_b32 s9, v240
    s_nop 0
    s_cmp_eq_u32 s9, 0
    s_cbranch_scc1 L_sb_ok
    s_add_u32 s95, s95, 1
    s_cmp_gt_u32 s95, 200000
    s_cbranch_scc1 L_sb_ok
    s_barrier
    s_branch L_sb_retry
L_sb_ok:
    buffer_store_dwordx4 v[200:203], v246, s[84:87], s10 offen sc1
    buffer_store_dwordx4 v[204:207], v246, s[84:87], s10 offen offset:1024 sc1
    v_dot2c_f32_bf16 v208, s101, v232
    v_dot2c_f32_bf16 v210, v232, v232
    v_dot2c_f32_bf16 v208, s101, v233
    v_dot2c_f32_bf16 v210, v233, v233
    v_dot2c_f32_bf16 v208, s101, v234
    v_dot2c_f32_bf16 v210, v234, v234
    v_dot2c_f32_bf16 v208, s101, v235
    v_dot2c_f32_bf16 v210, v235, v235
    v_dot2c_f32_bf16 v208, s101, v236
    v_dot2c_f32_bf16 v210, v236, v236
    v_dot2c_f32_bf16 v208, s101, v237
    v_dot2c_f32_bf16 v210, v237, v237
    v_dot2c_f32_bf16 v208, s101, v238
    v_dot2c_f32_bf16 v210, v238, v238
    v_dot2c_f32_bf16 v208, s101, v239
    v_dot2c_f32_bf16 v210, v239, v239
    s_nop 2
    v_permlane32_swap_b32 v208, v210
    v_add_f32 v208, v208, v210
    v_mov_b32 v210, v208
    s_nop 1
    v_permlane32_swap_b32 v208, v210
    v_mov_b32_e64 v209, v210
    s_lshl_b32 s9, s2, 4
    s_add_u32 s9, s9, s8
    s_lshl_b32 s9, s9, 8
    s_add_u32 s9, s9, 262144
    v_lshlrev_b32_e64 v244, 3, v255
    v_add3_u32 v249, v200, v201, v202
    v_add3_u32 v249, v249, v203, v204
    v_add3_u32 v249, v249, v205, v206
    v_add_u32 v249, v249, v207
    v_mov_b32_e64 v248, s91
    s_mov_b32 exec_hi, 0
    buffer_store_dwordx2 v[208:209], v244, s[84:87], s9 offen sc1
    v_add3_u32 v249, v249, v208, v209
    s_mov_b64 exec, -1
    s_lshl_b32 s8, s8, 3
    s_lshl_b32 s9, s2, 7
    s_add_u32 s8, s8, s9
    s_add_u32 s8, s8, 32768
    v_add_u32_dpp v249, v249, v249 row_shr:1 row_mask:0xf bank_mask:0xf bound_ctrl:0
    s_nop 1
    v_add_u32_dpp v249, v249, v249 row_shr:2 row_mask:0xf bank_mask:0xf bound_ctrl:0
    s_nop 1
    v_add_u32_dpp v249, v249, v249 row_shr:4 row_mask:0xf bank_mask:0xf bound_ctrl:0
    s_nop 1
    v_add_u32_dpp v249, v249, v249 row_shr:8 row_mask:0xf bank_mask:0xf bound_ctrl:0
    s_nop 1
    v_add_u32_dpp v249, v249, v249 row_bcast:15 row_mask:0xa bank_mask:0xf
    s_nop 1
    v_add_u32_dpp v249, v249, v249 row_bcast:31 row_mask:0xc bank_mask:0xf
    s_mov_b32 exec_lo, 0
    s_brev_b32 exec_hi, 1
    buffer_store_dwordx2 v[248:249], v254, s[84:87], s8 offen offset:0 sc1
    s_mov_b64 exec, -1
    s_or_b32 s8, s6, s7
    s_or_b32 s8, s8, s3
    s_cmp_lg_u32 s8, 0
    s_cbranch_scc1 L_p2b_j
    s_add_u32 s8, s13, 1
    v_mov_b32_e64 v244, s8
    s_mov_b64 exec, 1
    buffer_store_dword v244, v254, s[84:87], 0 offen sc1
    s_mov_b64 exec, -1
    s_branch L_p2b_j
L_p2b_alt:
    s_waitcnt lgkmcnt(0)
    s_barrier
    s_lshl_b32 s8, s6, 1
    s_add_u32 s8, s8, s7
    s_sub_u32 s8, s8, 14
    s_lshl_b32 s8, s8, 2
    s_add_u32 s11, s8, s3
    s_cmp_ge_u32 s11, 112
    s_cbranch_scc1 L_ax_done
    s_mul_i32 s8, s11, 9363
    s_lshr_b32 s8, s8, 16
    s_lshl_b32 s8, s8, 7
    s_add_u32 s8, s8, 118784
    v_lshlrev_b32_e64 v244, 2, v255
    s_mov_b64 exec, 0xfffffff
P_24:
    buffer_load_dword v245, v244, s[84:87], s8 offen sc1
    s_waitcnt vmcnt(0)
    v_cmp_ne_u32 vcc, s93, v245
    s_add_u32 s95, s95, 1
    s_cmp_gt_u32 s95, 200000
    s_cbranch_scc1 PX_25
    s_cbranch_vccz PX_25
    s_sleep 1
    s_branch P_24
PX_25:
    s_mov_b64 exec, -1
    s_mul_i32 s8, s11, 28672
    s_add_u32 s8, s8, 6291456
    buffer_load_dwordx4 v[0:3], v246, s[84:87], s8 offen offset:0 sc1
    buffer_load_dwordx4 v[4:7], v246, s[84:87], s8 offen offset:1024 sc1
    buffer_load_dwordx4 v[8:11], v246, s[84:87], s8 offen offset:2048 sc1
    buffer_load_dwordx4 v[12:15], v246, s[84:87], s8 offen offset:3072 sc1
    s_add_u32 s8, s8, 4096
    buffer_load_dwordx4 v[16:19], v246, s[84:87], s8 offen offset:0 sc1
    buffer_load_dwordx4 v[20:23], v246, s[84:87], s8 offen offset:1024 sc1
    buffer_load_dwordx4 v[24:27], v246, s[84:87], s8 offen offset:2048 sc1
    buffer_load_dwordx4 v[28:31], v246, s[84:87], s8 offen offset:3072 sc1
    s_add_u32 s8, s8, 4096
    buffer_load_dwordx4 v[32:35], v246, s[84:87], s8 offen offset:0 sc1
    buffer_load_dwordx4 v[36:39], v246, s[84:87], s8 offen offset:1024 sc1
    buffer_load_dwordx4 v[40:43], v246, s[84:87], s8 offen offset:2048 sc1
    buffer_load_dwordx4 v[44:47], v246, s[84:87], s8 offen offset:3072 sc1
    s_add_u32 s8, s8, 4096
    buffer_load_dwordx4 v[48:51], v246, s[84:87], s8 offen offset:0 sc1
    buffer_load_dwordx4 v[52:55], v246, s[84:87], s8 offen offset:1024 sc1
    buffer_load_dwordx4 v[56:59], v246, s[84:87], s8 offen offset:2048 sc1
    buffer_load_dwordx4 v[60:63], v246, s[84:87], s8 offen offset:3072 sc1
    s_add_u32 s8, s8, 4096
    buffer_load_dwordx4 v[64:67], v246, s[84:87], s8 offen offset:0 sc1
    buffer_load_dwordx4 v[68:71], v246, s[84:87], s8 offen offset:1024 sc1
    buffer_load_dwordx4 v[72:75], v246, s[84:87], s8 offen offset:2048 sc1
    buffer_load_dwordx4 v[76:79], v246, s[84:87], s8 offen offset:3072 sc1
    s_add_u32 s8, s8, 4096
    buffer_load_dwordx4 v[80:83], v246, s[84:87], s8 offen offset:0 sc1
    buffer_load_dwordx4 v[84:87], v246, s[84:87], s8 offen offset:1024 sc1
    buffer_load_dwordx4 v[88:91], v246, s[84:87], s8 offen offset:2048 sc1
    buffer_load_dwordx4 v[92:95], v246, s[84:87], s8 offen offset:3072 sc1
    s_add_u32 s8, s8, 4096
    buffer_load_dwordx4 v[96:99], v246, s[84:87], s8 offen offset:0 sc1
    buffer_load_dwordx4 v[100:103], v246, s[84:87], s8 offen offset:1024 sc1
    buffer_load_dwordx4 v[104:107], v246, s[84:87], s8 offen offset:2048 sc1
    buffer_load_dwordx4 v[108:111], v246, s[84:87], s8 offen offset:3072 sc1
    s_add_u32 s8, s8, 4096
    v_lshlrev_b32 v244, 3, v255
    v_and_b32 v240, 0x39, v255
    v_bfe_u32 v241, v255, 1, 1
    v_lshl_or_b32 v240, v241, 2, v240
    v_bfe_u32 v241, v255, 2, 1
    v_lshl_or_b32 v240, v241, 1, v240
    s_lshl_b32 s9, s12, 2
    s_nop 0
    v_lshl_add_u32 v245, v240, 2, s9
    s_mov_b32 s8, 9472
L_ax_p:
    buffer_load_dwordx2 v[112:113], v244, s[84:87], s8 offen offset:1792 sc1
    buffer_load_dwordx2 v[120:121], v244, s[84:87], s8 offen offset:0 sc1
    buffer_load_dwordx2 v[114:115], v244, s[84:87], s8 offen offset:2304 sc1
    buffer_load_dwordx2 v[122:123], v244, s[84:87], s8 offen offset:512 sc1
    buffer_load_dwordx2 v[116:117], v244, s[84:87], s8 offen offset:2816 sc1
    buffer_load_dwordx2 v[124:125], v244, s[84:87], s8 offen offset:1024 sc1
    buffer_load_dwordx2 v[118:119], v244, s[84:87], s8 offen offset:3328 sc1
    buffer_load_dwordx2 v[126:127], v244, s[84:87], s8 offen offset:1536 sc1
    s_waitcnt vmcnt(0)
    v_mov_b32 v128, 0
    v_xor_b32 v113, s88, v113
    v_or_b32 v128, v128, v113
    v_xor_b32 v115, s88, v115
    v_or_b32 v128, v128, v115
    v_xor_b32 v117, s88, v117
    v_or_b32 v128, v128, v117
    v_xor_b32 v119, s88, v119
    v_or_b32 v128, v128, v119
    v_xor_b32 v121, s88, v121
    v_or_b32 v128, v128, v121
    v_xor_b32 v123, s88, v123
    v_or_b32 v128, v128, v123
    v_xor_b32 v125, s88, v125
    v_or_b32 v128, v128, v125
    v_xor_b32 v127, s88, v127
    v_or_b32 v128, v128, v127
    v_cmp_ne_u32 vcc, 0, v128
    s_add_u32 s95, s95, 1
    s_cmp_gt_u32 s95, 200000
    s_cbranch_scc1 L_ax_px
    s_cbranch_vccnz L_ax_p
L_ax_px:
    ds_write_b32 v245, v112 offset:0
    ds_write_b32 v245, v120 offset:896
    ds_write_b32 v245, v114 offset:256
    ds_write_b32 v245, v122 offset:1152
    ds_write_b32 v245, v116 offset:512
    ds_write_b32 v245, v124 offset:1408
    s_mov_b32 exec_hi, 0
    ds_write_b32 v245, v118 offset:768
    ds_write_b32 v245, v126 offset:1664
    s_mov_b64 exec, -1
    v_and_b32_e64 v240, 1, v255
    v_mul_u32_u24 v240, 896, v240
    v_lshrrev_b32_e64 v241, 5, v255
    v_lshl_add_u32 v240, v241, 4, v240
    v_add_u32 v240, s9, v240
    s_waitcnt lgkmcnt(0)
    ds_read_b128 v[128:131], v240 offset:0
    ds_read_b128 v[132:135], v240 offset:32
    ds_read_b128 v[136:139], v240 offset:64
    ds_read_b128 v[140:143], v240 offset:96
    ds_read_b128 v[144:147], v240 offset:128
    ds_read_b128 v[148:151], v240 offset:160
    ds_read_b128 v[152:155], v240 offset:192
    ds_read_b128 v[156:159], v240 offset:224
    ds_read_b128 v[160:163], v240 offset:256
    ds_read_b128 v[164:167], v240 offset:288
    ds_read_b128 v[168:171], v240 offset:320
    ds_read_b128 v[172:175], v240 offset:352
    ds_read_b128 v[176:179], v240 offset:384
    ds_read_b128 v[180:183], v240 offset:416
    s_waitcnt lgkmcnt(0)
    s_nop 0
    v_mfma_f32_32x32x16_bf16 v[112:127], v[0:3], v[128:131], 0
    v_mfma_f32_32x32x16_bf16 v[112:127], v[4:7], v[132:135], v[112:127]
    v_mfma_f32_32x32x16_bf16 v[112:127], v[8:11], v[136:139], v[112:127]
    v_mfma_f32_32x32x16_bf16 v[112:127], v[12:15], v[140:143], v[112:127]
    v_mfma_f32_32x32x16_bf16 v[112:127], v[16:19], v[144:147], v[112:127]
    v_mfma_f32_32x32x16_bf16 v[112:127], v[20:23], v[148:151], v[112:127]
    v_mfma_f32_32x32x16_bf16 v[112:127], v[24:27], v[152:155], v[112:127]
    v_mfma_f32_32x32x16_bf16 v[112:127], v[28:31], v[156:159], v[112:127]
    v_mfma_f32_32x32x16_bf16 v[112:127], v[32:35], v[160:163], v[112:127]
    v_mfma_f32_32x32x16_bf16 v[112:127], v[36:39], v[164:167], v[112:127]
    v_mfma_f32_32x32x16_bf16 v[112:127], v[40:43], v[168:171], v[112:127]
    v_mfma_f32_32x32x16_bf16 v[112:127], v[44:47], v[172:175], v[112:127]
    v_mfma_f32_32x32x16_bf16 v[112:127], v[48:51], v[176:179], v[112:127]
    v_mfma_f32_32x32x16_bf16 v[112:127], v[52:55], v[180:183], v[112:127]
    ds_read_b128 v[128:131], v240 offset:448
    ds_read_b128 v[132:135], v240 offset:480
    ds_read_b128 v[136:139], v240 offset:512
    ds_read_b128 v[140:143], v240 offset:544
    ds_read_b128 v[144:147], v240 offset:576
    ds_read_b128 v[148:151], v240 offset:608
    ds_read_b128 v[152:155], v240 offset:640
    ds_read_b128 v[156:159], v240 offset:672
    ds_read_b128 v[160:163], v240 offset:704
    ds_read_b128 v[164:167], v240 offset:736
    ds_read_b128 v[168:171], v240 offset:768
    ds_read_b128 v[172:175], v240 offset:800
    ds_read_b128 v[176:179], v240 offset:832
    ds_read_b128 v[180:183], v240 offset:864
    s_waitcnt lgkmcnt(0)
    s_nop 0
    v_mfma_f32_32x32x16_bf16 v[112:127], v[56:59], v[128:131], v[112:127]
    v_mfma_f32_32x32x16_bf16 v[112:127], v[60:63], v[132:135], v[112:127]
    v_mfma_f32_32x32x16_bf16 v[112:127], v[64:67], v[136:139], v[112:127]
    v_mfma_f32_32x32x16_bf16 v[112:127], v[68:71], v[140:143], v[112:127]
    v_mfma_f32_32x32x16_bf16 v[112:127], v[72:75], v[144:147], v[112:127]
    v_mfma_f32_32x32x16_bf16 v[112:127], v[76:79], v[148:151], v[112:127]
    v_mfma_f32_32x32x16_bf16 v[112:127], v[80:83], v[152:155], v[112:127]
    v_mfma_f32_32x32x16_bf16 v[112:127], v[84:87], v[156:159], v[112:127]
    v_mfma_f32_32x32x16_bf16 v[112:127], v[88:91], v[160:163], v[112:127]
    v_mfma_f32_32x32x16_bf16 v[112:127], v[92:95], v[164:167], v[112:127]
    v_mfma_f32_32x32x16_bf16 v[112:127], v[96:99], v[168:171], v[112:127]
    v_mfma_f32_32x32x16_bf16 v[112:127], v[100:103], v[172:175], v[112:127]
    v_mfma_f32_32x32x16_bf16 v[112:127], v[104:107], v[176:179], v[112:127]
    v_mfma_f32_32x32x16_bf16 v[112:127], v[108:111], v[180:183], v[112:127]
    v_and_b32 v240, 1, v255
    v_lshlrev_b32 v240, 7, v240
    v_lshl_add_u32 v240, v241, 4, v240
    v_add_u32 v240, s9, v240
    s_mov_b32 exec_lo, 3
    s_mov_b32 exec_hi, 3
    s_nop 5
    ds_write_b128 v240, v[112:115] offset:2048
    ds_write_b128 v240, v[116:119] offset:2080
    ds_write_b128 v240, v[120:123] offset:2112
    ds_write_b128 v240, v[124:127] offset:2144
    s_mov_b64 exec, -1
    v_and_b32 v240, 31, v255
    v_lshl_add_u32 v240, v240, 2, s9
    s_waitcnt lgkmcnt(0)
    ds_read_b32 v130, v240 offset:2048
    ds_read_b32 v131, v240 offset:2176
    s_waitcnt lgkmcnt(0)
    v_cvt_pk_bf16_f32 v136, v130, v130
    v_and_b32 v136, s100, v136
    v_sub_f32 v137, v130, v136
    v_cvt_pk_bf16_f32 v132, v136, v137
    v_cvt_pk_bf16_f32 v136, v131, v131
    v_and_b32 v136, s100, v136
    v_sub_f32 v137, v131, v136
    v_cvt_pk_bf16_f32 v133, v136, v137
    v_mov_b32 v134, 0
    v_mov_b32 v135, s94
    s_mov_b64 exec, s[98:99]
    v_mov_b32 v132, 0
    v_mov_b32_e64 v133, 0
    s_mov_b64 exec, -1
    s_lshl_b32 s8, s11, 10
    s_add_u32 s8, s8, 131072
    buffer_store_dwordx4 v[132:135], v246, s[84:87], s8 offen sc1
L_ax_done:
    s_barrier
    s_barrier
L_p2b_j:
BD_26:
    s_cmp_eq_u32 s14, 0
    s_cbranch_scc1 BX_27
    s_mov_b32 m0, s42
    s_sub_u32 s14, s14, 1
    buffer_load_dwordx4 v246, s[84:87], s43 offen sc1 lds
    s_add_u32 s42, s42, 4096
    s_add_u32 s43, s43, 4096
    s_branch BD_26
BX_27:
    s_add_u32 s42, s12, 0
    s_mov_b32 s14, 14
    s_mov_b32 m0, s42
    s_sub_u32 s14, s14, 1
    buffer_load_dwordx4 v246, s[84:87], s43 offen sc1 lds
    s_add_u32 s42, s42, 4096
    s_add_u32 s43, s43, 4096
    s_mov_b32 m0, s42
    s_sub_u32 s14, s14, 1
    buffer_load_dwordx4 v246, s[84:87], s43 offen sc1 lds
    s_add_u32 s42, s42, 4096
    s_add_u32 s43, s43, 4096
    s_mov_b32 m0, s42
    s_sub_u32 s14, s14, 1
    buffer_load_dwordx4 v246, s[84:87], s43 offen sc1 lds
    s_add_u32 s42, s42, 4096
    s_add_u32 s43, s43, 4096
    s_mov_b32 m0, s42
    s_sub_u32 s14, s14, 1
    buffer_load_dwordx4 v246, s[84:87], s43 offen sc1 lds
    s_add_u32 s42, s42, 4096
    s_add_u32 s43, s43, 4096
    s_mov_b32 m0, s42
    s_sub_u32 s14, s14, 1
    buffer_load_dwordx4 v246, s[84:87], s43 offen sc1 lds
    s_add_u32 s42, s42, 4096
    s_add_u32 s43, s43, 4096
    s_mov_b32 m0, s42
    s_sub_u32 s14, s14, 1
    s_nop 0
    buffer_load_dwordx4 v246, s[84:87], s43 offen sc1 lds
    s_add_u32 s42, s42, 4096
    s_add_u32 s43, s43, 4096
    v_add_u32 v240, 65536, v246
    v_add_u32 v241, 122880, v246
    s_lshl_b32 s11, s41, 2
    s_add_u32 s11, s11, s3
    s_lshl_b32 s8, s11, 7
    s_add_u32 s8, s8, 32768
    v_lshlrev_b32 v244, 3, v255
    v_and_b32 v242, 31, v255
    v_lshrrev_b32 v243, 5, v255
    v_lshlrev_b32_e64 v242, 3, v242
    v_mul_u32_u24 v243, 1792, v243
    v_add_u32 v242, v242, v243
    s_lshl_b32 s49, s11, 12
    s_add_u32 s49, s49, 262144
    s_mul_i32 s50, s40, 7168
    s_add_u32 s50, s50, 131072
    s_mul_i32 s48, s11, 28672
    s_add_u32 s48, s48, 4194304
    s_mul_i32 s52, s11, 112
    s_mul_i32 s9, s40, 7
    s_add_u32 s52, s52, s9
    s_lshl_b32 s52, s52, 10
    s_add_u32 s52, s52, 11534336
    s_add_u32 s9, s52, 4096
    s_lshl_b32 s10, s41, 2
    s_lshr_b32 s11, s40, 2
    s_add_u32 s10, s10, s11
    s_lshl_b32 s10, s10, 7
    s_and_b32 s11, s40, 3
    s_lshl_b32 s11, s11, 2
    s_add_u32 s11, s11, s3
    s_lshl_b32 s11, s11, 3
    s_add_u32 s10, s10, s11
    s_add_u32 s10, s10, 40960
    s_and_b32 s11, s7, 1
    s_lshl_b32 s11, s11, 1
    v_lshrrev_b32 v243, 1, v255
    v_lshlrev_b32 v243, 5, v243
    v_and_b32 v245, 1, v255
    v_add_u32 v245, s11, v245
    v_lshl_add_u32 v243, v245, 3, v243
    s_mov_b32 s53, 0
    v_mov_b32 v250, 0
    s_mov_b64 exec, 0x3fff
    buffer_load_dwordx2 v[252:253], v244, s[84:87], s8 offen sc1
    s_mov_b64 exec, -1
    s_mov_b32 s13, s48
    buffer_load_dwordx4 v[0:3], v246, s[84:87], s13 offen offset:0 sc1
    buffer_load_dwordx4 v[4:7], v246, s[84:87], s13 offen offset:1024 sc1
    buffer_load_dwordx4 v[8:11], v246, s[84:87], s13 offen offset:2048 sc1
    buffer_load_dwordx4 v[12:15], v246, s[84:87], s13 offen offset:3072 sc1
    s_add_u32 s13, s13, 4096
    buffer_load_dwordx4 v[16:19], v246, s[84:87], s13 offen offset:0 sc1
    buffer_load_dwordx4 v[20:23], v246, s[84:87], s13 offen offset:1024 sc1
    buffer_load_dwordx4 v[24:27], v246, s[84:87], s13 offen offset:2048 sc1
    buffer_load_dwordx4 v[28:31], v246, s[84:87], s13 offen offset:3072 sc1
    s_waitcnt vmcnt(8)
    s_mov_b64 exec, 0x3fff
    v_cmp_ne_u32 vcc, s91, v252
    v_sub_u32_e64 v250, v250, v253
    s_mov_b64 exec, -1
    s_cbranch_vccz H_28
    s_mov_b64 exec, 0x3fff
    v_add_u32 v250, v250, v253
    s_mov_b64 exec, -1
    s_mov_b64 exec, 0x3fff
P_29:
    buffer_load_dwordx2 v[252:253], v244, s[84:87], s8 offen sc1
    s_waitcnt vmcnt(0)
    v_cmp_ne_u32 vcc, s91, v252
    s_add_u32 s95, s95, 1
    s_cmp_gt_u32 s95, 200000
    s_cbranch_scc1 PX_30
    s_cbranch_vccz PX_30
    s_sleep 1
    s_branch P_29
PX_30:
    v_sub_u32 v250, v250, v253
    s_mov_b64 exec, -1
L_sc_retry:
    s_mov_b32 s13, s48
    buffer_load_dwordx4 v[0:3], v246, s[84:87], s13 offen offset:0 sc1
    buffer_load_dwordx4 v[4:7], v246, s[84:87], s13 offen offset:1024 sc1
    buffer_load_dwordx4 v[8:11], v246, s[84:87], s13 offen offset:2048 sc1
    buffer_load_dwordx4 v[12:15], v246, s[84:87], s13 offen offset:3072 sc1
    s_add_u32 s13, s13, 4096
    buffer_load_dwordx4 v[16:19], v246, s[84:87], s13 offen offset:0 sc1
    buffer_load_dwordx4 v[20:23], v246, s[84:87], s13 offen offset:1024 sc1
    buffer_load_dwordx4 v[24:27], v246, s[84:87], s13 offen offset:2048 sc1
    buffer_load_dwordx4 v[28:31], v246, s[84:87], s13 offen offset:3072 sc1
H_28:
    v_mov_b32 v252, s92
    s_mov_b32 s8, s52
    s_cmp_lg_u32 s53, 0
    s_cbranch_scc1 L_sc_go
    s_mov_b32 s53, 1
    s_barrier
L_sc_go:
    v_mov_b32_e64 v251, v250
    buffer_load_dwordx2 v[194:195], v242, s[84:87], s49 offen offset:0 sc1
    buffer_load_dwordx2 v[196:197], v242, s[84:87], s49 offen offset:256 sc1
    buffer_load_dwordx2 v[198:199], v242, s[84:87], s49 offen offset:512 sc1
    buffer_load_dwordx2 v[200:201], v242, s[84:87], s49 offen offset:768 sc1
    buffer_load_dwordx2 v[202:203], v242, s[84:87], s49 offen offset:1024 sc1
    buffer_load_dwordx2 v[204:205], v242, s[84:87], s49 offen offset:1280 sc1
    buffer_load_dwordx2 v[206:207], v242, s[84:87], s49 offen offset:1536 sc1
    s_waitcnt vmcnt(14)
    s_nop 0
    ds_read_b128 v[160:163], v240 offset:0
    ds_read_b128 v[164:167], v240 offset:28672
    ds_read_b128 v[168:171], v241 offset:0
    ds_read_b128 v[172:175], v240 offset:1024
    ds_read_b128 v[176:179], v240 offset:29696
    ds_read_b128 v[180:183], v241 offset:1024
    s_waitcnt lgkmcnt(5)
    v_mfma_f32_32x32x16_bf16 v[112:127], v[160:163], v[0:3], 0
    s_add_u32 s13, s13, 4096
    buffer_load_dwordx4 v[32:35], v246, s[84:87], s13 offen offset:0 sc1
    ds_read_b128 v[184:187], v240 offset:2048
    s_waitcnt lgkmcnt(5)
    v_mfma_f32_32x32x16_bf16 v[128:143], v[164:167], v[0:3], 0
    ds_read_b128 v[188:191], v240 offset:30720
    v_add3_u32 v251, v251, v0, v1
    v_add3_u32 v251, v251, v2, v3
    s_waitcnt lgkmcnt(5)
    v_mfma_f32_32x32x16_bf16 v[144:159], v[168:171], v[0:3], 0
    buffer_load_dwordx4 v[36:39], v246, s[84:87], s13 offen offset:1024 sc1
    ds_read_b128 v[160:163], v241 offset:2048
    s_waitcnt vmcnt(15)
    s_waitcnt lgkmcnt(5)
    v_mfma_f32_32x32x16_bf16 v[112:127], v[172:175], v[4:7], v[112:127]
    ds_read_b128 v[164:167], v240 offset:3072
    s_waitcnt lgkmcnt(5)
    v_mfma_f32_32x32x16_bf16 v[128:143], v[176:179], v[4:7], v[128:143]
    buffer_load_dwordx4 v[40:43], v246, s[84:87], s13 offen offset:2048 sc1
    ds_read_b128 v[168:171], v240 offset:31744
    v_add3_u32 v251, v251, v4, v5
    v_add3_u32 v251, v251, v6, v7
    s_waitcnt lgkmcnt(5)
    v_mfma_f32_32x32x16_bf16 v[144:159], v[180:183], v[4:7], v[144:159]
    ds_read_b128 v[172:175], v241 offset:3072
    s_waitcnt vmcnt(15)
    s_waitcnt lgkmcnt(5)
    v_mfma_f32_32x32x16_bf16 v[112:127], v[184:187], v[8:11], v[112:127]
    buffer_load_dwordx4 v[44:47], v246, s[84:87], s13 offen offset:3072 sc1
    ds_read_b128 v[176:179], v240 offset:4096
    s_waitcnt lgkmcnt(5)
    v_mfma_f32_32x32x16_bf16 v[128:143], v[188:191], v[8:11], v[128:143]
    ds_read_b128 v[180:183], v240 offset:32768
    v_add3_u32 v251, v251, v8, v9
    v_add3_u32 v251, v251, v10, v11
    s_waitcnt lgkmcnt(5)
    v_mfma_f32_32x32x16_bf16 v[144:159], v[160:163], v[8:11], v[144:159]
    s_add_u32 s13, s13, 4096
    buffer_load_dwordx4 v[48:51], v246, s[84:87], s13 offen offset:0 sc1
    ds_read_b128 v[184:187], v241 offset:4096
    s_waitcnt vmcnt(16)
    s_waitcnt lgkmcnt(5)
    v_mfma_f32_32x32x16_bf16 v[112:127], v[164:167], v[12:15], v[112:127]
    ds_read_b128 v[188:191], v240 offset:5120
    s_waitcnt lgkmcnt(5)
    v_mfma_f32_32x32x16_bf16 v[128:143], v[168:171], v[12:15], v[128:143]
    buffer_load_dwordx4 v[52:55], v246, s[84:87], s13 offen offset:1024 sc1
    ds_read_b128 v[160:163], v240 offset:33792
    v_add3_u32 v251, v251, v12, v13
    v_add3_u32 v251, v251, v14, v15
    s_waitcnt lgkmcnt(5)
    v_mfma_f32_32x32x16_bf16 v[144:159], v[172:175], v[12:15], v[144:159]
    ds_read_b128 v[164:167], v241 offset:5120
    s_waitcnt vmcnt(16)
    s_waitcnt lgkmcnt(5)
    v_mfma_f32_32x32x16_bf16 v[112:127], v[176:179], v[16:19], v[112:127]
    buffer_load_dwordx4 v[56:59], v246, s[84:87], s13 offen offset:2048 sc1
    ds_read_b128 v[168:171], v240 offset:6144
    s_waitcnt lgkmcnt(5)
    v_mfma_f32_32x32x16_bf16 v[128:143], v[180:183], v[16:19], v[128:143]
    ds_read_b128 v[172:175], v240 offset:34816
    v_add3_u32 v251, v251, v16, v17
    v_add3_u32 v251, v251, v18, v19
    s_waitcnt lgkmcnt(5)
    v_mfma_f32_32x32x16_bf16 v[144:159], v[184:187], v[16:19], v[144:159]
    buffer_load_dwordx4 v[60:63], v246, s[84:87], s13 offen offset:3072 sc1
    ds_read_b128 v[176:179], v241 offset:6144
    s_waitcnt vmcnt(17)
    v_add3_u32 v251, v251, v20, v21
    v_add3_u32 v251, v251, v22, v23
    s_waitcnt vmcnt(17)
    s_waitcnt lgkmcnt(5)
    v_mfma_f32_32x32x16_bf16 v[112:127], v[188:191], v[20:23], v[112:127]
    ds_read_b128 v[180:183], v240 offset:7168
    s_waitcnt lgkmcnt(5)
    v_mfma_f32_32x32x16_bf16 v[128:143], v[160:163], v[20:23], v[128:143]
    s_add_u32 s13, s13, 4096
    buffer_load_dwordx4 v[64:67], v246, s[84:87], s13 offen offset:0 sc1
    ds_read_b128 v[184:187], v240 offset:35840
    s_waitcnt vmcnt(17)
    v_add3_u32 v251, v251, v24, v25
    v_add3_u32 v251, v251, v26, v27
    s_waitcnt lgkmcnt(5)
    v_mfma_f32_32x32x16_bf16 v[144:159], v[164:167], v[20:23], v[144:159]
    ds_read_b128 v[188:191], v241 offset:7168
    s_waitcnt vmcnt(17)
    s_waitcnt lgkmcnt(5)
    v_mfma_f32_32x32x16_bf16 v[112:127], v[168:171], v[24:27], v[112:127]
    buffer_load_dwordx4 v[68:71], v246, s[84:87], s13 offen offset:1024 sc1
    ds_read_b128 v[160:163], v240 offset:8192
    s_waitcnt lgkmcnt(5)
    v_mfma_f32_32x32x16_bf16 v[128:143], v[172:175], v[24:27], v[128:143]
    ds_read_b128 v[164:167], v240 offset:36864
    s_waitcnt vmcnt(17)
    v_add3_u32 v251, v251, v28, v29
    v_add3_u32 v251, v251, v30, v31
    s_waitcnt lgkmcnt(5)
    v_mfma_f32_32x32x16_bf16 v[144:159], v[176:179], v[24:27], v[144:159]
    buffer_load_dwordx4 v[72:75], v246, s[84:87], s13 offen offset:2048 sc1
    ds_read_b128 v[168:171], v241 offset:8192
    s_waitcnt vmcnt(18)
    s_waitcnt lgkmcnt(5)
    v_mfma_f32_32x32x16_bf16 v[112:127], v[180:183], v[28:31], v[112:127]
    ds_read_b128 v[172:175], v240 offset:9216
    s_waitcnt lgkmcnt(5)
    v_mfma_f32_32x32x16_bf16 v[128:143], v[184:187], v[28:31], v[128:143]
    buffer_load_dwordx4 v[76:79], v246, s[84:87], s13 offen offset:3072 sc1
    ds_read_b128 v[176:179], v240 offset:37888
    s_waitcnt vmcnt(11)
    v_add3_u32 v251, v251, v32, v33
    v_add3_u32 v251, v251, v34, v35
    s_waitcnt lgkmcnt(5)
    v_mfma_f32_32x32x16_bf16 v[144:159], v[188:191], v[28:31], v[144:159]
    ds_read_b128 v[180:183], v241 offset:9216
    s_waitcnt vmcnt(11)
    s_waitcnt lgkmcnt(5)
    v_mfma_f32_32x32x16_bf16 v[112:127], v[160:163], v[32:35], v[112:127]
    s_add_u32 s13, s13, 4096
    buffer_load_dwordx4 v[80:83], v246, s[84:87], s13 offen offset:0 sc1
    ds_read_b128 v[184:187], v240 offset:10240
    s_waitcnt lgkmcnt(5)
    v_mfma_f32_32x32x16_bf16 v[128:143], v[164:167], v[32:35], v[128:143]
    ds_read_b128 v[188:191], v240 offset:38912
    s_waitcnt vmcnt(11)
    v_add3_u32 v251, v251, v36, v37
    v_add3_u32 v251, v251, v38, v39
    s_waitcnt lgkmcnt(5)
    v_mfma_f32_32x32x16_bf16 v[144:159], v[168:171], v[32:35], v[144:159]
    buffer_load_dwordx4 v[84:87], v246, s[84:87], s13 offen offset:1024 sc1
    ds_read_b128 v[160:163], v241 offset:10240
    s_waitcnt vmcnt(11)
    v_add3_u32 v251, v251, v40, v41
    v_add3_u32 v251, v251, v42, v43
    s_waitcnt vmcnt(12)
    s_waitcnt lgkmcnt(5)
    v_mfma_f32_32x32x16_bf16 v[112:127], v[172:175], v[36:39], v[112:127]
    ds_read_b128 v[164:167], v240 offset:11264
    s_waitcnt lgkmcnt(5)
    v_mfma_f32_32x32x16_bf16 v[128:143], v[176:179], v[36:39], v[128:143]
    buffer_load_dwordx4 v[88:91], v246, s[84:87], s13 offen offset:2048 sc1
    ds_read_b128 v[168:171], v240 offset:39936
    s_waitcnt vmcnt(11)
    v_add3_u32 v251, v251, v44, v45
    v_add3_u32 v251, v251, v46, v47
    s_waitcnt lgkmcnt(5)
    v_mfma_f32_32x32x16_bf16 v[144:159], v[180:183], v[36:39], v[144:159]
    ds_read_b128 v[172:175], v241 offset:11264
    s_waitcnt vmcnt(12)
    s_waitcnt lgkmcnt(5)
    v_mfma_f32_32x32x16_bf16 v[112:127], v[184:187], v[40:43], v[112:127]
    buffer_load_dwordx4 v[92:95], v246, s[84:87], s13 offen offset:3072 sc1
    ds_read_b128 v[176:179], v240 offset:12288
    s_waitcnt lgkmcnt(5)
    v_mfma_f32_32x32x16_bf16 v[128:143], v[188:191], v[40:43], v[128:143]
    ds_read_b128 v[180:183], v240 offset:40960
    s_waitcnt vmcnt(11)
    v_add3_u32 v251, v251, v48, v49
    v_add3_u32 v251, v251, v50, v51
    s_waitcnt lgkmcnt(5)
    v_mfma_f32_32x32x16_bf16 v[144:159], v[160:163], v[40:43], v[144:159]
    s_add_u32 s13, s13, 4096
    buffer_load_dwordx4 v[96:99], v246, s[84:87], s13 offen offset:0 sc1
    ds_read_b128 v[184:187], v241 offset:12288
    s_waitcnt vmcnt(13)
    s_waitcnt lgkmcnt(5)
    v_mfma_f32_32x32x16_bf16 v[112:127], v[164:167], v[44:47], v[112:127]
    ds_read_b128 v[188:191], v240 offset:13312
    s_waitcnt lgkmcnt(5)
    v_mfma_f32_32x32x16_bf16 v[128:143], v[168:171], v[44:47], v[128:143]
    buffer_load_dwordx4 v[100:103], v246, s[84:87], s13 offen offset:1024 sc1
    ds_read_b128 v[160:163], v240 offset:41984
    s_waitcnt vmcnt(12)
    v_add3_u32 v251, v251, v52, v53
    v_add3_u32 v251, v251, v54, v55
    s_waitcnt lgkmcnt(5)
    v_mfma_f32_32x32x16_bf16 v[144:159], v[172:175], v[44:47], v[144:159]
    ds_read_b128 v[164:167], v241 offset:13312
    s_waitcnt vmcnt(13)
    s_waitcnt lgkmcnt(5)
    v_mfma_f32_32x32x16_bf16 v[112:127], v[176:179], v[48:51], v[112:127]
    buffer_load_dwordx4 v[104:107], v246, s[84:87], s13 offen offset:2048 sc1
    ds_read_b128 v[168:171], v240 offset:14336
    s_waitcnt lgkmcnt(5)
    v_mfma_f32_32x32x16_bf16 v[128:143], v[180:183], v[48:51], v[128:143]
    ds_read_b128 v[172:175], v240 offset:43008
    s_waitcnt vmcnt(12)
    v_add3_u32 v251, v251, v56, v57
    v_add3_u32 v251, v251, v58, v59
    s_waitcnt lgkmcnt(5)
    v_mfma_f32_32x32x16_bf16 v[144:159], v[184:187], v[48:51], v[144:159]
    buffer_load_dwordx4 v[108:111], v246, s[84:87], s13 offen offset:3072 sc1
    ds_read_b128 v[176:179], v241 offset:14336
    s_waitcnt vmcnt(12)
    v_add3_u32 v251, v251, v60, v61
    v_add3_u32 v251, v251, v62, v63
    s_waitcnt vmcnt(14)
    s_waitcnt lgkmcnt(5)
    v_mfma_f32_32x32x16_bf16 v[112:127], v[188:191], v[52:55], v[112:127]
    ds_read_b128 v[180:183], v240 offset:15360
    s_waitcnt lgkmcnt(5)
    v_mfma_f32_32x32x16_bf16 v[128:143], v[160:163], v[52:55], v[128:143]
    s_add_u32 s15, s50, 0
    buffer_load_dwordx4 a[224:227], v246, s[84:87], s15 offen sc1
    ds_read_b128 v[184:187], v240 offset:44032
    s_waitcnt vmcnt(12)
    v_add3_u32 v251, v251, v64, v65
    v_add3_u32 v251, v251, v66, v67
    s_waitcnt lgkmcnt(5)
    v_mfma_f32_32x32x16_bf16 v[144:159], v[164:167], v[52:55], v[144:159]
    ds_read_b128 v[188:191], v241 offset:15360
    s_waitcnt vmcnt(14)
    s_waitcnt lgkmcnt(5)
    v_mfma_f32_32x32x16_bf16 v[112:127], v[168:171], v[56:59], v[112:127]
    s_add_u32 s15, s50, 1024
    buffer_load_dwordx4 a[228:231], v246, s[84:87], s15 offen sc1
    ds_read_b128 v[160:163], v240 offset:16384
    s_waitcnt lgkmcnt(5)
    v_mfma_f32_32x32x16_bf16 v[128:143], v[172:175], v[56:59], v[128:143]
    ds_read_b128 v[164:167], v240 offset:45056
    s_waitcnt vmcnt(12)
    v_add3_u32 v251, v251, v68, v69
    v_add3_u32 v251, v251, v70, v71
    s_waitcnt vmcnt(22)
    s_waitcnt lgkmcnt(5)
    v_mfma_f32_32x32x16_bf16 v[144:159], v[176:179], v[56:59], v[144:159]
    s_add_u32 s15, s50, 2048
    buffer_load_dwordx4 a[232:235], v246, s[84:87], s15 offen sc1
    ds_read_b128 v[168:171], v241 offset:16384
    v_add3_u32 v251, v251, v194, v195
    v_add3_u32 v251, v251, v196, v197
    v_add3_u32 v251, v251, v198, v199
    s_waitcnt vmcnt(15)
    s_waitcnt lgkmcnt(5)
    v_mfma_f32_32x32x16_bf16 v[112:127], v[180:183], v[60:63], v[112:127]
    ds_read_b128 v[172:175], v240 offset:17408
    v_add3_u32 v251, v251, v200, v201
    v_add3_u32 v251, v251, v202, v203
    v_add3_u32 v251, v251, v204, v205
    s_waitcnt lgkmcnt(5)
    v_mfma_f32_32x32x16_bf16 v[128:143], v[184:187], v[60:63], v[128:143]
    s_add_u32 s15, s50, 3072
    buffer_load_dwordx4 a[236:239], v246, s[84:87], s15 offen sc1
    ds_read_b128 v[176:179], v240 offset:46080
    s_waitcnt vmcnt(13)
    v_add3_u32 v251, v251, v72, v73
    v_add3_u32 v251, v251, v74, v75
    v_add3_u32 v251, v251, v206, v207
    v_add_f32 v194, v194, v196
    v_add_f32_e64 v195, v195, v197
    s_waitcnt lgkmcnt(5)
    v_mfma_f32_32x32x16_bf16 v[144:159], v[188:191], v[60:63], v[144:159]
    ds_read_b128 v[180:183], v241 offset:17408
    v_add_f32 v194, v194, v198
    v_add_f32 v195, v195, v199
    v_add_f32_e64 v194, v194, v200
    s_waitcnt vmcnt(15)
    s_waitcnt lgkmcnt(5)
    v_mfma_f32_32x32x16_bf16 v[112:127], v[160:163], v[64:67], v[112:127]
    s_add_u32 s15, s50, 4096
    buffer_load_dwordx4 a[240:243], v246, s[84:87], s15 offen sc1
    ds_read_b128 v[184:187], v240 offset:18432
    v_add_f32 v195, v195, v201
    v_add_f32 v194, v194, v202
    v_add_f32 v195, v195, v203
    s_waitcnt lgkmcnt(5)
    v_mfma_f32_32x32x16_bf16 v[128:143], v[164:167], v[64:67], v[128:143]
    ds_read_b128 v[188:191], v240 offset:47104
    s_waitcnt vmcnt(13)
    v_add3_u32 v251, v251, v76, v77
    v_add3_u32 v251, v251, v78, v79
    v_add_f32 v194, v194, v204
    v_add_f32 v195, v195, v205
    v_add_f32_e64 v194, v194, v206
    s_waitcnt lgkmcnt(5)
    v_mfma_f32_32x32x16_bf16 v[144:159], v[168:171], v[64:67], v[144:159]
    s_add_u32 s15, s50, 5120
    buffer_load_dwordx4 a[244:247], v246, s[84:87], s15 offen sc1
    ds_read_b128 v[160:163], v241 offset:18432
    s_waitcnt vmcnt(13)
    v_add3_u32 v251, v251, v80, v81
    v_add3_u32 v251, v251, v82, v83
    v_add_f32 v195, v195, v207
    v_mov_b32 v196, v195
    s_nop 1
    v_permlane32_swap_b32_e64 v194, v196
    s_waitcnt vmcnt(16)
    s_waitcnt lgkmcnt(5)
    v_mfma_f32_32x32x16_bf16 v[112:127], v[172:175], v[68:71], v[112:127]
    ds_read_b128 v[164:167], v240 offset:19456
    v_add_f32 v194, v194, v196
    v_mov_b32 v196, v194
    s_nop 1
    v_permlane32_swap_b32_e64 v194, v196
    s_waitcnt lgkmcnt(5)
    v_mfma_f32_32x32x16_bf16 v[128:143], v[176:179], v[68:71], v[128:143]
    s_add_u32 s15, s50, 6144
    buffer_load_dwordx4 a[248:251], v246, s[84:87], s15 offen sc1
    ds_read_b128 v[168:171], v240 offset:48128
    s_waitcnt vmcnt(13)
    s_nop 0
    v_add3_u32 v251, v251, v84, v85
    v_add3_u32 v251, v251, v86, v87
    v_mul_f32 v194, 0x3b124925, v194
    v_mul_f32 v196, 0x3b124925, v196
    v_fma_f32 v196, -v194, v194, v196
    s_waitcnt lgkmcnt(5)
    v_mfma_f32_32x32x16_bf16 v[144:159], v[180:183], v[68:71], v[144:159]
    ds_read_b128 v[172:175], v241 offset:19456
    v_max_f32 v196, 0, v196
    v_cvt_pk_bf16_f32 v195, v194, v196
    v_lshlrev_b32_e64 v194, 16, v195
    s_waitcnt vmcnt(16)
    s_waitcnt lgkmcnt(5)
    v_mfma_f32_32x32x16_bf16 v[112:127], v[184:187], v[72:75], v[112:127]
    s_add_u32 m0, s12, 24576
    s_add_u32 s15, s1, 110592
    buffer_load_dwordx4 v246, s[84:87], s15 offen sc1 lds
    ds_read_b128 v[176:179], v240 offset:20480
    v_and_b32_e64 v196, s100, v195
    v_add_f32 v196, 0x3727c5ac, v196
    v_cvt_pk_bf16_f32 v195, v196, v196
    s_waitcnt lgkmcnt(5)
    v_mfma_f32_32x32x16_bf16 v[128:143], v[188:191], v[72:75], v[128:143]
    ds_read_b128 v[180:183], v240 offset:49152
    s_waitcnt vmcnt(13)
    v_add3_u32 v251, v251, v88, v89
    v_add3_u32 v251, v251, v90, v91
    v_and_b32 v196, s100, v195
    v_sqrt_f32_e64 v196, v196
    s_nop 0
    v_cvt_pk_bf16_f32 v195, v196, v196
    s_waitcnt lgkmcnt(5)
    s_nop 0
    v_mfma_f32_32x32x16_bf16 v[144:159], v[160:163], v[72:75], v[144:159]
    s_add_u32 m0, s12, 28672
    s_add_u32 s15, s1, 114688
    buffer_load_dwordx4 v246, s[84:87], s15 offen sc1 lds
    ds_read_b128 v[184:187], v241 offset:20480
    v_and_b32 v195, s100, v195
    v_rcp_f32 v196, v195
    s_nop 0
    v_mul_f32 v248, v196, v196
    s_waitcnt vmcnt(17)
    s_waitcnt lgkmcnt(5)
    v_mfma_f32_32x32x16_bf16 v[112:127], v[164:167], v[76:79], v[112:127]
    ds_read_b128 v[188:191], v240 offset:21504
    v_xor_b32 v194, 0x80000000, v194
    s_mov_b32 s11, 0x07060706
    v_perm_b32 v220, v194, v194, s11
    s_waitcnt lgkmcnt(5)
    s_nop 0
    v_mfma_f32_32x32x16_bf16 v[128:143], v[168:171], v[76:79], v[128:143]
    s_add_u32 m0, s12, 32768
    s_add_u32 s15, s1, 118784
    buffer_load_dwordx4 v246, s[84:87], s15 offen sc1 lds
    ds_read_b128 v[160:163], v240 offset:50176
    s_waitcnt vmcnt(14)
    v_add3_u32 v251, v251, v92, v93
    v_add3_u32 v251, v251, v94, v95
    v_perm_b32 v221, v195, v195, s11
    v_mov_b32 v222, 0
    v_mov_b32 v223, 0
    s_waitcnt lgkmcnt(5)
    v_mfma_f32_32x32x16_bf16 v[144:159], v[172:175], v[76:79], v[144:159]
    ds_read_b128 v[164:167], v241 offset:21504
    s_waitcnt vmcnt(17)
    s_waitcnt lgkmcnt(5)
    v_mfma_f32_32x32x16_bf16 v[112:127], v[176:179], v[80:83], v[112:127]
    s_add_u32 m0, s12, 36864
    s_add_u32 s15, s1, 122880
    buffer_load_dwordx4 v246, s[84:87], s15 offen sc1 lds
    ds_read_b128 v[168:171], v240 offset:22528
    s_waitcnt lgkmcnt(5)
    v_mfma_f32_32x32x16_bf16 v[128:143], v[180:183], v[80:83], v[128:143]
    ds_read_b128 v[172:175], v240 offset:51200
    s_waitcnt vmcnt(14)
    v_add3_u32 v251, v251, v96, v97
    v_add3_u32 v251, v251, v98, v99
    s_waitcnt lgkmcnt(5)
    s_nop 0
    v_mfma_f32_32x32x16_bf16 v[144:159], v[184:187], v[80:83], v[144:159]
    s_add_u32 m0, s12, 40960
    s_add_u32 s15, s1, 126976
    buffer_load_dwordx4 v246, s[84:87], s15 offen sc1 lds
    ds_read_b128 v[176:179], v241 offset:22528
    s_waitcnt vmcnt(14)
    v_add3_u32 v251, v251, v100, v101
    v_add3_u32 v251, v251, v102, v103
    s_waitcnt vmcnt(18)
    s_waitcnt lgkmcnt(5)
    v_mfma_f32_32x32x16_bf16 v[112:127], v[188:191], v[84:87], v[112:127]
    ds_read_b128 v[180:183], v240 offset:23552
    s_waitcnt lgkmcnt(5)
    v_mfma_f32_32x32x16_bf16 v[128:143], v[160:163], v[84:87], v[128:143]
    s_add_u32 m0, s12, 45056
    s_add_u32 s15, s1, 131072
    buffer_load_dwordx4 v246, s[84:87], s15 offen sc1 lds
    ds_read_b128 v[184:187], v240 offset:52224
    s_waitcnt vmcnt(14)
    v_add3_u32 v251, v251, v104, v105
    v_add3_u32 v251, v251, v106, v107
    s_waitcnt lgkmcnt(5)
    v_mfma_f32_32x32x16_bf16 v[144:159], v[164:167], v[84:87], v[144:159]
    ds_read_b128 v[188:191], v241 offset:23552
    s_waitcnt vmcnt(18)
    s_waitcnt lgkmcnt(5)
    v_mfma_f32_32x32x16_bf16 v[112:127], v[168:171], v[88:91], v[112:127]
    s_add_u32 m0, s12, 49152
    s_add_u32 s15, s1, 135168
    buffer_load_dwordx4 v246, s[84:87], s15 offen sc1 lds
    ds_read_b128 v[160:163], v240 offset:24576
    s_waitcnt lgkmcnt(5)
    v_mfma_f32_32x32x16_bf16 v[128:143], v[172:175], v[88:91], v[128:143]
    ds_read_b128 v[164:167], v240 offset:53248
    s_waitcnt vmcnt(14)
    v_add3_u32 v251, v251, v108, v109
    v_add3_u32 v251, v251, v110, v111
    s_waitcnt lgkmcnt(5)
    s_nop 0
    v_mfma_f32_32x32x16_bf16 v[144:159], v[176:179], v[88:91], v[144:159]
    s_add_u32 m0, s12, 53248
    s_add_u32 s15, s1, 139264
    buffer_load_dwordx4 v246, s[84:87], s15 offen sc1 lds
    ds_read_b128 v[168:171], v241 offset:24576
    s_waitcnt vmcnt(19)
    s_waitcnt lgkmcnt(5)
    v_mfma_f32_32x32x16_bf16 v[112:127], v[180:183], v[92:95], v[112:127]
    ds_read_b128 v[172:175], v240 offset:25600
    v_add_u32_dpp v251, v251, v251 row_shr:1 row_mask:0xf bank_mask:0xf bound_ctrl:0
    s_waitcnt lgkmcnt(5)
    s_nop 0
    v_mfma_f32_32x32x16_bf16 v[128:143], v[184:187], v[92:95], v[128:143]
    s_add_u32 s15, s0, 20480
    buffer_load_dwordx4 a[80:83], v246, s[84:87], s15 offen sc1
    ds_read_b128 v[176:179], v240 offset:54272
    v_add_u32_dpp v251, v251, v251 row_shr:2 row_mask:0xf bank_mask:0xf bound_ctrl:0
    s_waitcnt lgkmcnt(5)
    v_mfma_f32_32x32x16_bf16 v[144:159], v[188:191], v[92:95], v[144:159]
    ds_read_b128 v[180:183], v241 offset:25600
    v_add_u32_dpp v251, v251, v251 row_shr:4 row_mask:0xf bank_mask:0xf bound_ctrl:0
    s_waitcnt vmcnt(19)
    s_waitcnt lgkmcnt(5)
    s_nop 0
    v_mfma_f32_32x32x16_bf16 v[112:127], v[160:163], v[96:99], v[112:127]
    s_add_u32 s15, s72, 20480
    buffer_load_dwordx4 a[84:87], v246, s[84:87], s15 offen sc1
    ds_read_b128 v[184:187], v240 offset:26624
    v_add_u32_dpp v251, v251, v251 row_shr:8 row_mask:0xf bank_mask:0xf bound_ctrl:0
    s_waitcnt lgkmcnt(5)
    v_mfma_f32_32x32x16_bf16 v[128:143], v[164:167], v[96:99], v[128:143]
    ds_read_b128 v[188:191], v240 offset:55296
    v_add_u32_dpp v251, v251, v251 row_bcast:15 row_mask:0xa bank_mask:0xf
    s_waitcnt lgkmcnt(5)
    v_mfma_f32_32x32x16_bf16 v[144:159], v[168:171], v[96:99], v[144:159]
    s_add_u32 s15, s0, 22528
    buffer_load_dwordx4 a[88:91], v246, s[84:87], s15 offen sc1
    ds_read_b128 v[160:163], v241 offset:26624
    v_add_u32_dpp v251, v251, v251 row_bcast:31 row_mask:0xc bank_mask:0xf
    s_nop 0
    v_readlane_b32 s11, v251, 63
    s_nop 0
    s_cmp_eq_u32 s11, 0
    s_cbranch_scc1 V_31
    s_add_u32 s95, s95, 1
    s_cmp_gt_u32 s95, 200000
    s_cbranch_scc1 V_31
    s_branch L_sc_retry
V_31:
    s_waitcnt vmcnt(11)
    s_waitcnt vmcnt(20)
    s_waitcnt lgkmcnt(5)
    v_mfma_f32_32x32x16_bf16 v[112:127], v[172:175], v[100:103], v[112:127]
    ds_read_b128 v[164:167], v240 offset:27648
    v_mov_b32_e64 v249, 0
    v_accvgpr_read_b32 v245, a227
    v_xor_b32 v245, s94, v245
    s_waitcnt lgkmcnt(5)
    v_mfma_f32_32x32x16_bf16 v[128:143], v[176:179], v[100:103], v[128:143]
    s_add_u32 s15, s72, 22528
    buffer_load_dwordx4 a[92:95], v246, s[84:87], s15 offen sc1
    ds_read_b128 v[168:171], v240 offset:56320
    v_or_b32_e64 v249, v249, v245
    v_accvgpr_write_b32 a227, 0
    v_accvgpr_read_b32 v245, a231
    s_waitcnt vmcnt(4)
    s_barrier
    s_waitcnt lgkmcnt(5)
    v_mfma_f32_32x32x16_bf16 v[144:159], v[180:183], v[100:103], v[144:159]
    ds_read_b128 v[172:175], v241 offset:27648
    v_xor_b32 v245, s94, v245
    v_or_b32_e64 v249, v249, v245
    v_accvgpr_write_b32 a231, 0
    s_waitcnt vmcnt(20)
    s_waitcnt lgkmcnt(5)
    v_mfma_f32_32x32x16_bf16 v[112:127], v[184:187], v[104:107], v[112:127]
    s_add_u32 s15, s0, 24576
    buffer_load_dwordx4 a[96:99], v246, s[84:87], s15 offen sc1
    ds_read_b128 v[176:179], v246 offset:0
    v_accvgpr_read_b32 v245, a235
    v_xor_b32 v245, s94, v245
    v_or_b32_e64 v249, v249, v245
    s_waitcnt lgkmcnt(5)
    v_mfma_f32_32x32x16_bf16 v[128:143], v[188:191], v[104:107], v[128:143]
    ds_read_b128 v[180:183], v246 offset:1024
    v_accvgpr_write_b32 a235, 0
    v_accvgpr_read_b32 v245, a239
    v_xor_b32 v245, s94, v245
    s_waitcnt lgkmcnt(5)
    v_mfma_f32_32x32x16_bf16 v[144:159], v[160:163], v[104:107], v[144:159]
    s_add_u32 s15, s72, 24576
    buffer_load_dwordx4 a[100:103], v246, s[84:87], s15 offen sc1
    ds_read_b128 v[184:187], v246 offset:2048
    v_or_b32_e64 v249, v249, v245
    v_accvgpr_write_b32 a239, 0
    v_accvgpr_read_b32 v245, a243
    s_waitcnt vmcnt(21)
    s_waitcnt lgkmcnt(5)
    v_mfma_f32_32x32x16_bf16 v[112:127], v[164:167], v[108:111], v[112:127]
    ds_read_b128 v[188:191], v246 offset:3072
    v_xor_b32 v245, s94, v245
    v_or_b32 v249, v249, v245
    v_accvgpr_write_b32 a243, 0
    s_waitcnt lgkmcnt(5)
    s_nop 0
    v_mfma_f32_32x32x16_bf16 v[128:143], v[168:171], v[108:111], v[128:143]
    s_add_u32 s15, s0, 26624
    buffer_load_dwordx4 a[104:107], v246, s[84:87], s15 offen sc1
    ds_read_b128 v[160:163], v246 offset:4096
    v_accvgpr_read_b32 v245, a247
    v_xor_b32 v245, s94, v245
    v_or_b32_e64 v249, v249, v245
    s_waitcnt lgkmcnt(5)
    v_mfma_f32_32x32x16_bf16 v[144:159], v[172:175], v[108:111], v[144:159]
    ds_read_b128 v[164:167], v246 offset:5120
    v_accvgpr_write_b32 a247, 0
    v_accvgpr_read_b32 v245, a251
    v_xor_b32 v245, s94, v245
    v_or_b32 v249, v249, v245
    v_accvgpr_write_b32 a251, 0
L_ae:
    v_cmp_ne_u32 vcc, 0, v249
    s_add_u32 s95, s95, 1
    s_cmp_gt_u32 s95, 200000
    s_cbranch_scc1 L_aex
    s_cbranch_vccz L_aex
    s_add_u32 s15, s50, 0
    s_nop 0
    buffer_load_dwordx4 a[224:227], v246, s[84:87], s15 offen sc1
    s_add_u32 s15, s50, 1024
    buffer_load_dwordx4 a[228:231], v246, s[84:87], s15 offen sc1
    s_add_u32 s15, s50, 2048
    buffer_load_dwordx4 a[232:235], v246, s[84:87], s15 offen sc1
    s_add_u32 s15, s50, 3072
    buffer_load_dwordx4 a[236:239], v246, s[84:87], s15 offen sc1
    s_add_u32 s15, s50, 4096
    buffer_load_dwordx4 a[240:243], v246, s[84:87], s15 offen sc1
    s_add_u32 s15, s50, 5120
    buffer_load_dwordx4 a[244:247], v246, s[84:87], s15 offen sc1
    s_add_u32 s15, s50, 6144
    buffer_load_dwordx4 a[248:251], v246, s[84:87], s15 offen sc1
    s_waitcnt vmcnt(0)
    v_mov_b32 v249, 0
    v_accvgpr_read_b32 v245, a227
    v_xor_b32 v245, s94, v245
    v_or_b32 v249, v249, v245
    v_accvgpr_write_b32 a227, 0
    v_accvgpr_read_b32 v245, a231
    v_xor_b32 v245, s94, v245
    v_or_b32 v249, v249, v245
    v_accvgpr_write_b32 a231, 0
    v_accvgpr_read_b32 v245, a235
    v_xor_b32 v245, s94, v245
    v_or_b32 v249, v249, v245
    v_accvgpr_write_b32 a235, 0
    v_accvgpr_read_b32 v245, a239
    v_xor_b32 v245, s94, v245
    v_or_b32 v249, v249, v245
    v_accvgpr_write_b32 a239, 0
    v_accvgpr_read_b32 v245, a243
    v_xor_b32 v245, s94, v245
    v_or_b32 v249, v249, v245
    v_accvgpr_write_b32 a243, 0
    v_accvgpr_read_b32 v245, a247
    v_xor_b32 v245, s94, v245
    v_or_b32 v249, v249, v245
    v_accvgpr_write_b32 a247, 0
    v_accvgpr_read_b32 v245, a251
    v_xor_b32 v245, s94, v245
    v_or_b32 v249, v249, v245
    v_accvgpr_write_b32 a251, 0
    s_branch L_ae
L_aex:
    v_mfma_f32_32x32x16_bf16 v[112:127], a[224:227], v[220:223], v[112:127]
    v_mfma_f32_32x32x16_bf16 v[128:143], a[228:231], v[220:223], v[128:143]
    v_mfma_f32_32x32x16_bf16 v[144:159], a[232:235], v[220:223], v[144:159]
    s_waitcnt lgkmcnt(5)
    v_mfma_f32_32x32x16_bf16 v[192:207], v[176:179], v[0:3], 0
    s_add_u32 s15, s72, 26624
    buffer_load_dwordx4 a[108:111], v246, s[84:87], s15 offen sc1
    ds_read_b128 v[168:171], v246 offset:6144
    s_waitcnt lgkmcnt(5)
    v_mfma_f32_32x32x16_bf16 v[192:207], v[180:183], v[4:7], v[192:207]
    ds_read_b128 v[172:175], v246 offset:7168
    s_barrier
    s_waitcnt lgkmcnt(5)
    s_nop 0
    v_mfma_f32_32x32x16_bf16 v[192:207], v[184:187], v[8:11], v[192:207]
    s_add_u32 m0, s12, 65536
    s_add_u32 s15, s1, 143360
    buffer_load_dwordx4 v246, s[84:87], s15 offen sc1 lds
    ds_read_b128 v[176:179], v246 offset:8192
    v_mul_f32 v112, v112, v120
    v_mul_f32 v113, v113, v121
    v_mul_f32 v114, v114, v122
    s_waitcnt lgkmcnt(5)
    v_mfma_f32_32x32x16_bf16 v[192:207], v[188:191], v[12:15], v[192:207]
    ds_read_b128 v[180:183], v246 offset:9216
    v_mul_f32 v115, v115, v123
    v_mul_f32 v116, v116, v124
    v_mul_f32 v117, v117, v125
    s_waitcnt lgkmcnt(5)
    v_mfma_f32_32x32x16_bf16 v[192:207], v[160:163], v[16:19], v[192:207]
    s_add_u32 m0, s12, 69632
    s_add_u32 s15, s1, 147456
    buffer_load_dwordx4 v246, s[84:87], s15 offen sc1 lds
    ds_read_b128 v[184:187], v246 offset:10240
    v_mul_f32 v118, v118, v126
    v_mul_f32 v119, v119, v127
    v_mul_f32 v112, v248, v112
    s_waitcnt lgkmcnt(5)
    v_mfma_f32_32x32x16_bf16 v[192:207], v[164:167], v[20:23], v[192:207]
    ds_read_b128 v[188:191], v246 offset:11264
    v_mul_f32 v113, v248, v113
    v_mul_f32 v114, v248, v114
    v_mul_f32 v115, v248, v115
    s_waitcnt lgkmcnt(5)
    v_mfma_f32_32x32x16_bf16 v[192:207], v[168:171], v[24:27], v[192:207]
    s_add_u32 m0, s12, 73728
    s_add_u32 s15, s1, 151552
    buffer_load_dwordx4 v246, s[84:87], s15 offen sc1 lds
    ds_read_b128 v[160:163], v246 offset:12288
    v_mul_f32 v116, v248, v116
    v_mul_f32 v117, v248, v117
    v_mul_f32 v118, v248, v118
    s_waitcnt lgkmcnt(5)
    v_mfma_f32_32x32x16_bf16 v[192:207], v[172:175], v[28:31], v[192:207]
    ds_read_b128 v[164:167], v246 offset:13312
    v_mul_f32_e64 v119, v248, v119
    v_cvt_pk_bf16_f32 v120, v112, v113
    v_cvt_pk_bf16_f32 v121, v114, v115
    s_waitcnt lgkmcnt(5)
    s_nop 0
    v_mfma_f32_32x32x16_bf16 v[192:207], v[176:179], v[32:35], v[192:207]
    s_add_u32 m0, s12, 77824
    s_add_u32 s15, s1, 155648
    buffer_load_dwordx4 v246, s[84:87], s15 offen sc1 lds
    ds_read_b128 v[168:171], v246 offset:14336
    v_cvt_pk_bf16_f32 v122, v116, v117
    v_cvt_pk_bf16_f32 v123, v118, v119
    buffer_store_dwordx4 v[120:123], v246, s[84:87], s8 offen offset:0 sc1
    s_waitcnt lgkmcnt(5)
    v_mfma_f32_32x32x16_bf16 v[192:207], v[180:183], v[36:39], v[192:207]
    ds_read_b128 v[172:175], v246 offset:15360
    v_add3_u32 v253, v120, v121, v122
    v_add_u32 v253, v253, v123
    v_mul_f32 v128, v128, v136
    s_waitcnt lgkmcnt(5)
    v_mfma_f32_32x32x16_bf16 v[192:207], v[184:187], v[40:43], v[192:207]
    s_add_u32 m0, s12, 81920
    s_add_u32 s15, s1, 159744
    buffer_load_dwordx4 v246, s[84:87], s15 offen sc1 lds
    ds_read_b128 v[176:179], v246 offset:16384
    v_mul_f32 v129, v129, v137
    v_mul_f32 v130, v130, v138
    v_mul_f32 v131, v131, v139
    s_waitcnt lgkmcnt(5)
    v_mfma_f32_32x32x16_bf16 v[192:207], v[188:191], v[44:47], v[192:207]
    ds_read_b128 v[180:183], v246 offset:17408
    v_mul_f32 v132, v132, v140
    v_mul_f32 v133, v133, v141
    v_mul_f32 v134, v134, v142
    s_waitcnt lgkmcnt(5)
    v_mfma_f32_32x32x16_bf16 v[192:207], v[160:163], v[48:51], v[192:207]
    s_add_u32 m0, s12, 86016
    s_add_u32 s15, s1, 163840
    buffer_load_dwordx4 v246, s[84:87], s15 offen sc1 lds
    ds_read_b128 v[184:187], v246 offset:18432
    v_mul_f32 v135, v135, v143
    v_mul_f32 v128, v248, v128
    v_mul_f32 v129, v248, v129
    s_waitcnt lgkmcnt(5)
    v_mfma_f32_32x32x16_bf16 v[192:207], v[164:167], v[52:55], v[192:207]
    ds_read_b128 v[188:191], v246 offset:19456
    v_mul_f32 v130, v248, v130
    v_mul_f32 v131, v248, v131
    v_mul_f32 v132, v248, v132
    s_waitcnt lgkmcnt(5)
    v_mfma_f32_32x32x16_bf16 v[192:207], v[168:171], v[56:59], v[192:207]
    s_add_u32 m0, s12, 90112
    s_add_u32 s15, s1, 167936
    buffer_load_dwordx4 v246, s[84:87], s15 offen sc1 lds
    ds_read_b128 v[160:163], v246 offset:20480
    v_mul_f32 v133, v248, v133
    v_mul_f32 v134, v248, v134
    v_mul_f32 v135, v248, v135
    s_waitcnt lgkmcnt(5)
    v_mfma_f32_32x32x16_bf16 v[192:207], v[172:175], v[60:63], v[192:207]
    ds_read_b128 v[164:167], v246 offset:21504
    v_cvt_pk_bf16_f32 v136, v128, v129
    v_cvt_pk_bf16_f32 v137, v130, v131
    v_cvt_pk_bf16_f32 v138, v132, v133
    s_waitcnt lgkmcnt(5)
    s_nop 0
    v_mfma_f32_32x32x16_bf16 v[192:207], v[176:179], v[64:67], v[192:207]
    s_add_u32 m0, s12, 94208
    s_add_u32 s15, s1, 172032
    buffer_load_dwordx4 v246, s[84:87], s15 offen sc1 lds
    ds_read_b128 v[168:171], v246 offset:22528
    v_cvt_pk_bf16_f32 v139, v134, v135
    buffer_store_dwordx4 v[136:139], v246, s[84:87], s8 offen offset:1024 sc1
    v_add3_u32 v253, v253, v136, v137
    s_waitcnt lgkmcnt(5)
    v_mfma_f32_32x32x16_bf16 v[192:207], v[180:183], v[68:71], v[192:207]
    ds_read_b128 v[172:175], v246 offset:23552
    v_add3_u32 v253, v253, v138, v139
    v_mul_f32 v144, v144, v152
    v_mul_f32 v145, v145, v153
    s_waitcnt lgkmcnt(5)
    v_mfma_f32_32x32x16_bf16 v[192:207], v[184:187], v[72:75], v[192:207]
    s_add_u32 m0, s12, 98304
    s_add_u32 s15, s1, 176128
    buffer_load_dwordx4 v246, s[84:87], s15 offen sc1 lds
    ds_read_b128 v[176:179], v246 offset:24576
    v_mul_f32 v146, v146, v154
    v_mul_f32 v147, v147, v155
    v_mul_f32 v148, v148, v156
    s_waitcnt lgkmcnt(5)
    v_mfma_f32_32x32x16_bf16 v[192:207], v[188:191], v[76:79], v[192:207]
    ds_read_b128 v[180:183], v246 offset:25600
    v_mul_f32 v149, v149, v157
    v_mul_f32 v150, v150, v158
    v_mul_f32 v151, v151, v159
    s_waitcnt lgkmcnt(5)
    v_mfma_f32_32x32x16_bf16 v[192:207], v[160:163], v[80:83], v[192:207]
    s_add_u32 m0, s12, 102400
    s_add_u32 s15, s1, 180224
    buffer_load_dwordx4 v246, s[84:87], s15 offen sc1 lds
    ds_read_b128 v[184:187], v246 offset:26624
    v_mul_f32 v144, v248, v144
    v_mul_f32 v145, v248, v145
    v_mul_f32 v146, v248, v146
    s_waitcnt lgkmcnt(5)
    v_mfma_f32_32x32x16_bf16 v[192:207], v[164:167], v[84:87], v[192:207]
    ds_read_b128 v[188:191], v246 offset:27648
    v_mul_f32 v147, v248, v147
    v_mul_f32 v148, v248, v148
    v_mul_f32 v149, v248, v149
    s_waitcnt lgkmcnt(5)
    v_mfma_f32_32x32x16_bf16 v[192:207], v[168:171], v[88:91], v[192:207]
    s_add_u32 m0, s12, 106496
    s_add_u32 s15, s1, 184320
    buffer_load_dwordx4 v246, s[84:87], s15 offen sc1 lds
    ds_read_b128 v[160:163], v246 offset:28672
    v_mul_f32 v150, v248, v150
    v_mul_f32 v151, v248, v151
    v_cvt_pk_bf16_f32 v152, v144, v145
    s_waitcnt lgkmcnt(5)
    s_nop 0
    v_mfma_f32_32x32x16_bf16 v[192:207], v[172:175], v[92:95], v[192:207]
    ds_read_b128 v[164:167], v246 offset:29696
    v_cvt_pk_bf16_f32 v153, v146, v147
    v_cvt_pk_bf16_f32 v154, v148, v149
    v_cvt_pk_bf16_f32 v155, v150, v151
    s_waitcnt lgkmcnt(5)
    s_nop 0
    v_mfma_f32_32x32x16_bf16 v[192:207], v[176:179], v[96:99], v[192:207]
    s_add_u32 m0, s12, 110592
    s_add_u32 s15, s1, 188416
    buffer_load_dwordx4 v246, s[84:87], s15 offen sc1 lds
    ds_read_b128 v[168:171], v246 offset:30720
    buffer_store_dwordx4 v[152:155], v246, s[84:87], s8 offen offset:2048 sc1
    v_add3_u32 v253, v253, v152, v153
    v_add3_u32 v253, v253, v154, v155
    s_waitcnt lgkmcnt(5)
    v_mfma_f32_32x32x16_bf16 v[192:207], v[180:183], v[100:103], v[192:207]
    ds_read_b128 v[172:175], v246 offset:31744
    v_add_u32_dpp v253, v253, v253 row_shr:1 row_mask:0xf bank_mask:0xf bound_ctrl:0
    s_waitcnt lgkmcnt(5)
    v_mfma_f32_32x32x16_bf16 v[192:207], v[184:187], v[104:107], v[192:207]
    s_add_u32 m0, s12, 114688
    s_add_u32 s15, s1, 192512
    buffer_load_dwordx4 v246, s[84:87], s15 offen sc1 lds
    ds_read_b128 v[176:179], v246 offset:32768
    v_add_u32_dpp v253, v253, v253 row_shr:2 row_mask:0xf bank_mask:0xf bound_ctrl:0
    s_waitcnt lgkmcnt(5)
    v_mfma_f32_32x32x16_bf16 v[192:207], v[188:191], v[108:111], v[192:207]
    v_mfma_f32_32x32x16_bf16 v[192:207], a[236:239], v[220:223], v[192:207]
    ds_read_b128 v[180:183], v246 offset:33792
    v_add_u32_dpp v253, v253, v253 row_shr:4 row_mask:0xf bank_mask:0xf bound_ctrl:0
    s_waitcnt lgkmcnt(5)
    v_mfma_f32_32x32x16_bf16 v[112:127], v[160:163], v[0:3], 0
    s_add_u32 m0, s12, 118784
    s_add_u32 s15, s1, 196608
    buffer_load_dwordx4 v246, s[84:87], s15 offen sc1 lds
    ds_read_b128 v[184:187], v246 offset:34816
    s_waitcnt lgkmcnt(5)
    v_mfma_f32_32x32x16_bf16 v[112:127], v[164:167], v[4:7], v[112:127]
    ds_read_b128 v[188:191], v246 offset:35840
    s_waitcnt lgkmcnt(5)
    v_mfma_f32_32x32x16_bf16 v[112:127], v[168:171], v[8:11], v[112:127]
    s_add_u32 s15, s0, 28672
    buffer_load_dwordx4 a[112:115], v246, s[84:87], s15 offen sc1
    ds_read_b128 v[160:163], v246 offset:36864
    v_add_u32_dpp v253, v253, v253 row_shr:8 row_mask:0xf bank_mask:0xf bound_ctrl:0
    s_waitcnt lgkmcnt(5)
    v_mfma_f32_32x32x16_bf16 v[112:127], v[172:175], v[12:15], v[112:127]
    ds_read_b128 v[164:167], v246 offset:37888
    v_add_u32_dpp v253, v253, v253 row_bcast:15 row_mask:0xa bank_mask:0xf
    s_waitcnt lgkmcnt(5)
    v_mfma_f32_32x32x16_bf16 v[112:127], v[176:179], v[16:19], v[112:127]
    s_add_u32 s15, s72, 28672
    buffer_load_dwordx4 a[116:119], v246, s[84:87], s15 offen sc1
    ds_read_b128 v[168:171], v246 offset:38912
    v_add_u32_dpp v253, v253, v253 row_bcast:31 row_mask:0xc bank_mask:0xf
    s_waitcnt lgkmcnt(5)
    v_mfma_f32_32x32x16_bf16 v[112:127], v[180:183], v[20:23], v[112:127]
    ds_read_b128 v[172:175], v246 offset:39936
    s_add_u32 s11, s10, 0
    s_mov_b32 exec_lo, 0
    s_brev_b32 exec_hi, 1
    buffer_store_dwordx2 v[252:253], v254, s[84:87], s11 offen offset:0 sc1
    s_mov_b64 exec, -1
    v_mul_f32 v192, v192, v200
    v_mul_f32 v193, v193, v201
    s_waitcnt lgkmcnt(5)
    v_mfma_f32_32x32x16_bf16 v[112:127], v[184:187], v[24:27], v[112:127]
    s_add_u32 s15, s0, 30720
    buffer_load_dwordx4 a[120:123], v246, s[84:87], s15 offen sc1
    ds_read_b128 v[176:179], v246 offset:40960
    v_mul_f32 v194, v194, v202
    v_mul_f32 v195, v195, v203
    v_mul_f32 v196, v196, v204
    s_waitcnt lgkmcnt(5)
    v_mfma_f32_32x32x16_bf16 v[112:127], v[188:191], v[28:31], v[112:127]
    ds_read_b128 v[180:183], v246 offset:41984
    v_mul_f32 v197, v197, v205
    v_mul_f32 v198, v198, v206
    v_mul_f32 v199, v199, v207
    s_waitcnt lgkmcnt(5)
    v_mfma_f32_32x32x16_bf16 v[112:127], v[160:163], v[32:35], v[112:127]
    s_add_u32 s15, s72, 30720
    buffer_load_dwordx4 a[124:127], v246, s[84:87], s15 offen sc1
    ds_read_b128 v[184:187], v246 offset:43008
    v_mul_f32 v192, v248, v192
    v_mul_f32 v193, v248, v193
    v_mul_f32 v194, v248, v194
    s_waitcnt lgkmcnt(5)
    v_mfma_f32_32x32x16_bf16 v[112:127], v[164:167], v[36:39], v[112:127]
    ds_read_b128 v[188:191], v246 offset:44032
    v_mul_f32 v195, v248, v195
    v_mul_f32 v196, v248, v196
    v_mul_f32 v197, v248, v197
    s_waitcnt lgkmcnt(5)
    v_mfma_f32_32x32x16_bf16 v[112:127], v[168:171], v[40:43], v[112:127]
    s_add_u32 s15, s0, 32768
    buffer_load_dwordx4 a[128:131], v246, s[84:87], s15 offen sc1
    ds_read_b128 v[160:163], v246 offset:45056
    v_mul_f32 v198, v248, v198
    v_mul_f32 v199, v248, v199
    v_cvt_pk_bf16_f32 v200, v192, v193
    s_waitcnt lgkmcnt(5)
    s_nop 0
    v_mfma_f32_32x32x16_bf16 v[112:127], v[172:175], v[44:47], v[112:127]
    ds_read_b128 v[164:167], v246 offset:46080
    v_cvt_pk_bf16_f32 v201, v194, v195
    v_cvt_pk_bf16_f32 v202, v196, v197
    v_cvt_pk_bf16_f32 v203, v198, v199
    s_waitcnt lgkmcnt(5)
    s_nop 0
    v_mfma_f32_32x32x16_bf16 v[112:127], v[176:179], v[48:51], v[112:127]
    s_add_u32 s15, s72, 32768
    buffer_load_dwordx4 a[132:135], v246, s[84:87], s15 offen sc1
    ds_read_b128 v[168:171], v246 offset:47104
    buffer_store_dwordx4 v[200:203], v246, s[84:87], s8 offen offset:3072 sc1
    v_add3_u32 v253, v200, v201, v202
    v_add_u32 v253, v253, v203
    s_waitcnt lgkmcnt(5)
    v_mfma_f32_32x32x16_bf16 v[112:127], v[180:183], v[52:55], v[112:127]
    ds_read_b128 v[172:175], v246 offset:48128
    s_waitcnt lgkmcnt(5)
    v_mfma_f32_32x32x16_bf16 v[112:127], v[184:187], v[56:59], v[112:127]
    s_add_u32 s15, s0, 34816
    buffer_load_dwordx4 a[136:139], v246, s[84:87], s15 offen sc1
    ds_read_b128 v[176:179], v246 offset:49152
    s_waitcnt lgkmcnt(5)
    v_mfma_f32_32x32x16_bf16 v[112:127], v[188:191], v[60:63], v[112:127]
    ds_read_b128 v[180:183], v246 offset:50176
    s_waitcnt lgkmcnt(5)
    v_mfma_f32_32x32x16_bf16 v[112:127], v[160:163], v[64:67], v[112:127]
    s_add_u32 s15, s72, 34816
    buffer_load_dwordx4 a[140:143], v246, s[84:87], s15 offen sc1
    ds_read_b128 v[184:187], v246 offset:51200
    s_waitcnt lgkmcnt(5)
    v_mfma_f32_32x32x16_bf16 v[112:127], v[164:167], v[68:71], v[112:127]
    ds_read_b128 v[188:191], v246 offset:52224
    s_waitcnt lgkmcnt(5)
    v_mfma_f32_32x32x16_bf16 v[112:127], v[168:171], v[72:75], v[112:127]
    s_add_u32 s15, s0, 36864
    buffer_load_dwordx4 a[144:147], v246, s[84:87], s15 offen sc1
    ds_read_b128 v[160:163], v246 offset:53248
    s_waitcnt lgkmcnt(5)
    v_mfma_f32_32x32x16_bf16 v[112:127], v[172:175], v[76:79], v[112:127]
    ds_read_b128 v[164:167], v246 offset:54272
    s_waitcnt lgkmcnt(5)
    v_mfma_f32_32x32x16_bf16 v[112:127], v[176:179], v[80:83], v[112:127]
    s_add_u32 s15, s72, 36864
    buffer_load_dwordx4 a[148:151], v246, s[84:87], s15 offen sc1
    ds_read_b128 v[168:171], v246 offset:55296
    s_waitcnt vmcnt(12)
    s_barrier
    s_waitcnt lgkmcnt(5)
    v_mfma_f32_32x32x16_bf16 v[112:127], v[180:183], v[84:87], v[112:127]
    ds_read_b128 v[172:175], v246 offset:56320
    s_waitcnt lgkmcnt(5)
    v_mfma_f32_32x32x16_bf16 v[112:127], v[184:187], v[88:91], v[112:127]
    s_add_u32 s15, s0, 38912
    buffer_load_dwordx4 a[152:155], v246, s[84:87], s15 offen sc1
    ds_read_b128 v[176:179], v240 offset:0
    s_waitcnt lgkmcnt(5)
    v_mfma_f32_32x32x16_bf16 v[112:127], v[188:191], v[92:95], v[112:127]
    ds_read_b128 v[180:183], v240 offset:1024
    s_waitcnt lgkmcnt(5)
    v_mfma_f32_32x32x16_bf16 v[112:127], v[160:163], v[96:99], v[112:127]
    s_add_u32 s15, s72, 38912
    buffer_load_dwordx4 a[156:159], v246, s[84:87], s15 offen sc1
    ds_read_b128 v[184:187], v240 offset:2048
    s_waitcnt lgkmcnt(5)
    v_mfma_f32_32x32x16_bf16 v[112:127], v[164:167], v[100:103], v[112:127]
    ds_read_b128 v[188:191], v240 offset:3072
    s_waitcnt lgkmcnt(5)
    v_mfma_f32_32x32x16_bf16 v[112:127], v[168:171], v[104:107], v[112:127]
    s_add_u32 s15, s0, 40960
    buffer_load_dwordx4 a[160:163], v246, s[84:87], s15 offen sc1
    ds_read_b128 v[160:163], v240 offset:4096
    s_waitcnt lgkmcnt(5)
    v_mfma_f32_32x32x16_bf16 v[112:127], v[172:175], v[108:111], v[112:127]
    v_mfma_f32_32x32x16_bf16 v[112:127], a[240:243], v[220:223], v[112:127]
    ds_read_b128 v[164:167], v240 offset:5120
    s_waitcnt lgkmcnt(5)
    v_mfma_f32_32x32x16_bf16 v[128:143], v[176:179], v[0:3], 0
    s_add_u32 s15, s72, 40960
    buffer_load_dwordx4 a[164:167], v246, s[84:87], s15 offen sc1
    ds_read_b128 v[168:171], v240 offset:6144
    s_waitcnt lgkmcnt(5)
    v_mfma_f32_32x32x16_bf16 v[128:143], v[180:183], v[4:7], v[128:143]
    ds_read_b128 v[172:175], v240 offset:7168
    s_waitcnt lgkmcnt(5)
    v_mfma_f32_32x32x16_bf16 v[128:143], v[184:187], v[8:11], v[128:143]
    s_add_u32 s15, s0, 43008
    buffer_load_dwordx4 a[168:171], v246, s[84:87], s15 offen sc1
    ds_read_b128 v[176:179], v240 offset:8192
    v_mul_f32 v112, v112, v120
    v_mul_f32 v113, v113, v121
    v_mul_f32_e64 v114, v114, v122
    s_waitcnt lgkmcnt(5)
    v_mfma_f32_32x32x16_bf16 v[128:143], v[188:191], v[12:15], v[128:143]
    ds_read_b128 v[180:183], v240 offset:9216
    v_mul_f32 v115, v115, v123
    v_mul_f32 v116, v116, v124
    v_mul_f32 v117, v117, v125
    s_waitcnt lgkmcnt(5)
    v_mfma_f32_32x32x16_bf16 v[128:143], v[160:163], v[16:19], v[128:143]
    s_add_u32 s15, s72, 43008
    buffer_load_dwordx4 a[172:175], v246, s[84:87], s15 offen sc1
    ds_read_b128 v[184:187], v240 offset:10240
    v_mul_f32 v118, v118, v126
    v_mul_f32 v119, v119, v127
    v_mul_f32 v112, v248, v112
    s_waitcnt lgkmcnt(5)
    v_mfma_f32_32x32x16_bf16 v[128:143], v[164:167], v[20:23], v[128:143]
    ds_read_b128 v[188:191], v240 offset:11264
    v_mul_f32 v113, v248, v113
    v_mul_f32 v114, v248, v114
    v_mul_f32 v115, v248, v115
    s_waitcnt lgkmcnt(5)
    v_mfma_f32_32x32x16_bf16 v[128:143], v[168:171], v[24:27], v[128:143]
    s_add_u32 s15, s0, 45056
    buffer_load_dwordx4 a[176:179], v246, s[84:87], s15 offen sc1
    ds_read_b128 v[160:163], v240 offset:12288
    v_mul_f32 v116, v248, v116
    v_mul_f32 v117, v248, v117
    v_mul_f32 v118, v248, v118
    s_waitcnt lgkmcnt(5)
    v_mfma_f32_32x32x16_bf16 v[128:143], v[172:175], v[28:31], v[128:143]
    ds_read_b128 v[164:167], v240 offset:13312
    v_mul_f32_e64 v119, v248, v119
    v_cvt_pk_bf16_f32 v120, v112, v113
    v_cvt_pk_bf16_f32 v121, v114, v115
    s_waitcnt lgkmcnt(5)
    s_nop 0
    v_mfma_f32_32x32x16_bf16 v[128:143], v[176:179], v[32:35], v[128:143]
    s_add_u32 s15, s72, 45056
    buffer_load_dwordx4 a[180:183], v246, s[84:87], s15 offen sc1
    ds_read_b128 v[168:171], v240 offset:14336
    v_cvt_pk_bf16_f32 v122, v116, v117
    v_cvt_pk_bf16_f32 v123, v118, v119
    buffer_store_dwordx4 v[120:123], v246, s[84:87], s9 offen offset:0 sc1
    s_waitcnt lgkmcnt(5)
    v_mfma_f32_32x32x16_bf16 v[128:143], v[180:183], v[36:39], v[128:143]
    ds_read_b128 v[172:175], v240 offset:15360
    v_add3_u32 v253, v253, v120, v121
    v_add3_u32 v253, v253, v122, v123
    s_nop 1
    v_add_u32_dpp v253, v253, v253 row_shr:1 row_mask:0xf bank_mask:0xf bound_ctrl:0
    s_waitcnt lgkmcnt(5)
    s_nop 0
    v_mfma_f32_32x32x16_bf16 v[128:143], v[184:187], v[40:43], v[128:143]
    s_add_u32 s15, s0, 47104
    buffer_load_dwordx4 a[184:187], v246, s[84:87], s15 offen sc1
    ds_read_b128 v[176:179], v240 offset:16384
    v_add_u32_dpp v253, v253, v253 row_shr:2 row_mask:0xf bank_mask:0xf bound_ctrl:0
    s_waitcnt lgkmcnt(5)
    v_mfma_f32_32x32x16_bf16 v[128:143], v[188:191], v[44:47], v[128:143]
    ds_read_b128 v[180:183], v240 offset:17408
    v_add_u32_dpp v253, v253, v253 row_shr:4 row_mask:0xf bank_mask:0xf bound_ctrl:0
    s_waitcnt lgkmcnt(5)
    v_mfma_f32_32x32x16_bf16 v[128:143], v[160:163], v[48:51], v[128:143]
    s_add_u32 s15, s72, 47104
    buffer_load_dwordx4 a[188:191], v246, s[84:87], s15 offen sc1
    ds_read_b128 v[184:187], v240 offset:18432
    v_add_u32_dpp v253, v253, v253 row_shr:8 row_mask:0xf bank_mask:0xf bound_ctrl:0
    s_waitcnt lgkmcnt(5)
    v_mfma_f32_32x32x16_bf16 v[128:143], v[164:167], v[52:55], v[128:143]
    ds_read_b128 v[188:191], v240 offset:19456
    v_add_u32_dpp v253, v253, v253 row_bcast:15 row_mask:0xa bank_mask:0xf
    s_waitcnt lgkmcnt(5)
    v_mfma_f32_32x32x16_bf16 v[128:143], v[168:171], v[56:59], v[128:143]
    s_add_u32 s15, s0, 49152
    buffer_load_dwordx4 a[192:195], v246, s[84:87], s15 offen sc1
    ds_read_b128 v[160:163], v240 offset:20480
    v_add_u32_dpp v253, v253, v253 row_bcast:31 row_mask:0xc bank_mask:0xf
    s_waitcnt lgkmcnt(5)
    v_mfma_f32_32x32x16_bf16 v[128:143], v[172:175], v[60:63], v[128:143]
    ds_read_b128 v[164:167], v240 offset:21504
    s_add_u32 s11, s10, 8192
    s_mov_b32 exec_lo, 0
    s_brev_b32 exec_hi, 1
    buffer_store_dwordx2 v[252:253], v254, s[84:87], s11 offen offset:0 sc1
    s_mov_b64 exec, -1
    s_waitcnt lgkmcnt(5)
    v_mfma_f32_32x32x16_bf16 v[128:143], v[176:179], v[64:67], v[128:143]
    s_add_u32 s15, s72, 49152
    buffer_load_dwordx4 a[196:199], v246, s[84:87], s15 offen sc1
    ds_read_b128 v[168:171], v240 offset:22528
    s_waitcnt lgkmcnt(5)
    v_mfma_f32_32x32x16_bf16 v[128:143], v[180:183], v[68:71], v[128:143]
    ds_read_b128 v[172:175], v240 offset:23552
    s_waitcnt lgkmcnt(5)
    v_mfma_f32_32x32x16_bf16 v[128:143], v[184:187], v[72:75], v[128:143]
    s_add_u32 s15, s0, 51200
    buffer_load_dwordx4 a[200:203], v246, s[84:87], s15 offen sc1
    ds_read_b128 v[176:179], v240 offset:24576
    s_waitcnt lgkmcnt(5)
    v_mfma_f32_32x32x16_bf16 v[128:143], v[188:191], v[76:79], v[128:143]
    ds_read_b128 v[180:183], v240 offset:25600
    s_waitcnt lgkmcnt(5)
    v_mfma_f32_32x32x16_bf16 v[128:143], v[160:163], v[80:83], v[128:143]
    s_add_u32 s15, s72, 51200
    buffer_load_dwordx4 a[204:207], v246, s[84:87], s15 offen sc1
    ds_read_b128 v[184:187], v240 offset:26624
    s_waitcnt lgkmcnt(5)
    v_mfma_f32_32x32x16_bf16 v[128:143], v[164:167], v[84:87], v[128:143]
    ds_read_b128 v[188:191], v240 offset:27648
    s_waitcnt lgkmcnt(5)
    v_mfma_f32_32x32x16_bf16 v[128:143], v[168:171], v[88:91], v[128:143]
    s_add_u32 s15, s0, 53248
    buffer_load_dwordx4 a[208:211], v246, s[84:87], s15 offen sc1
    ds_read_b128 v[160:163], v240 offset:28672
    s_waitcnt lgkmcnt(5)
    v_mfma_f32_32x32x16_bf16 v[128:143], v[172:175], v[92:95], v[128:143]
    ds_read_b128 v[164:167], v240 offset:29696
    s_waitcnt lgkmcnt(5)
    v_mfma_f32_32x32x16_bf16 v[128:143], v[176:179], v[96:99], v[128:143]
    s_add_u32 s15, s72, 53248
    buffer_load_dwordx4 a[212:215], v246, s[84:87], s15 offen sc1
    ds_read_b128 v[168:171], v240 offset:30720
    s_waitcnt lgkmcnt(5)
    v_mfma_f32_32x32x16_bf16 v[128:143], v[180:183], v[100:103], v[128:143]
    ds_read_b128 v[172:175], v240 offset:31744
    s_waitcnt lgkmcnt(5)
    v_mfma_f32_32x32x16_bf16 v[128:143], v[184:187], v[104:107], v[128:143]
    s_add_u32 s15, s0, 55296
    buffer_load_dwordx4 a[216:219], v246, s[84:87], s15 offen sc1
    ds_read_b128 v[176:179], v240 offset:32768
    s_waitcnt lgkmcnt(5)
    v_mfma_f32_32x32x16_bf16 v[128:143], v[188:191], v[108:111], v[128:143]
    v_mfma_f32_32x32x16_bf16 v[128:143], a[244:247], v[220:223], v[128:143]
    ds_read_b128 v[180:183], v240 offset:33792
    s_waitcnt lgkmcnt(5)
    v_mfma_f32_32x32x16_bf16 v[144:159], v[160:163], v[0:3], 0
    s_add_u32 s15, s72, 55296
    buffer_load_dwordx4 a[220:223], v246, s[84:87], s15 offen sc1
    ds_read_b128 v[184:187], v240 offset:34816
    s_waitcnt lgkmcnt(5)
    v_mfma_f32_32x32x16_bf16 v[144:159], v[164:167], v[4:7], v[144:159]
    ds_read_b128 v[188:191], v240 offset:35840
    s_waitcnt lgkmcnt(5)
    v_mfma_f32_32x32x16_bf16 v[144:159], v[168:171], v[8:11], v[144:159]
    ds_read_b128 v[160:163], v240 offset:36864
    v_mul_f32 v128, v128, v136
    v_mul_f32 v129, v129, v137
    v_mul_f32_e64 v130, v130, v138
    s_waitcnt lgkmcnt(5)
    v_mfma_f32_32x32x16_bf16 v[144:159], v[172:175], v[12:15], v[144:159]
    ds_read_b128 v[164:167], v240 offset:37888
    v_mul_f32 v131, v131, v139
    v_mul_f32 v132, v132, v140
    v_mul_f32 v133, v133, v141
    s_waitcnt lgkmcnt(5)
    v_mfma_f32_32x32x16_bf16 v[144:159], v[176:179], v[16:19], v[144:159]
    ds_read_b128 v[168:171], v240 offset:38912
    v_mul_f32 v134, v134, v142
    v_mul_f32 v135, v135, v143
    v_mul_f32 v128, v248, v128
    s_waitcnt lgkmcnt(5)
    v_mfma_f32_32x32x16_bf16 v[144:159], v[180:183], v[20:23], v[144:159]
    ds_read_b128 v[172:175], v240 offset:39936
    v_mul_f32 v129, v248, v129
    v_mul_f32 v130, v248, v130
    v_mul_f32 v131, v248, v131
    s_waitcnt lgkmcnt(5)
    v_mfma_f32_32x32x16_bf16 v[144:159], v[184:187], v[24:27], v[144:159]
    ds_read_b128 v[176:179], v240 offset:40960
    v_mul_f32 v132, v248, v132
    v_mul_f32 v133, v248, v133
    v_mul_f32 v134, v248, v134
    s_waitcnt lgkmcnt(5)
    v_mfma_f32_32x32x16_bf16 v[144:159], v[188:191], v[28:31], v[144:159]
    ds_read_b128 v[180:183], v240 offset:41984
    v_mul_f32_e64 v135, v248, v135
    v_cvt_pk_bf16_f32 v136, v128, v129
    v_cvt_pk_bf16_f32 v137, v130, v131
    s_waitcnt lgkmcnt(5)
    s_nop 0
    v_mfma_f32_32x32x16_bf16 v[144:159], v[160:163], v[32:35], v[144:159]
    ds_read_b128 v[184:187], v240 offset:43008
    v_cvt_pk_bf16_f32 v138, v132, v133
    v_cvt_pk_bf16_f32 v139, v134, v135
    buffer_store_dwordx4 v[136:139], v246, s[84:87], s9 offen offset:1024 sc1
    s_waitcnt lgkmcnt(5)
    v_mfma_f32_32x32x16_bf16 v[144:159], v[164:167], v[36:39], v[144:159]
    ds_read_b128 v[188:191], v240 offset:44032
    v_add3_u32 v253, v136, v137, v138
    v_add_u32_e64 v253, v253, v139
    s_waitcnt lgkmcnt(5)
    v_mfma_f32_32x32x16_bf16 v[144:159], v[168:171], v[40:43], v[144:159]
    ds_read_b128 v[160:163], v240 offset:45056
    s_waitcnt lgkmcnt(5)
    v_mfma_f32_32x32x16_bf16 v[144:159], v[172:175], v[44:47], v[144:159]
    ds_read_b128 v[164:167], v240 offset:46080
    s_waitcnt lgkmcnt(5)
    v_mfma_f32_32x32x16_bf16 v[144:159], v[176:179], v[48:51], v[144:159]
    ds_read_b128 v[168:171], v240 offset:47104
    s_waitcnt lgkmcnt(5)
    v_mfma_f32_32x32x16_bf16 v[144:159], v[180:183], v[52:55], v[144:159]
    ds_read_b128 v[172:175], v240 offset:48128
    s_waitcnt lgkmcnt(5)
    v_mfma_f32_32x32x16_bf16 v[144:159], v[184:187], v[56:59], v[144:159]
    ds_read_b128 v[176:179], v240 offset:49152
    s_waitcnt lgkmcnt(5)
    v_mfma_f32_32x32x16_bf16 v[144:159], v[188:191], v[60:63], v[144:159]
    ds_read_b128 v[180:183], v240 offset:50176
    s_waitcnt lgkmcnt(5)
    v_mfma_f32_32x32x16_bf16 v[144:159], v[160:163], v[64:67], v[144:159]
    s_lshl_b32 s12, s6, 2
    s_add_u32 s12, s12, s3
    s_lshl_b32 s12, s12, 7
    s_nop 0
    s_add_u32 s12, s12, 40960
    s_add_u32 s11, s12, 8192
    s_mov_b64 exec, 0xff
    buffer_load_dwordx2 v[208:209], v243, s[84:87], s12 offen sc1
    buffer_load_dwordx2 v[210:211], v243, s[84:87], s11 offen sc1
    s_mov_b64 exec, -1
    s_and_b32 s11, s7, 1
    s_lshl_b32 s11, s11, 1
    s_lshl_b32 s15, s6, 2
    s_add_u32 s11, s11, s15
    s_lshr_b32 s15, s3, 1
    s_add_u32 s11, s11, s15
    s_mul_i32 s15, s3, 28
    s_mul_i32 s48, s11, 112
    s_add_u32 s48, s48, s15
    s_lshl_b32 s48, s48, 10
    s_add_u32 s48, s48, 11534336
    s_xor_b32 s11, s11, 1
    s_mul_i32 s49, s11, 112
    s_add_u32 s49, s49, s15
    s_lshl_b32 s49, s49, 10
    s_add_u32 s49, s49, 11534336
    ds_read_b128 v[184:187], v240 offset:51200
    s_waitcnt lgkmcnt(5)
    v_mfma_f32_32x32x16_bf16 v[144:159], v[164:167], v[68:71], v[144:159]
    ds_read_b128 v[188:191], v240 offset:52224
    s_waitcnt lgkmcnt(5)
    v_mfma_f32_32x32x16_bf16 v[144:159], v[168:171], v[72:75], v[144:159]
    ds_read_b128 v[160:163], v240 offset:53248
    s_waitcnt lgkmcnt(5)
    v_mfma_f32_32x32x16_bf16 v[144:159], v[172:175], v[76:79], v[144:159]
    ds_read_b128 v[164:167], v240 offset:54272
    s_waitcnt lgkmcnt(5)
    v_mfma_f32_32x32x16_bf16 v[144:159], v[176:179], v[80:83], v[144:159]
    ds_read_b128 v[168:171], v240 offset:55296
    s_waitcnt lgkmcnt(5)
    v_mfma_f32_32x32x16_bf16 v[144:159], v[180:183], v[84:87], v[144:159]
    ds_read_b128 v[172:175], v240 offset:56320
    s_waitcnt lgkmcnt(5)
    v_mfma_f32_32x32x16_bf16 v[144:159], v[184:187], v[88:91], v[144:159]
    s_waitcnt lgkmcnt(4)
    v_mfma_f32_32x32x16_bf16 v[144:159], v[188:191], v[92:95], v[144:159]
    s_waitcnt lgkmcnt(3)
    v_mfma_f32_32x32x16_bf16 v[144:159], v[160:163], v[96:99], v[144:159]
    s_waitcnt vmcnt(0)
    v_mov_b32_e64 v250, 0
    s_cmp_ge_u32 s7, 14
    s_cbranch_scc1 L_sdc
    s_mov_b64 exec, 0xff
    v_xor_b32 v208, s92, v208
    v_xor_b32 v210, s92, v210
    v_or_b32 v208, v208, v210
    v_cmp_ne_u32 vcc, 0, v208
    v_sub_u32 v250, v250, v209
    v_sub_u32 v250, v250, v211
    s_mov_b64 exec, -1
    s_cbranch_vccz L_sdc
    v_mov_b32_e64 v250, 0
    s_mov_b64 exec, 0xff
P_32:
    buffer_load_dwordx2 v[208:209], v243, s[84:87], s12 offen sc1
    s_waitcnt vmcnt(0)
    v_cmp_ne_u32 vcc, s92, v208
    s_add_u32 s95, s95, 1
    s_cmp_gt_u32 s95, 200000
    s_cbranch_scc1 PX_33
    s_cbranch_vccz PX_33
    s_sleep 1
    s_branch P_32
PX_33:
    v_sub_u32_e64 v250, v250, v209
    s_mov_b64 exec, -1
    s_add_u32 s11, s12, 8192
    s_mov_b64 exec, 0xff
P_34:
    buffer_load_dwordx2 v[208:209], v243, s[84:87], s11 offen sc1
    s_waitcnt vmcnt(0)
    v_cmp_ne_u32 vcc, s92, v208
    s_add_u32 s95, s95, 1
    s_cmp_gt_u32 s95, 200000
    s_cbranch_scc1 PX_35
    s_cbranch_vccz PX_35
    s_sleep 1
    s_branch P_34
PX_35:
    v_sub_u32 v250, v250, v209
    s_mov_b64 exec, -1
L_sdc:
    s_add_u32 s15, s48, 0
    buffer_load_dwordx4 v[112:115], v246, s[84:87], s15 offen sc1
    s_waitcnt lgkmcnt(2)
    v_mfma_f32_32x32x16_bf16 v[144:159], v[164:167], v[100:103], v[144:159]
    s_add_u32 s15, s49, 0
    buffer_load_dwordx4 v[116:119], v246, s[84:87], s15 offen sc1
    s_waitcnt lgkmcnt(1)
    v_mfma_f32_32x32x16_bf16 v[144:159], v[168:171], v[104:107], v[144:159]
    s_add_u32 s15, s48, 1024
    buffer_load_dwordx4 v[120:123], v246, s[84:87], s15 offen sc1
    s_waitcnt lgkmcnt(0)
    v_mfma_f32_32x32x16_bf16 v[144:159], v[172:175], v[108:111], v[144:159]
    s_add_u32 s15, s49, 1024
    buffer_load_dwordx4 v[124:127], v246, s[84:87], s15 offen sc1
    v_mfma_f32_32x32x16_bf16 v[144:159], a[248:251], v[220:223], v[144:159]
    s_cmp_ge_u32 s7, 14
    s_cbranch_scc1 L_p4_alt
    s_waitcnt vmcnt(3)
    v_mfma_f32_32x32x16_bf16 v[0:15], a[0:3], v[112:115], 0
    s_add_u32 s15, s48, 2048
    buffer_load_dwordx4 v[192:195], v246, s[84:87], s15 offen sc1
    s_nop 5
    v_mul_f32 v144, v144, v152
    v_mul_f32 v145, v145, v153
    v_mul_f32 v146, v146, v154
    v_mul_f32 v147, v147, v155
    v_mfma_f32_32x32x16_bf16 v[16:31], a[4:7], v[112:115], 0
    s_add_u32 s15, s49, 2048
    buffer_load_dwordx4 v[196:199], v246, s[84:87], s15 offen sc1
    v_add3_u32 v250, v250, v112, v113
    v_add3_u32 v250, v250, v114, v115
    v_mul_f32 v148, v148, v156
    v_mul_f32 v149, v149, v157
    v_mul_f32 v150, v150, v158
    v_mul_f32_e64 v151, v151, v159
    s_waitcnt vmcnt(4)
    v_mfma_f32_32x32x16_bf16 v[32:47], a[0:3], v[116:119], 0
    s_add_u32 s15, s48, 7168
    buffer_load_dwordx4 v[200:203], v246, s[84:87], s15 offen sc1
    v_mul_f32 v144, v248, v144
    v_mul_f32 v145, v248, v145
    v_mul_f32 v146, v248, v146
    v_mul_f32 v147, v248, v147
    v_mfma_f32_32x32x16_bf16 v[48:63], a[4:7], v[116:119], 0
    s_add_u32 s15, s49, 7168
    buffer_load_dwordx4 v[204:207], v246, s[84:87], s15 offen sc1
    v_add3_u32 v250, v250, v116, v117
    v_add3_u32 v250, v250, v118, v119
    v_mul_f32 v148, v248, v148
    v_mul_f32 v149, v248, v149
    v_mul_f32 v150, v248, v150
    v_mul_f32_e64 v151, v248, v151
    s_waitcnt vmcnt(5)
    v_mfma_f32_32x32x16_bf16 v[0:15], a[8:11], v[120:123], v[0:15]
    s_add_u32 s15, s48, 8192
    buffer_load_dwordx4 v[128:131], v246, s[84:87], s15 offen sc1
    v_cvt_pk_bf16_f32 v152, v144, v145
    v_cvt_pk_bf16_f32 v153, v146, v147
    v_cvt_pk_bf16_f32 v154, v148, v149
    v_cvt_pk_bf16_f32 v155, v150, v151
    v_mfma_f32_32x32x16_bf16 v[16:31], a[12:15], v[120:123], v[16:31]
    s_add_u32 s15, s49, 8192
    buffer_load_dwordx4 v[132:135], v246, s[84:87], s15 offen sc1
    v_add3_u32 v250, v250, v120, v121
    v_add3_u32 v250, v250, v122, v123
    buffer_store_dwordx4 v[152:155], v246, s[84:87], s9 offen offset:2048 sc1
    v_add3_u32 v253, v253, v152, v153
    v_add3_u32 v253, v253, v154, v155
    s_nop 1
    v_add_u32_dpp v253, v253, v253 row_shr:1 row_mask:0xf bank_mask:0xf bound_ctrl:0
    s_waitcnt vmcnt(7)
    v_mfma_f32_32x32x16_bf16 v[32:47], a[8:11], v[124:127], v[32:47]
    s_add_u32 s15, s48, 9216
    buffer_load_dwordx4 v[136:139], v246, s[84:87], s15 offen sc1
    v_add_u32_dpp v253, v253, v253 row_shr:2 row_mask:0xf bank_mask:0xf bound_ctrl:0
    v_mfma_f32_32x32x16_bf16 v[48:63], a[12:15], v[124:127], v[48:63]
    s_add_u32 s15, s49, 9216
    buffer_load_dwordx4 v[140:143], v246, s[84:87], s15 offen sc1
    v_add3_u32 v250, v250, v124, v125
    v_add3_u32 v250, v250, v126, v127
    v_add_u32_dpp v253, v253, v253 row_shr:4 row_mask:0xf bank_mask:0xf bound_ctrl:0
    s_waitcnt vmcnt(8)
    v_mfma_f32_32x32x16_bf16 v[0:15], a[16:19], v[192:195], v[0:15]
    s_add_u32 s15, s48, 14336
    buffer_load_dwordx4 v[208:211], v246, s[84:87], s15 offen sc1
    v_add_u32_dpp v253, v253, v253 row_shr:8 row_mask:0xf bank_mask:0xf bound_ctrl:0
    s_nop 1
    v_add_u32_dpp v253, v253, v253 row_bcast:15 row_mask:0xa bank_mask:0xf
    v_mfma_f32_32x32x16_bf16 v[16:31], a[20:23], v[192:195], v[16:31]
    s_add_u32 s15, s49, 14336
    buffer_load_dwordx4 v[212:215], v246, s[84:87], s15 offen sc1
    v_add3_u32 v250, v250, v192, v193
    v_add3_u32 v250, v250, v194, v195
    v_add_u32_dpp v253, v253, v253 row_bcast:31 row_mask:0xc bank_mask:0xf
    s_waitcnt vmcnt(9)
    v_mfma_f32_32x32x16_bf16 v[32:47], a[16:19], v[196:199], v[32:47]
    s_add_u32 s15, s48, 15360
    buffer_load_dwordx4 v[216:219], v246, s[84:87], s15 offen sc1
    s_add_u32 s11, s10, 16384
    s_mov_b32 exec_lo, 0
    s_brev_b32 exec_hi, 1
    buffer_store_dwordx2 v[252:253], v254, s[84:87], s11 offen offset:0 sc1
    s_mov_b64 exec, -1
    v_mfma_f32_32x32x16_bf16 v[48:63], a[20:23], v[196:199], v[48:63]
    s_add_u32 s15, s49, 15360
    buffer_load_dwordx4 v[160:163], v246, s[84:87], s15 offen sc1
    v_add3_u32 v250, v250, v196, v197
    v_add3_u32 v250, v250, v198, v199
    s_waitcnt vmcnt(11)
    s_nop 0
    v_mfma_f32_32x32x16_bf16 v[0:15], a[56:59], v[200:203], v[0:15]
    s_add_u32 s15, s48, 16384
    buffer_load_dwordx4 v[164:167], v246, s[84:87], s15 offen sc1
    v_mfma_f32_32x32x16_bf16 v[16:31], a[60:63], v[200:203], v[16:31]
    s_add_u32 s15, s49, 16384
    buffer_load_dwordx4 v[168:171], v246, s[84:87], s15 offen sc1
    v_add3_u32 v250, v250, v200, v201
    v_add3_u32 v250, v250, v202, v203
    s_waitcnt vmcnt(12)
    s_nop 0
    v_mfma_f32_32x32x16_bf16 v[32:47], a[56:59], v[204:207], v[32:47]
    s_add_u32 s15, s48, 21504
    buffer_load_dwordx4 v[172:175], v246, s[84:87], s15 offen sc1
    v_mfma_f32_32x32x16_bf16 v[48:63], a[60:63], v[204:207], v[48:63]
    v_add3_u32 v250, v250, v204, v205
    v_add3_u32 v250, v250, v206, v207
    s_waitcnt vmcnt(12)
    s_nop 0
    v_mfma_f32_32x32x16_bf16 v[0:15], a[64:67], v[128:131], v[0:15]
    s_add_u32 s15, s49, 21504
    buffer_load_dwordx4 v[176:179], v246, s[84:87], s15 offen sc1
    v_mfma_f32_32x32x16_bf16 v[16:31], a[68:71], v[128:131], v[16:31]
    v_add3_u32 v250, v250, v128, v129
    v_add3_u32 v250, v250, v130, v131
    s_waitcnt vmcnt(12)
    s_nop 0
    v_mfma_f32_32x32x16_bf16 v[32:47], a[64:67], v[132:135], v[32:47]
    s_add_u32 s15, s48, 22528
    buffer_load_dwordx4 v[180:183], v246, s[84:87], s15 offen sc1
    v_mfma_f32_32x32x16_bf16 v[48:63], a[68:71], v[132:135], v[48:63]
    v_add3_u32 v250, v250, v132, v133
    v_add3_u32 v250, v250, v134, v135
    s_waitcnt vmcnt(11)
    s_nop 0
    v_mfma_f32_32x32x16_bf16 v[0:15], a[72:75], v[136:139], v[0:15]
    s_add_u32 s15, s49, 22528
    buffer_load_dwordx4 v[184:187], v246, s[84:87], s15 offen sc1
    v_mfma_f32_32x32x16_bf16 v[16:31], a[76:79], v[136:139], v[16:31]
    v_add3_u32 v250, v250, v136, v137
    v_add3_u32 v250, v250, v138, v139
    s_waitcnt vmcnt(11)
    s_nop 0
    v_mfma_f32_32x32x16_bf16 v[32:47], a[72:75], v[140:143], v[32:47]
    s_add_u32 s15, s48, 23552
    buffer_load_dwordx4 v[188:191], v246, s[84:87], s15 offen sc1
    v_mfma_f32_32x32x16_bf16 v[48:63], a[76:79], v[140:143], v[48:63]
    v_add3_u32 v250, v250, v140, v141
    v_add3_u32 v250, v250, v142, v143
    s_waitcnt vmcnt(11)
    s_nop 0
    v_mfma_f32_32x32x16_bf16 v[0:15], a[112:115], v[208:211], v[0:15]
    s_add_u32 s15, s49, 23552
    buffer_load_dwordx4 v[64:67], v246, s[84:87], s15 offen sc1
    v_mfma_f32_32x32x16_bf16 v[16:31], a[116:119], v[208:211], v[16:31]
    v_add3_u32 v250, v250, v208, v209
    v_add3_u32 v250, v250, v210, v211
    s_waitcnt vmcnt(11)
    s_nop 0
    v_mfma_f32_32x32x16_bf16 v[32:47], a[112:115], v[212:215], v[32:47]
    s_add_u32 s15, s48, 3072
    buffer_load_dwordx4 v[68:71], v246, s[84:87], s15 offen sc1
    v_mfma_f32_32x32x16_bf16 v[48:63], a[116:119], v[212:215], v[48:63]
    v_add3_u32 v250, v250, v212, v213
    v_add3_u32 v250, v250, v214, v215
    s_waitcnt vmcnt(11)
    s_nop 0
    v_mfma_f32_32x32x16_bf16 v[0:15], a[120:123], v[216:219], v[0:15]
    s_add_u32 s15, s49, 3072
    buffer_load_dwordx4 v[72:75], v246, s[84:87], s15 offen sc1
    v_mfma_f32_32x32x16_bf16 v[16:31], a[124:127], v[216:219], v[16:31]
    v_add3_u32 v250, v250, v216, v217
    v_add3_u32 v250, v250, v218, v219
    s_waitcnt vmcnt(10)
    s_nop 0
    v_mfma_f32_32x32x16_bf16 v[32:47], a[120:123], v[160:163], v[32:47]
    s_add_u32 s15, s48, 4096
    buffer_load_dwordx4 v[76:79], v246, s[84:87], s15 offen sc1
    v_mfma_f32_32x32x16_bf16 v[48:63], a[124:127], v[160:163], v[48:63]
    v_add3_u32 v250, v250, v160, v161
    v_add3_u32 v250, v250, v162, v163
    s_waitcnt vmcnt(10)
    s_nop 0
    v_mfma_f32_32x32x16_bf16 v[0:15], a[128:131], v[164:167], v[0:15]
    s_add_u32 s15, s49, 4096
    buffer_load_dwordx4 v[80:83], v246, s[84:87], s15 offen sc1
    v_mfma_f32_32x32x16_bf16 v[16:31], a[132:135], v[164:167], v[16:31]
    v_add3_u32 v250, v250, v164, v165
    v_add3_u32 v250, v250, v166, v167
    s_waitcnt vmcnt(10)
    s_nop 0
    v_mfma_f32_32x32x16_bf16 v[32:47], a[128:131], v[168:171], v[32:47]
    s_add_u32 s15, s48, 10240
    buffer_load_dwordx4 v[84:87], v246, s[84:87], s15 offen sc1
    v_mfma_f32_32x32x16_bf16 v[48:63], a[132:135], v[168:171], v[48:63]
    v_add3_u32 v250, v250, v168, v169
    v_add3_u32 v250, v250, v170, v171
    s_waitcnt vmcnt(10)
    s_nop 0
    v_mfma_f32_32x32x16_bf16 v[0:15], a[168:171], v[172:175], v[0:15]
    s_add_u32 s15, s49, 10240
    buffer_load_dwordx4 v[88:91], v246, s[84:87], s15 offen sc1
    v_mfma_f32_32x32x16_bf16 v[16:31], a[172:175], v[172:175], v[16:31]
    v_add3_u32 v250, v250, v172, v173
    v_add3_u32 v250, v250, v174, v175
    s_waitcnt vmcnt(10)
    s_nop 0
    v_mfma_f32_32x32x16_bf16 v[32:47], a[168:171], v[176:179], v[32:47]
    s_add_u32 s15, s48, 11264
    buffer_load_dwordx4 v[92:95], v246, s[84:87], s15 offen sc1
    v_mfma_f32_32x32x16_bf16 v[48:63], a[172:175], v[176:179], v[48:63]
    v_add3_u32 v250, v250, v176, v177
    v_add3_u32 v250, v250, v178, v179
    s_waitcnt vmcnt(10)
    s_nop 0
    v_mfma_f32_32x32x16_bf16 v[0:15], a[176:179], v[180:183], v[0:15]
    s_add_u32 s15, s49, 11264
    buffer_load_dwordx4 v[96:99], v246, s[84:87], s15 offen sc1
    v_mfma_f32_32x32x16_bf16 v[16:31], a[180:183], v[180:183], v[16:31]
    v_add3_u32 v250, v250, v180, v181
    v_add3_u32 v250, v250, v182, v183
    s_waitcnt vmcnt(10)
    s_nop 0
    v_mfma_f32_32x32x16_bf16 v[32:47], a[176:179], v[184:187], v[32:47]
    s_add_u32 s15, s48, 17408
    buffer_load_dwordx4 v[100:103], v246, s[84:87], s15 offen sc1
    v_mfma_f32_32x32x16_bf16 v[48:63], a[180:183], v[184:187], v[48:63]
    v_add3_u32 v250, v250, v184, v185
    v_add3_u32 v250, v250, v186, v187
    s_waitcnt vmcnt(10)
    s_nop 0
    v_mfma_f32_32x32x16_bf16 v[0:15], a[184:187], v[188:191], v[0:15]
    s_add_u32 s15, s49, 17408
    buffer_load_dwordx4 v[104:107], v246, s[84:87], s15 offen sc1
    v_mfma_f32_32x32x16_bf16 v[16:31], a[188:191], v[188:191], v[16:31]
    v_add3_u32 v250, v250, v188, v189
    v_add3_u32 v250, v250, v190, v191
    s_waitcnt vmcnt(10)
    s_nop 0
    v_mfma_f32_32x32x16_bf16 v[32:47], a[184:187], v[64:67], v[32:47]
    s_add_u32 s15, s48, 18432
    buffer_load_dwordx4 v[108:111], v246, s[84:87], s15 offen sc1
    v_mfma_f32_32x32x16_bf16 v[48:63], a[188:191], v[64:67], v[48:63]
    v_add3_u32 v250, v250, v64, v65
    v_add3_u32 v250, v250, v66, v67
    s_waitcnt vmcnt(10)
    s_nop 0
    v_mfma_f32_32x32x16_bf16 v[0:15], a[24:27], v[68:71], v[0:15]
    s_add_u32 s15, s49, 18432
    buffer_load_dwordx4 v[144:147], v246, s[84:87], s15 offen sc1
    v_mfma_f32_32x32x16_bf16 v[16:31], a[28:31], v[68:71], v[16:31]
    v_add3_u32 v250, v250, v68, v69
    v_add3_u32 v250, v250, v70, v71
    s_waitcnt vmcnt(10)
    s_nop 0
    v_mfma_f32_32x32x16_bf16 v[32:47], a[24:27], v[72:75], v[32:47]
    s_add_u32 s15, s48, 24576
    buffer_load_dwordx4 v[148:151], v246, s[84:87], s15 offen sc1
    v_mfma_f32_32x32x16_bf16 v[48:63], a[28:31], v[72:75], v[48:63]
    v_add3_u32 v250, v250, v72, v73
    v_add3_u32 v250, v250, v74, v75
    s_waitcnt vmcnt(10)
    s_nop 0
    v_mfma_f32_32x32x16_bf16 v[0:15], a[32:35], v[76:79], v[0:15]
    s_add_u32 s15, s49, 24576
    buffer_load_dwordx4 v[152:155], v246, s[84:87], s15 offen sc1
    v_mfma_f32_32x32x16_bf16 v[16:31], a[36:39], v[76:79], v[16:31]
    v_add3_u32 v250, v250, v76, v77
    v_add3_u32 v250, v250, v78, v79
    s_waitcnt vmcnt(10)
    s_nop 0
    v_mfma_f32_32x32x16_bf16 v[32:47], a[32:35], v[80:83], v[32:47]
    s_add_u32 s15, s48, 25600
    buffer_load_dwordx4 v[156:159], v246, s[84:87], s15 offen sc1
    v_mfma_f32_32x32x16_bf16 v[48:63], a[36:39], v[80:83], v[48:63]
    v_add3_u32 v250, v250, v80, v81
    v_add3_u32 v250, v250, v82, v83
    s_waitcnt vmcnt(10)
    s_nop 0
    v_mfma_f32_32x32x16_bf16 v[0:15], a[80:83], v[84:87], v[0:15]
    s_add_u32 s15, s49, 25600
    buffer_load_dwordx4 v[112:115], v246, s[84:87], s15 offen sc1
    v_mfma_f32_32x32x16_bf16 v[16:31], a[84:87], v[84:87], v[16:31]
    v_add3_u32 v250, v250, v84, v85
    v_add3_u32 v250, v250, v86, v87
    s_waitcnt vmcnt(10)
    v_mfma_f32_32x32x16_bf16 v[32:47], a[80:83], v[88:91], v[32:47]
    v_mfma_f32_32x32x16_bf16 v[48:63], a[84:87], v[88:91], v[48:63]
    v_add3_u32 v250, v250, v88, v89
    v_add3_u32 v250, v250, v90, v91
    s_waitcnt vmcnt(9)
    v_mfma_f32_32x32x16_bf16 v[0:15], a[88:91], v[92:95], v[0:15]
    v_mfma_f32_32x32x16_bf16 v[16:31], a[92:95], v[92:95], v[16:31]
    v_add3_u32 v250, v250, v92, v93
    v_add3_u32 v250, v250, v94, v95
    s_waitcnt vmcnt(8)
    s_nop 0
    v_mfma_f32_32x32x16_bf16 v[32:47], a[88:91], v[96:99], v[32:47]
    v_mfma_f32_32x32x16_bf16 v[48:63], a[92:95], v[96:99], v[48:63]
    v_add3_u32 v250, v250, v96, v97
    v_add3_u32 v250, v250, v98, v99
    s_add_u32 s11, s12, 16384
    s_mov_b64 exec, 0xff
P_36:
    buffer_load_dwordx2 v[248:249], v243, s[84:87], s11 offen sc1
    s_waitcnt vmcnt(0)
    v_cmp_ne_u32 vcc, s92, v248
    s_add_u32 s95, s95, 1
    s_cmp_gt_u32 s95, 200000
    s_cbranch_scc1 PX_37
    s_cbranch_vccz PX_37
    s_sleep 1
    s_branch P_36
PX_37:
    v_sub_u32_e64 v250, v250, v249
    s_mov_b64 exec, -1
    s_add_u32 s15, s48, 5120
    buffer_load_dwordx4 v[116:119], v246, s[84:87], s15 offen sc1
    s_add_u32 s15, s49, 5120
    buffer_load_dwordx4 v[120:123], v246, s[84:87], s15 offen sc1
    s_add_u32 s15, s48, 6144
    buffer_load_dwordx4 v[124:127], v246, s[84:87], s15 offen sc1
    s_add_u32 s15, s49, 6144
    buffer_load_dwordx4 v[192:195], v246, s[84:87], s15 offen sc1
    s_add_u32 s15, s48, 12288
    buffer_load_dwordx4 v[196:199], v246, s[84:87], s15 offen sc1
    s_add_u32 s15, s49, 12288
    buffer_load_dwordx4 v[200:203], v246, s[84:87], s15 offen sc1
    v_mfma_f32_32x32x16_bf16 v[0:15], a[136:139], v[100:103], v[0:15]
    s_add_u32 s15, s48, 13312
    buffer_load_dwordx4 v[204:207], v246, s[84:87], s15 offen sc1
    v_mfma_f32_32x32x16_bf16 v[16:31], a[140:143], v[100:103], v[16:31]
    s_add_u32 s15, s49, 13312
    buffer_load_dwordx4 v[128:131], v246, s[84:87], s15 offen sc1
    v_add3_u32 v250, v250, v100, v101
    v_add3_u32 v250, v250, v102, v103
    v_mfma_f32_32x32x16_bf16 v[32:47], a[136:139], v[104:107], v[32:47]
    s_add_u32 s15, s48, 19456
    buffer_load_dwordx4 v[132:135], v246, s[84:87], s15 offen sc1
    v_mfma_f32_32x32x16_bf16 v[48:63], a[140:143], v[104:107], v[48:63]
    s_add_u32 s15, s49, 19456
    buffer_load_dwordx4 v[136:139], v246, s[84:87], s15 offen sc1
    v_add3_u32 v250, v250, v104, v105
    v_add3_u32 v250, v250, v106, v107
    v_mfma_f32_32x32x16_bf16 v[0:15], a[144:147], v[108:111], v[0:15]
    s_add_u32 s15, s48, 20480
    buffer_load_dwordx4 v[140:143], v246, s[84:87], s15 offen sc1
    v_mfma_f32_32x32x16_bf16 v[16:31], a[148:151], v[108:111], v[16:31]
    s_add_u32 s15, s49, 20480
    buffer_load_dwordx4 v[208:211], v246, s[84:87], s15 offen sc1
    v_add3_u32 v250, v250, v108, v109
    v_add3_u32 v250, v250, v110, v111
    v_mfma_f32_32x32x16_bf16 v[32:47], a[144:147], v[144:147], v[32:47]
    s_add_u32 s15, s48, 26624
    buffer_load_dwordx4 v[212:215], v246, s[84:87], s15 offen sc1
    v_mfma_f32_32x32x16_bf16 v[48:63], a[148:151], v[144:147], v[48:63]
    s_add_u32 s15, s49, 26624
    buffer_load_dwordx4 v[216:219], v246, s[84:87], s15 offen sc1
    v_add3_u32 v250, v250, v144, v145
    v_add3_u32 v250, v250, v146, v147
    v_mfma_f32_32x32x16_bf16 v[0:15], a[192:195], v[148:151], v[0:15]
    s_add_u32 s15, s48, 27648
    buffer_load_dwordx4 v[160:163], v246, s[84:87], s15 offen sc1
    v_mfma_f32_32x32x16_bf16 v[16:31], a[196:199], v[148:151], v[16:31]
    s_add_u32 s15, s49, 27648
    buffer_load_dwordx4 v[164:167], v246, s[84:87], s15 offen sc1
    v_add3_u32 v250, v250, v148, v149
    v_add3_u32 v250, v250, v150, v151
    v_mfma_f32_32x32x16_bf16 v[32:47], a[192:195], v[152:155], v[32:47]
    v_mfma_f32_32x32x16_bf16 v[48:63], a[196:199], v[152:155], v[48:63]
    v_add3_u32 v250, v250, v152, v153
    v_add3_u32 v250, v250, v154, v155
    v_mfma_f32_32x32x16_bf16 v[0:15], a[200:203], v[156:159], v[0:15]
    v_mfma_f32_32x32x16_bf16 v[16:31], a[204:207], v[156:159], v[16:31]
    v_add3_u32 v250, v250, v156, v157
    v_add3_u32 v250, v250, v158, v159
    v_mfma_f32_32x32x16_bf16 v[32:47], a[200:203], v[112:115], v[32:47]
    v_mfma_f32_32x32x16_bf16 v[48:63], a[204:207], v[112:115], v[48:63]
    v_add3_u32 v250, v250, v112, v113
    v_add3_u32 v250, v250, v114, v115
    s_waitcnt vmcnt(15)
    v_mfma_f32_32x32x16_bf16 v[0:15], a[40:43], v[116:119], v[0:15]
    v_mfma_f32_32x32x16_bf16 v[16:31], a[44:47], v[116:119], v[16:31]
    v_add3_u32 v250, v250, v116, v117
    v_add3_u32 v250, v250, v118, v119
    s_waitcnt vmcnt(14)
    v_mfma_f32_32x32x16_bf16 v[32:47], a[40:43], v[120:123], v[32:47]
    v_mfma_f32_32x32x16_bf16 v[48:63], a[44:47], v[120:123], v[48:63]
    v_add3_u32 v250, v250, v120, v121
    v_add3_u32 v250, v250, v122, v123
    s_waitcnt vmcnt(13)
    v_mfma_f32_32x32x16_bf16 v[0:15], a[48:51], v[124:127], v[0:15]
    v_mfma_f32_32x32x16_bf16 v[16:31], a[52:55], v[124:127], v[16:31]
    v_add3_u32 v250, v250, v124, v125
    v_add3_u32 v250, v250, v126, v127
    s_waitcnt vmcnt(12)
    v_mfma_f32_32x32x16_bf16 v[32:47], a[48:51], v[192:195], v[32:47]
    v_mfma_f32_32x32x16_bf16 v[48:63], a[52:55], v[192:195], v[48:63]
    v_add3_u32 v250, v250, v192, v193
    v_add3_u32 v250, v250, v194, v195
    s_waitcnt vmcnt(11)
    v_mfma_f32_32x32x16_bf16 v[0:15], a[96:99], v[196:199], v[0:15]
    v_mfma_f32_32x32x16_bf16 v[16:31], a[100:103], v[196:199], v[16:31]
    v_add3_u32 v250, v250, v196, v197
    v_add3_u32 v250, v250, v198, v199
    s_waitcnt vmcnt(10)
    v_mfma_f32_32x32x16_bf16 v[32:47], a[96:99], v[200:203], v[32:47]
    v_mfma_f32_32x32x16_bf16 v[48:63], a[100:103], v[200:203], v[48:63]
    v_add3_u32 v250, v250, v200, v201
    v_add3_u32 v250, v250, v202, v203
    s_waitcnt vmcnt(9)
    v_mfma_f32_32x32x16_bf16 v[0:15], a[104:107], v[204:207], v[0:15]
    v_mfma_f32_32x32x16_bf16 v[16:31], a[108:111], v[204:207], v[16:31]
    v_add3_u32 v250, v250, v204, v205
    v_add3_u32 v250, v250, v206, v207
    s_waitcnt vmcnt(8)
    v_mfma_f32_32x32x16_bf16 v[32:47], a[104:107], v[128:131], v[32:47]
    v_mfma_f32_32x32x16_bf16 v[48:63], a[108:111], v[128:131], v[48:63]
    v_add3_u32 v250, v250, v128, v129
    v_add3_u32 v250, v250, v130, v131
    s_waitcnt vmcnt(7)
    v_mfma_f32_32x32x16_bf16 v[0:15], a[152:155], v[132:135], v[0:15]
    v_mfma_f32_32x32x16_bf16 v[16:31], a[156:159], v[132:135], v[16:31]
    v_add3_u32 v250, v250, v132, v133
    v_add3_u32 v250, v250, v134, v135
    s_waitcnt vmcnt(6)
    v_mfma_f32_32x32x16_bf16 v[32:47], a[152:155], v[136:139], v[32:47]
    v_mfma_f32_32x32x16_bf16 v[48:63], a[156:159], v[136:139], v[48:63]
    v_add3_u32 v250, v250, v136, v137
    v_add3_u32 v250, v250, v138, v139
    s_waitcnt vmcnt(5)
    v_mfma_f32_32x32x16_bf16 v[0:15], a[160:163], v[140:143], v[0:15]
    v_mfma_f32_32x32x16_bf16 v[16:31], a[164:167], v[140:143], v[16:31]
    v_add3_u32 v250, v250, v140, v141
    v_add3_u32 v250, v250, v142, v143
    s_waitcnt vmcnt(4)
    v_mfma_f32_32x32x16_bf16 v[32:47], a[160:163], v[208:211], v[32:47]
    v_mfma_f32_32x32x16_bf16 v[48:63], a[164:167], v[208:211], v[48:63]
    v_add3_u32 v250, v250, v208, v209
    v_add3_u32 v250, v250, v210, v211
    s_waitcnt vmcnt(3)
    v_mfma_f32_32x32x16_bf16 v[0:15], a[208:211], v[212:215], v[0:15]
    v_mfma_f32_32x32x16_bf16 v[16:31], a[212:215], v[212:215], v[16:31]
    v_add3_u32 v250, v250, v212, v213
    v_add3_u32 v250, v250, v214, v215
    s_waitcnt vmcnt(2)
    v_mfma_f32_32x32x16_bf16 v[32:47], a[208:211], v[216:219], v[32:47]
    v_mfma_f32_32x32x16_bf16 v[48:63], a[212:215], v[216:219], v[48:63]
    v_add3_u32 v250, v250, v216, v217
    v_add3_u32 v250, v250, v218, v219
    s_waitcnt vmcnt(1)
    v_mfma_f32_32x32x16_bf16 v[0:15], a[216:219], v[160:163], v[0:15]
    v_mfma_f32_32x32x16_bf16 v[16:31], a[220:223], v[160:163], v[16:31]
    v_add3_u32 v250, v250, v160, v161
    v_add3_u32 v250, v250, v162, v163
    s_waitcnt vmcnt(0)
    v_mfma_f32_32x32x16_bf16 v[32:47], a[216:219], v[164:167], v[32:47]
    v_mfma_f32_32x32x16_bf16 v[48:63], a[220:223], v[164:167], v[48:63]
    v_add3_u32 v250, v250, v164, v165
    v_add3_u32 v250, v250, v166, v167
    s_branch L_sd_j
L_sd_retry:
    v_mov_b32 v250, 0
    s_mov_b64 exec, 0xff
P_38:
    buffer_load_dwordx2 v[248:249], v243, s[84:87], s12 offen sc1
    s_waitcnt vmcnt(0)
    v_cmp_ne_u32 vcc, s92, v248
    s_add_u32 s95, s95, 1
    s_cmp_gt_u32 s95, 200000
    s_cbranch_scc1 PX_39
    s_cbranch_vccz PX_39
    s_sleep 1
    s_branch P_38
PX_39:
    v_sub_u32_e64 v250, v250, v249
    s_mov_b64 exec, -1
    s_add_u32 s11, s12, 8192
    s_mov_b64 exec, 0xff
P_40:
    buffer_load_dwordx2 v[248:249], v243, s[84:87], s11 offen sc1
    s_waitcnt vmcnt(0)
    v_cmp_ne_u32 vcc, s92, v248
    s_add_u32 s95, s95, 1
    s_cmp_gt_u32 s95, 200000
    s_cbranch_scc1 PX_41
    s_cbranch_vccz PX_41
    s_sleep 1
    s_branch P_40
PX_41:
    v_sub_u32_e64 v250, v250, v249
    s_mov_b64 exec, -1
    s_add_u32 s11, s12, 16384
    s_mov_b64 exec, 0xff
P_42:
    buffer_load_dwordx2 v[248:249], v243, s[84:87], s11 offen sc1
    s_waitcnt vmcnt(0)
    v_cmp_ne_u32 vcc, s92, v248
    s_add_u32 s95, s95, 1
    s_cmp_gt_u32 s95, 200000
    s_cbranch_scc1 PX_43
    s_cbranch_vccz PX_43
    s_sleep 1
    s_branch P_42
PX_43:
    v_sub_u32 v250, v250, v249
    s_mov_b64 exec, -1
    s_add_u32 s15, s48, 0
    buffer_load_dwordx4 v[112:115], v246, s[84:87], s15 offen sc1
    s_waitcnt vmcnt(0)
    v_mfma_f32_32x32x16_bf16 v[0:15], a[0:3], v[112:115], 0
    v_mfma_f32_32x32x16_bf16 v[16:31], a[4:7], v[112:115], 0
    v_add3_u32 v250, v250, v112, v113
    v_add3_u32 v250, v250, v114, v115
    s_add_u32 s15, s49, 0
    buffer_load_dwordx4 v[116:119], v246, s[84:87], s15 offen sc1
    s_waitcnt vmcnt(0)
    s_nop 0
    v_mfma_f32_32x32x16_bf16 v[32:47], a[0:3], v[116:119], 0
    v_mfma_f32_32x32x16_bf16 v[48:63], a[4:7], v[116:119], 0
    v_add3_u32 v250, v250, v116, v117
    v_add3_u32 v250, v250, v118, v119
    s_add_u32 s15, s48, 1024
    buffer_load_dwordx4 v[120:123], v246, s[84:87], s15 offen sc1
    s_waitcnt vmcnt(0)
    s_nop 0
    v_mfma_f32_32x32x16_bf16 v[0:15], a[8:11], v[120:123], v[0:15]
    v_mfma_f32_32x32x16_bf16 v[16:31], a[12:15], v[120:123], v[16:31]
    v_add3_u32 v250, v250, v120, v121
    v_add3_u32 v250, v250, v122, v123
    s_add_u32 s15, s49, 1024
    buffer_load_dwordx4 v[124:127], v246, s[84:87], s15 offen sc1
    s_waitcnt vmcnt(0)
    s_nop 0
    v_mfma_f32_32x32x16_bf16 v[32:47], a[8:11], v[124:127], v[32:47]
    v_mfma_f32_32x32x16_bf16 v[48:63], a[12:15], v[124:127], v[48:63]
    v_add3_u32 v250, v250, v124, v125
    v_add3_u32 v250, v250, v126, v127
    s_add_u32 s15, s48, 2048
    buffer_load_dwordx4 v[192:195], v246, s[84:87], s15 offen sc1
    s_waitcnt vmcnt(0)
    s_nop 0
    v_mfma_f32_32x32x16_bf16 v[0:15], a[16:19], v[192:195], v[0:15]
    v_mfma_f32_32x32x16_bf16 v[16:31], a[20:23], v[192:195], v[16:31]
    v_add3_u32 v250, v250, v192, v193
    v_add3_u32 v250, v250, v194, v195
    s_add_u32 s15, s49, 2048
    buffer_load_dwordx4 v[196:199], v246, s[84:87], s15 offen sc1
    s_waitcnt vmcnt(0)
    s_nop 0
    v_mfma_f32_32x32x16_bf16 v[32:47], a[16:19], v[196:199], v[32:47]
    v_mfma_f32_32x32x16_bf16 v[48:63], a[20:23], v[196:199], v[48:63]
    v_add3_u32 v250, v250, v196, v197
    v_add3_u32 v250, v250, v198, v199
    s_add_u32 s15, s48, 7168
    buffer_load_dwordx4 v[200:203], v246, s[84:87], s15 offen sc1
    s_waitcnt vmcnt(0)
    s_nop 0
    v_mfma_f32_32x32x16_bf16 v[0:15], a[56:59], v[200:203], v[0:15]
    v_mfma_f32_32x32x16_bf16 v[16:31], a[60:63], v[200:203], v[16:31]
    v_add3_u32 v250, v250, v200, v201
    v_add3_u32 v250, v250, v202, v203
    s_add_u32 s15, s49, 7168
    buffer_load_dwordx4 v[204:207], v246, s[84:87], s15 offen sc1
    s_waitcnt vmcnt(0)
    s_nop 0
    v_mfma_f32_32x32x16_bf16 v[32:47], a[56:59], v[204:207], v[32:47]
    v_mfma_f32_32x32x16_bf16 v[48:63], a[60:63], v[204:207], v[48:63]
    v_add3_u32 v250, v250, v204, v205
    v_add3_u32 v250, v250, v206, v207
    s_add_u32 s15, s48, 8192
    buffer_load_dwordx4 v[128:131], v246, s[84:87], s15 offen sc1
    s_waitcnt vmcnt(0)
    s_nop 0
    v_mfma_f32_32x32x16_bf16 v[0:15], a[64:67], v[128:131], v[0:15]
    v_mfma_f32_32x32x16_bf16 v[16:31], a[68:71], v[128:131], v[16:31]
    v_add3_u32 v250, v250, v128, v129
    v_add3_u32 v250, v250, v130, v131
    s_add_u32 s15, s49, 8192
    buffer_load_dwordx4 v[132:135], v246, s[84:87], s15 offen sc1
    s_waitcnt vmcnt(0)
    s_nop 0
    v_mfma_f32_32x32x16_bf16 v[32:47], a[64:67], v[132:135], v[32:47]
    v_mfma_f32_32x32x16_bf16 v[48:63], a[68:71], v[132:135], v[48:63]
    v_add3_u32 v250, v250, v132, v133
    v_add3_u32 v250, v250, v134, v135
    s_add_u32 s15, s48, 9216
    buffer_load_dwordx4 v[136:139], v246, s[84:87], s15 offen sc1
    s_waitcnt vmcnt(0)
    s_nop 0
    v_mfma_f32_32x32x16_bf16 v[0:15], a[72:75], v[136:139], v[0:15]
    v_mfma_f32_32x32x16_bf16 v[16:31], a[76:79], v[136:139], v[16:31]
    v_add3_u32 v250, v250, v136, v137
    v_add3_u32 v250, v250, v138, v139
    s_add_u32 s15, s49, 9216
    buffer_load_dwordx4 v[140:143], v246, s[84:87], s15 offen sc1
    s_waitcnt vmcnt(0)
    s_nop 0
    v_mfma_f32_32x32x16_bf16 v[32:47], a[72:75], v[140:143], v[32:47]
    v_mfma_f32_32x32x16_bf16 v[48:63], a[76:79], v[140:143], v[48:63]
    v_add3_u32 v250, v250, v140, v141
    v_add3_u32 v250, v250, v142, v143
    s_add_u32 s15, s48, 14336
    buffer_load_dwordx4 v[208:211], v246, s[84:87], s15 offen sc1
    s_waitcnt vmcnt(0)
    s_nop 0
    v_mfma_f32_32x32x16_bf16 v[0:15], a[112:115], v[208:211], v[0:15]
    v_mfma_f32_32x32x16_bf16 v[16:31], a[116:119], v[208:211], v[16:31]
    v_add3_u32 v250, v250, v208, v209
    v_add3_u32 v250, v250, v210, v211
    s_add_u32 s15, s49, 14336
    buffer_load_dwordx4 v[212:215], v246, s[84:87], s15 offen sc1
    s_waitcnt vmcnt(0)
    s_nop 0
    v_mfma_f32_32x32x16_bf16 v[32:47], a[112:115], v[212:215], v[32:47]
    v_mfma_f32_32x32x16_bf16 v[48:63], a[116:119], v[212:215], v[48:63]
    v_add3_u32 v250, v250, v212, v213
    v_add3_u32 v250, v250, v214, v215
    s_add_u32 s15, s48, 15360
    buffer_load_dwordx4 v[216:219], v246, s[84:87], s15 offen sc1
    s_waitcnt vmcnt(0)
    s_nop 0
    v_mfma_f32_32x32x16_bf16 v[0:15], a[120:123], v[216:219], v[0:15]
    v_mfma_f32_32x32x16_bf16 v[16:31], a[124:127], v[216:219], v[16:31]
    v_add3_u32 v250, v250, v216, v217
    v_add3_u32 v250, v250, v218, v219
    s_add_u32 s15, s49, 15360
    buffer_load_dwordx4 v[160:163], v246, s[84:87], s15 offen sc1
    s_waitcnt vmcnt(0)
    s_nop 0
    v_mfma_f32_32x32x16_bf16 v[32:47], a[120:123], v[160:163], v[32:47]
    v_mfma_f32_32x32x16_bf16 v[48:63], a[124:127], v[160:163], v[48:63]
    v_add3_u32 v250, v250, v160, v161
    v_add3_u32 v250, v250, v162, v163
    s_add_u32 s15, s48, 16384
    buffer_load_dwordx4 v[164:167], v246, s[84:87], s15 offen sc1
    s_waitcnt vmcnt(0)
    s_nop 0
    v_mfma_f32_32x32x16_bf16 v[0:15], a[128:131], v[164:167], v[0:15]
    v_mfma_f32_32x32x16_bf16 v[16:31], a[132:135], v[164:167], v[16:31]
    v_add3_u32 v250, v250, v164, v165
    v_add3_u32 v250, v250, v166, v167
    s_add_u32 s15, s49, 16384
    buffer_load_dwordx4 v[168:171], v246, s[84:87], s15 offen sc1
    s_waitcnt vmcnt(0)
    s_nop 0
    v_mfma_f32_32x32x16_bf16 v[32:47], a[128:131], v[168:171], v[32:47]
    v_mfma_f32_32x32x16_bf16 v[48:63], a[132:135], v[168:171], v[48:63]
    v_add3_u32 v250, v250, v168, v169
    v_add3_u32 v250, v250, v170, v171
    s_add_u32 s15, s48, 21504
    buffer_load_dwordx4 v[172:175], v246, s[84:87], s15 offen sc1
    s_waitcnt vmcnt(0)
    s_nop 0
    v_mfma_f32_32x32x16_bf16 v[0:15], a[168:171], v[172:175], v[0:15]
    v_mfma_f32_32x32x16_bf16 v[16:31], a[172:175], v[172:175], v[16:31]
    v_add3_u32 v250, v250, v172, v173
    v_add3_u32 v250, v250, v174, v175
    s_add_u32 s15, s49, 21504
    buffer_load_dwordx4 v[176:179], v246, s[84:87], s15 offen sc1
    s_waitcnt vmcnt(0)
    s_nop 0
    v_mfma_f32_32x32x16_bf16 v[32:47], a[168:171], v[176:179], v[32:47]
    v_mfma_f32_32x32x16_bf16 v[48:63], a[172:175], v[176:179], v[48:63]
    v_add3_u32 v250, v250, v176, v177
    v_add3_u32 v250, v250, v178, v179
    s_add_u32 s15, s48, 22528
    buffer_load_dwordx4 v[180:183], v246, s[84:87], s15 offen sc1
    s_waitcnt vmcnt(0)
    s_nop 0
    v_mfma_f32_32x32x16_bf16 v[0:15], a[176:179], v[180:183], v[0:15]
    v_mfma_f32_32x32x16_bf16 v[16:31], a[180:183], v[180:183], v[16:31]
    v_add3_u32 v250, v250, v180, v181
    v_add3_u32 v250, v250, v182, v183
    s_add_u32 s15, s49, 22528
    buffer_load_dwordx4 v[184:187], v246, s[84:87], s15 offen sc1
    s_waitcnt vmcnt(0)
    s_nop 0
    v_mfma_f32_32x32x16_bf16 v[32:47], a[176:179], v[184:187], v[32:47]
    v_mfma_f32_32x32x16_bf16 v[48:63], a[180:183], v[184:187], v[48:63]
    v_add3_u32 v250, v250, v184, v185
    v_add3_u32 v250, v250, v186, v187
    s_add_u32 s15, s48, 23552
    buffer_load_dwordx4 v[188:191], v246, s[84:87], s15 offen sc1
    s_waitcnt vmcnt(0)
    s_nop 0
    v_mfma_f32_32x32x16_bf16 v[0:15], a[184:187], v[188:191], v[0:15]
    v_mfma_f32_32x32x16_bf16 v[16:31], a[188:191], v[188:191], v[16:31]
    v_add3_u32 v250, v250, v188, v189
    v_add3_u32 v250, v250, v190, v191
    s_add_u32 s15, s49, 23552
    buffer_load_dwordx4 v[64:67], v246, s[84:87], s15 offen sc1
    s_waitcnt vmcnt(0)
    s_nop 0
    v_mfma_f32_32x32x16_bf16 v[32:47], a[184:187], v[64:67], v[32:47]
    v_mfma_f32_32x32x16_bf16 v[48:63], a[188:191], v[64:67], v[48:63]
    v_add3_u32 v250, v250, v64, v65
    v_add3_u32 v250, v250, v66, v67
    s_add_u32 s15, s48, 3072
    buffer_load_dwordx4 v[68:71], v246, s[84:87], s15 offen sc1
    s_waitcnt vmcnt(0)
    s_nop 0
    v_mfma_f32_32x32x16_bf16 v[0:15], a[24:27], v[68:71], v[0:15]
    v_mfma_f32_32x32x16_bf16 v[16:31], a[28:31], v[68:71], v[16:31]
    v_add3_u32 v250, v250, v68, v69
    v_add3_u32 v250, v250, v70, v71
    s_add_u32 s15, s49, 3072
    buffer_load_dwordx4 v[72:75], v246, s[84:87], s15 offen sc1
    s_waitcnt vmcnt(0)
    s_nop 0
    v_mfma_f32_32x32x16_bf16 v[32:47], a[24:27], v[72:75], v[32:47]
    v_mfma_f32_32x32x16_bf16 v[48:63], a[28:31], v[72:75], v[48:63]
    v_add3_u32 v250, v250, v72, v73
    v_add3_u32 v250, v250, v74, v75
    s_add_u32 s15, s48, 4096
    buffer_load_dwordx4 v[76:79], v246, s[84:87], s15 offen sc1
    s_waitcnt vmcnt(0)
    s_nop 0
    v_mfma_f32_32x32x16_bf16 v[0:15], a[32:35], v[76:79], v[0:15]
    v_mfma_f32_32x32x16_bf16 v[16:31], a[36:39], v[76:79], v[16:31]
    v_add3_u32 v250, v250, v76, v77
    v_add3_u32 v250, v250, v78, v79
    s_add_u32 s15, s49, 4096
    buffer_load_dwordx4 v[80:83], v246, s[84:87], s15 offen sc1
    s_waitcnt vmcnt(0)
    s_nop 0
    v_mfma_f32_32x32x16_bf16 v[32:47], a[32:35], v[80:83], v[32:47]
    v_mfma_f32_32x32x16_bf16 v[48:63], a[36:39], v[80:83], v[48:63]
    v_add3_u32 v250, v250, v80, v81
    v_add3_u32 v250, v250, v82, v83
    s_add_u32 s15, s48, 10240
    buffer_load_dwordx4 v[84:87], v246, s[84:87], s15 offen sc1
    s_waitcnt vmcnt(0)
    s_nop 0
    v_mfma_f32_32x32x16_bf16 v[0:15], a[80:83], v[84:87], v[0:15]
    v_mfma_f32_32x32x16_bf16 v[16:31], a[84:87], v[84:87], v[16:31]
    v_add3_u32 v250, v250, v84, v85
    v_add3_u32 v250, v250, v86, v87
    s_add_u32 s15, s49, 10240
    buffer_load_dwordx4 v[88:91], v246, s[84:87], s15 offen sc1
    s_waitcnt vmcnt(0)
    s_nop 0
    v_mfma_f32_32x32x16_bf16 v[32:47], a[80:83], v[88:91], v[32:47]
    v_mfma_f32_32x32x16_bf16 v[48:63], a[84:87], v[88:91], v[48:63]
    v_add3_u32 v250, v250, v88, v89
    v_add3_u32 v250, v250, v90, v91
    s_add_u32 s15, s48, 11264
    buffer_load_dwordx4 v[92:95], v246, s[84:87], s15 offen sc1
    s_waitcnt vmcnt(0)
    s_nop 0
    v_mfma_f32_32x32x16_bf16 v[0:15], a[88:91], v[92:95], v[0:15]
    v_mfma_f32_32x32x16_bf16 v[16:31], a[92:95], v[92:95], v[16:31]
    v_add3_u32 v250, v250, v92, v93
    v_add3_u32 v250, v250, v94, v95
    s_add_u32 s15, s49, 11264
    buffer_load_dwordx4 v[96:99], v246, s[84:87], s15 offen sc1
    s_waitcnt vmcnt(0)
    s_nop 0
    v_mfma_f32_32x32x16_bf16 v[32:47], a[88:91], v[96:99], v[32:47]
    v_mfma_f32_32x32x16_bf16 v[48:63], a[92:95], v[96:99], v[48:63]
    v_add3_u32 v250, v250, v96, v97
    v_add3_u32 v250, v250, v98, v99
    s_add_u32 s15, s48, 17408
    buffer_load_dwordx4 v[100:103], v246, s[84:87], s15 offen sc1
    s_waitcnt vmcnt(0)
    s_nop 0
    v_mfma_f32_32x32x16_bf16 v[0:15], a[136:139], v[100:103], v[0:15]
    v_mfma_f32_32x32x16_bf16 v[16:31], a[140:143], v[100:103], v[16:31]
    v_add3_u32 v250, v250, v100, v101
    v_add3_u32 v250, v250, v102, v103
    s_add_u32 s15, s49, 17408
    buffer_load_dwordx4 v[104:107], v246, s[84:87], s15 offen sc1
    s_waitcnt vmcnt(0)
    s_nop 0
    v_mfma_f32_32x32x16_bf16 v[32:47], a[136:139], v[104:107], v[32:47]
    v_mfma_f32_32x32x16_bf16 v[48:63], a[140:143], v[104:107], v[48:63]
    v_add3_u32 v250, v250, v104, v105
    v_add3_u32 v250, v250, v106, v107
    s_add_u32 s15, s48, 18432
    buffer_load_dwordx4 v[108:111], v246, s[84:87], s15 offen sc1
    s_waitcnt vmcnt(0)
    s_nop 0
    v_mfma_f32_32x32x16_bf16 v[0:15], a[144:147], v[108:111], v[0:15]
    v_mfma_f32_32x32x16_bf16 v[16:31], a[148:151], v[108:111], v[16:31]
    v_add3_u32 v250, v250, v108, v109
    v_add3_u32 v250, v250, v110, v111
    s_add_u32 s15, s49, 18432
    buffer_load_dwordx4 v[144:147], v246, s[84:87], s15 offen sc1
    s_waitcnt vmcnt(0)
    s_nop 0
    v_mfma_f32_32x32x16_bf16 v[32:47], a[144:147], v[144:147], v[32:47]
    v_mfma_f32_32x32x16_bf16 v[48:63], a[148:151], v[144:147], v[48:63]
    v_add3_u32 v250, v250, v144, v145
    v_add3_u32 v250, v250, v146, v147
    s_add_u32 s15, s48, 24576
    buffer_load_dwordx4 v[148:151], v246, s[84:87], s15 offen sc1
    s_waitcnt vmcnt(0)
    s_nop 0
    v_mfma_f32_32x32x16_bf16 v[0:15], a[192:195], v[148:151], v[0:15]
    v_mfma_f32_32x32x16_bf16 v[16:31], a[196:199], v[148:151], v[16:31]
    v_add3_u32 v250, v250, v148, v149
    v_add3_u32 v250, v250, v150, v151
    s_add_u32 s15, s49, 24576
    buffer_load_dwordx4 v[152:155], v246, s[84:87], s15 offen sc1
    s_waitcnt vmcnt(0)
    s_nop 0
    v_mfma_f32_32x32x16_bf16 v[32:47], a[192:195], v[152:155], v[32:47]
    v_mfma_f32_32x32x16_bf16 v[48:63], a[196:199], v[152:155], v[48:63]
    v_add3_u32 v250, v250, v152, v153
    v_add3_u32 v250, v250, v154, v155
    s_add_u32 s15, s48, 25600
    buffer_load_dwordx4 v[156:159], v246, s[84:87], s15 offen sc1
    s_waitcnt vmcnt(0)
    s_nop 0
    v_mfma_f32_32x32x16_bf16 v[0:15], a[200:203], v[156:159], v[0:15]
    v_mfma_f32_32x32x16_bf16 v[16:31], a[204:207], v[156:159], v[16:31]
    v_add3_u32 v250, v250, v156, v157
    v_add3_u32 v250, v250, v158, v159
    s_add_u32 s15, s49, 25600
    buffer_load_dwordx4 v[112:115], v246, s[84:87], s15 offen sc1
    s_waitcnt vmcnt(0)
    s_nop 0
    v_mfma_f32_32x32x16_bf16 v[32:47], a[200:203], v[112:115], v[32:47]
    v_mfma_f32_32x32x16_bf16 v[48:63], a[204:207], v[112:115], v[48:63]
    v_add3_u32 v250, v250, v112, v113
    v_add3_u32 v250, v250, v114, v115
    s_add_u32 s15, s48, 5120
    buffer_load_dwordx4 v[116:119], v246, s[84:87], s15 offen sc1
    s_waitcnt vmcnt(0)
    s_nop 0
    v_mfma_f32_32x32x16_bf16 v[0:15], a[40:43], v[116:119], v[0:15]
    v_mfma_f32_32x32x16_bf16 v[16:31], a[44:47], v[116:119], v[16:31]
    v_add3_u32 v250, v250, v116, v117
    v_add3_u32 v250, v250, v118, v119
    s_add_u32 s15, s49, 5120
    buffer_load_dwordx4 v[120:123], v246, s[84:87], s15 offen sc1
    s_waitcnt vmcnt(0)
    s_nop 0
    v_mfma_f32_32x32x16_bf16 v[32:47], a[40:43], v[120:123], v[32:47]
    v_mfma_f32_32x32x16_bf16 v[48:63], a[44:47], v[120:123], v[48:63]
    v_add3_u32 v250, v250, v120, v121
    v_add3_u32 v250, v250, v122, v123
    s_add_u32 s15, s48, 6144
    buffer_load_dwordx4 v[124:127], v246, s[84:87], s15 offen sc1
    s_waitcnt vmcnt(0)
    s_nop 0
    v_mfma_f32_32x32x16_bf16 v[0:15], a[48:51], v[124:127], v[0:15]
    v_mfma_f32_32x32x16_bf16 v[16:31], a[52:55], v[124:127], v[16:31]
    v_add3_u32 v250, v250, v124, v125
    v_add3_u32 v250, v250, v126, v127
    s_add_u32 s15, s49, 6144
    buffer_load_dwordx4 v[192:195], v246, s[84:87], s15 offen sc1
    s_waitcnt vmcnt(0)
    s_nop 0
    v_mfma_f32_32x32x16_bf16 v[32:47], a[48:51], v[192:195], v[32:47]
    v_mfma_f32_32x32x16_bf16 v[48:63], a[52:55], v[192:195], v[48:63]
    v_add3_u32 v250, v250, v192, v193
    v_add3_u32 v250, v250, v194, v195
    s_add_u32 s15, s48, 12288
    buffer_load_dwordx4 v[196:199], v246, s[84:87], s15 offen sc1
    s_waitcnt vmcnt(0)
    s_nop 0
    v_mfma_f32_32x32x16_bf16 v[0:15], a[96:99], v[196:199], v[0:15]
    v_mfma_f32_32x32x16_bf16 v[16:31], a[100:103], v[196:199], v[16:31]
    v_add3_u32 v250, v250, v196, v197
    v_add3_u32 v250, v250, v198, v199
    s_add_u32 s15, s49, 12288
    buffer_load_dwordx4 v[200:203], v246, s[84:87], s15 offen sc1
    s_waitcnt vmcnt(0)
    s_nop 0
    v_mfma_f32_32x32x16_bf16 v[32:47], a[96:99], v[200:203], v[32:47]
    v_mfma_f32_32x32x16_bf16 v[48:63], a[100:103], v[200:203], v[48:63]
    v_add3_u32 v250, v250, v200, v201
    v_add3_u32 v250, v250, v202, v203
    s_add_u32 s15, s48, 13312
    buffer_load_dwordx4 v[204:207], v246, s[84:87], s15 offen sc1
    s_waitcnt vmcnt(0)
    s_nop 0
    v_mfma_f32_32x32x16_bf16 v[0:15], a[104:107], v[204:207], v[0:15]
    v_mfma_f32_32x32x16_bf16 v[16:31], a[108:111], v[204:207], v[16:31]
    v_add3_u32 v250, v250, v204, v205
    v_add3_u32 v250, v250, v206, v207
    s_add_u32 s15, s49, 13312
    buffer_load_dwordx4 v[128:131], v246, s[84:87], s15 offen sc1
    s_waitcnt vmcnt(0)
    s_nop 0
    v_mfma_f32_32x32x16_bf16 v[32:47], a[104:107], v[128:131], v[32:47]
    v_mfma_f32_32x32x16_bf16 v[48:63], a[108:111], v[128:131], v[48:63]
    v_add3_u32 v250, v250, v128, v129
    v_add3_u32 v250, v250, v130, v131
    s_add_u32 s15, s48, 19456
    buffer_load_dwordx4 v[132:135], v246, s[84:87], s15 offen sc1
    s_waitcnt vmcnt(0)
    s_nop 0
    v_mfma_f32_32x32x16_bf16 v[0:15], a[152:155], v[132:135], v[0:15]
    v_mfma_f32_32x32x16_bf16 v[16:31], a[156:159], v[132:135], v[16:31]
    v_add3_u32 v250, v250, v132, v133
    v_add3_u32 v250, v250, v134, v135
    s_add_u32 s15, s49, 19456
    buffer_load_dwordx4 v[136:139], v246, s[84:87], s15 offen sc1
    s_waitcnt vmcnt(0)
    s_nop 0
    v_mfma_f32_32x32x16_bf16 v[32:47], a[152:155], v[136:139], v[32:47]
    v_mfma_f32_32x32x16_bf16 v[48:63], a[156:159], v[136:139], v[48:63]
    v_add3_u32 v250, v250, v136, v137
    v_add3_u32 v250, v250, v138, v139
    s_add_u32 s15, s48, 20480
    buffer_load_dwordx4 v[140:143], v246, s[84:87], s15 offen sc1
    s_waitcnt vmcnt(0)
    s_nop 0
    v_mfma_f32_32x32x16_bf16 v[0:15], a[160:163], v[140:143], v[0:15]
    v_mfma_f32_32x32x16_bf16 v[16:31], a[164:167], v[140:143], v[16:31]
    v_add3_u32 v250, v250, v140, v141
    v_add3_u32 v250, v250, v142, v143
    s_add_u32 s15, s49, 20480
    buffer_load_dwordx4 v[208:211], v246, s[84:87], s15 offen sc1
    s_waitcnt vmcnt(0)
    s_nop 0
    v_mfma_f32_32x32x16_bf16 v[32:47], a[160:163], v[208:211], v[32:47]
    v_mfma_f32_32x32x16_bf16 v[48:63], a[164:167], v[208:211], v[48:63]
    v_add3_u32 v250, v250, v208, v209
    v_add3_u32 v250, v250, v210, v211
    s_add_u32 s15, s48, 26624
    buffer_load_dwordx4 v[212:215], v246, s[84:87], s15 offen sc1
    s_waitcnt vmcnt(0)
    s_nop 0
    v_mfma_f32_32x32x16_bf16 v[0:15], a[208:211], v[212:215], v[0:15]
    v_mfma_f32_32x32x16_bf16 v[16:31], a[212:215], v[212:215], v[16:31]
    v_add3_u32 v250, v250, v212, v213
    v_add3_u32 v250, v250, v214, v215
    s_add_u32 s15, s49, 26624
    buffer_load_dwordx4 v[216:219], v246, s[84:87], s15 offen sc1
    s_waitcnt vmcnt(0)
    s_nop 0
    v_mfma_f32_32x32x16_bf16 v[32:47], a[208:211], v[216:219], v[32:47]
    v_mfma_f32_32x32x16_bf16 v[48:63], a[212:215], v[216:219], v[48:63]
    v_add3_u32 v250, v250, v216, v217
    v_add3_u32 v250, v250, v218, v219
    s_add_u32 s15, s48, 27648
    buffer_load_dwordx4 v[160:163], v246, s[84:87], s15 offen sc1
    s_waitcnt vmcnt(0)
    s_nop 0
    v_mfma_f32_32x32x16_bf16 v[0:15], a[216:219], v[160:163], v[0:15]
    v_mfma_f32_32x32x16_bf16 v[16:31], a[220:223], v[160:163], v[16:31]
    v_add3_u32 v250, v250, v160, v161
    v_add3_u32 v250, v250, v162, v163
    s_add_u32 s15, s49, 27648
    buffer_load_dwordx4 v[164:167], v246, s[84:87], s15 offen sc1
    s_waitcnt vmcnt(0)
    v_mfma_f32_32x32x16_bf16 v[32:47], a[216:219], v[164:167], v[32:47]
    v_mfma_f32_32x32x16_bf16 v[48:63], a[220:223], v[164:167], v[48:63]
    v_add3_u32 v250, v250, v164, v165
    v_add3_u32 v250, v250, v166, v167
L_sd_j:
    s_xor_b32 s8, s3, 1
    s_mul_i32 s8, s8, 12288
    v_add_u32 v241, s8, v246
    s_xor_b32 s8, s3, 2
    s_mul_i32 s8, s8, 12288
    v_add_u32 v244, s8, v246
    s_xor_b32 s8, s3, 3
    s_mul_i32 s8, s8, 12288
    v_add_u32_e64 v243, s8, v246
    s_mul_i32 s8, s3, 12288
    v_add_u32 v245, s8, v246
    s_barrier
    ds_write_b128 v241, v[16:19] offset:0
    v_add_u32_dpp v250, v250, v250 row_shr:1 row_mask:0xf bank_mask:0xf bound_ctrl:0
    ds_write_b128 v241, v[20:23] offset:1024
    ds_write_b128 v241, v[24:27] offset:2048
    v_add_u32_dpp v250, v250, v250 row_shr:2 row_mask:0xf bank_mask:0xf bound_ctrl:0
    ds_write_b128 v241, v[28:31] offset:3072
    ds_write_b128 v244, v[32:35] offset:4096
    v_add_u32_dpp v250, v250, v250 row_shr:4 row_mask:0xf bank_mask:0xf bound_ctrl:0
    ds_write_b128 v244, v[36:39] offset:5120
    ds_write_b128 v244, v[40:43] offset:6144
    v_add_u32_dpp v250, v250, v250 row_shr:8 row_mask:0xf bank_mask:0xf bound_ctrl:0
    ds_write_b128 v244, v[44:47] offset:7168
    ds_write_b128 v243, v[48:51] offset:8192
    v_add_u32_dpp v250, v250, v250 row_bcast:15 row_mask:0xa bank_mask:0xf
    ds_write_b128 v243, v[52:55] offset:9216
    ds_write_b128 v243, v[56:59] offset:10240
    v_add_u32_dpp v250, v250, v250 row_bcast:31 row_mask:0xc bank_mask:0xf
    ds_write_b128 v243, v[60:63] offset:11264
    v_readlane_b32 s8, v250, 63
    v_mov_b32 v248, 155648
    s_lshl_b32 s9, s3, 10
    v_add_u32 v249, s9, v248
    v_mov_b32_e64 v250, s8
    ds_write_b32 v249, v250
    v_lshlrev_b32 v128, 16, v232
    v_and_b32 v129, s100, v232
    v_lshlrev_b32 v144, 16, v224
    v_and_b32 v145, s100, v224
    v_lshlrev_b32 v130, 16, v233
    v_and_b32 v131, s100, v233
    v_lshlrev_b32 v146, 16, v225
    v_and_b32 v147, s100, v225
    v_lshlrev_b32 v132, 16, v234
    v_and_b32 v133, s100, v234
    v_lshlrev_b32 v148, 16, v226
    v_and_b32 v149, s100, v226
    v_lshlrev_b32 v134, 16, v235
    v_and_b32 v135, s100, v235
    v_lshlrev_b32 v150, 16, v227
    v_and_b32 v151, s100, v227
    v_lshlrev_b32 v136, 16, v236
    v_and_b32 v137, s100, v236
    v_lshlrev_b32 v152, 16, v228
    v_and_b32 v153, s100, v228
    v_lshlrev_b32 v138, 16, v237
    v_and_b32 v139, s100, v237
    v_lshlrev_b32 v154, 16, v229
    v_and_b32 v155, s100, v229
    v_lshlrev_b32 v140, 16, v238
    v_and_b32 v141, s100, v238
    v_lshlrev_b32 v156, 16, v230
    v_and_b32 v157, s100, v230
    v_lshlrev_b32 v142, 16, v239
    v_and_b32 v143, s100, v239
    v_lshlrev_b32 v158, 16, v231
    v_and_b32 v159, s100, v231
    v_and_b32_e64 v242, 31, v255
    v_mul_u32_u24 v242, 896, v242
    v_lshrrev_b32_e64 v241, 5, v255
    v_lshl_add_u32 v242, v241, 4, v242
    s_mul_i32 s8, s2, 28672
    s_and_b32 s9, s7, 14
    s_and_b32 s10, s3, 1
    s_add_u32 s9, s9, s10
    s_lshl_b32 s9, s9, 6
    s_add_u32 s8, s8, s9
    s_waitcnt lgkmcnt(0)
    s_barrier
    s_nop 0
    ds_read_b32 v160, v248 offset:0
    ds_read_b32 v161, v248 offset:1024
    ds_read_b32 v162, v248 offset:2048
    ds_read_b32 v163, v248 offset:3072
    ds_read_b128 v[64:67], v245 offset:0
    ds_read_b128 v[68:71], v245 offset:1024
    ds_read_b128 v[72:75], v245 offset:2048
    ds_read_b128 v[76:79], v245 offset:3072
    ds_read_b128 v[80:83], v245 offset:4096
    ds_read_b128 v[84:87], v245 offset:5120
    ds_read_b128 v[88:91], v245 offset:6144
    ds_read_b128 v[92:95], v245 offset:7168
    ds_read_b128 v[96:99], v245 offset:8192
    ds_read_b128 v[100:103], v245 offset:9216
    ds_read_b128 v[104:107], v245 offset:10240
    ds_read_b128 v[108:111], v245 offset:11264
    s_waitcnt lgkmcnt(8)
    v_or3_b32 v160, v160, v161, v162
    v_or_b32 v160, v160, v163
    s_nop 0
    v_readfirstlane_b32 s9, v160
    s_nop 0
    s_cmp_eq_u32 s9, 0
    s_cbranch_scc1 L_sd_ok
    s_add_u32 s95, s95, 1
    s_cmp_gt_u32 s95, 200000
    s_cbranch_scc1 L_sd_ok
    s_waitcnt lgkmcnt(0)
    s_and_b32 s11, s7, 1
    s_lshl_b32 s11, s11, 1
    v_lshrrev_b32 v243, 1, v255
    v_lshlrev_b32 v243, 5, v243
    v_and_b32 v245, 1, v255
    v_add_u32 v245, s11, v245
    v_lshl_add_u32 v243, v245, 3, v243
    s_branch L_sd_retry
L_sd_ok:
    s_nop 0
    v_pk_add_f32 v[0:1], v[0:1], v[64:65]
    v_pk_add_f32 v[2:3], v[2:3], v[66:67]
    v_pk_add_f32 v[4:5], v[4:5], v[68:69]
    v_pk_add_f32 v[6:7], v[6:7], v[70:71]
    v_pk_add_f32 v[8:9], v[8:9], v[72:73]
    v_pk_add_f32 v[10:11], v[10:11], v[74:75]
    v_pk_add_f32 v[12:13], v[12:13], v[76:77]
    v_pk_add_f32 v[14:15], v[14:15], v[78:79]
    s_waitcnt lgkmcnt(0)
    s_nop 0
    v_pk_add_f32 v[80:81], v[80:81], v[96:97]
    v_pk_add_f32 v[82:83], v[82:83], v[98:99]
    v_pk_add_f32 v[84:85], v[84:85], v[100:101]
    v_pk_add_f32 v[86:87], v[86:87], v[102:103]
    v_pk_add_f32 v[88:89], v[88:89], v[104:105]
    v_pk_add_f32 v[90:91], v[90:91], v[106:107]
    v_pk_add_f32 v[92:93], v[92:93], v[108:109]
    v_pk_add_f32 v[94:95], v[94:95], v[110:111]
    v_pk_add_f32 v[0:1], v[0:1], v[80:81]
    v_pk_add_f32 v[2:3], v[2:3], v[82:83]
    v_pk_add_f32 v[4:5], v[4:5], v[84:85]
    v_pk_add_f32 v[6:7], v[6:7], v[86:87]
    v_pk_add_f32 v[8:9], v[8:9], v[88:89]
    v_pk_add_f32 v[10:11], v[10:11], v[90:91]
    v_pk_add_f32 v[12:13], v[12:13], v[92:93]
    v_pk_add_f32 v[14:15], v[14:15], v[94:95]
    v_pk_fma_f32 v[0:1], v[0:1], v[144:145], v[128:129]
    v_pk_fma_f32 v[2:3], v[2:3], v[146:147], v[130:131]
    v_pk_fma_f32 v[4:5], v[4:5], v[148:149], v[132:133]
    v_pk_fma_f32 v[6:7], v[6:7], v[150:151], v[134:135]
    v_pk_fma_f32 v[8:9], v[8:9], v[152:153], v[136:137]
    v_pk_fma_f32 v[10:11], v[10:11], v[154:155], v[138:139]
    v_pk_fma_f32 v[12:13], v[12:13], v[156:157], v[140:141]
    v_pk_fma_f32 v[14:15], v[14:15], v[158:159], v[142:143]
    v_cvt_pk_bf16_f32 v80, v0, v1
    v_cvt_pk_bf16_f32 v81, v2, v3
    v_cvt_pk_bf16_f32 v82, v4, v5
    v_cvt_pk_bf16_f32 v83, v6, v7
    v_cvt_pk_bf16_f32 v84, v8, v9
    v_cvt_pk_bf16_f32 v85, v10, v11
    v_cvt_pk_bf16_f32 v86, v12, v13
    v_cvt_pk_bf16_f32 v87, v14, v15
    v_permlane32_swap_b32 v80, v82
    v_permlane32_swap_b32 v81, v83
    v_permlane32_swap_b32 v84, v86
    v_permlane32_swap_b32 v85, v87
    buffer_store_dwordx4 v[80:83], v242, s[80:83], s8 offen offset:0
    buffer_store_dwordx4 v[84:87], v242, s[80:83], s8 offen offset:32
    s_branch L_done
L_p4_alt:
    s_nop 9
    v_mul_f32 v144, v144, v152
    v_mul_f32 v145, v145, v153
    v_mul_f32 v146, v146, v154
    v_mul_f32 v147, v147, v155
    v_mul_f32 v148, v148, v156
    v_mul_f32 v149, v149, v157
    v_mul_f32 v150, v150, v158
    v_mul_f32 v151, v151, v159
    v_mul_f32 v144, v248, v144
    v_mul_f32 v145, v248, v145
    v_mul_f32 v146, v248, v146
    v_mul_f32 v147, v248, v147
    v_mul_f32 v148, v248, v148
    v_mul_f32 v149, v248, v149
    v_mul_f32 v150, v248, v150
    v_mul_f32 v151, v248, v151
    v_cvt_pk_bf16_f32 v152, v144, v145
    v_cvt_pk_bf16_f32 v153, v146, v147
    v_cvt_pk_bf16_f32 v154, v148, v149
    v_cvt_pk_bf16_f32 v155, v150, v151
    buffer_store_dwordx4 v[152:155], v246, s[84:87], s9 offen offset:2048 sc1
    v_add3_u32 v253, v253, v152, v153
    v_add3_u32 v253, v253, v154, v155
    s_nop 1
    v_add_u32_dpp v253, v253, v253 row_shr:1 row_mask:0xf bank_mask:0xf bound_ctrl:0
    s_nop 1
    v_add_u32_dpp v253, v253, v253 row_shr:2 row_mask:0xf bank_mask:0xf bound_ctrl:0
    s_nop 1
    v_add_u32_dpp v253, v253, v253 row_shr:4 row_mask:0xf bank_mask:0xf bound_ctrl:0
    s_nop 1
    v_add_u32_dpp v253, v253, v253 row_shr:8 row_mask:0xf bank_mask:0xf bound_ctrl:0
    s_nop 1
    v_add_u32_dpp v253, v253, v253 row_bcast:15 row_mask:0xa bank_mask:0xf
    s_nop 1
    v_add_u32_dpp v253, v253, v253 row_bcast:31 row_mask:0xc bank_mask:0xf
    s_add_u32 s11, s10, 16384
    s_mov_b32 exec_lo, 0
    s_brev_b32 exec_hi, 1
    buffer_store_dwordx2 v[252:253], v254, s[84:87], s11 offen offset:0 sc1
    s_mov_b64 exec, -1
L_done:
L_exit:
    s_endpgm
.section .rodata,"a"
.p2align 6
.amdhsa_kernel adaLN_cond__linear_kernel_hedgehog__glu_gated_bilinear__prompt_kernel
  .amdhsa_next_free_vgpr 512
  .amdhsa_next_free_sgpr 102
  .amdhsa_accum_offset 256
  .amdhsa_group_segment_fixed_size 0
  .amdhsa_kernarg_size 104
  .amdhsa_user_sgpr_count 2
  .amdhsa_user_sgpr_kernarg_segment_ptr 1
  .amdhsa_system_sgpr_workgroup_id_x 1
  .amdhsa_float_denorm_mode_32 3
.end_amdhsa_kernel
```
